```python
import torch

def _softmax(x, axis=-1):
    return torch.softmax(x, dim=axis)
def _gelu(x):
    return torch.nn.functional.gelu(x, approximate="tanh")
def _silu(x):
    return torch.nn.functional.silu(x)
def _sigmoid(x):
    return torch.sigmoid(x)
def _layernorm(x, axis=-1, eps=1e-5):
    m = x.mean(dim=axis, keepdim=True)
    v = x.var(dim=axis, keepdim=True, unbiased=False)
    return (x - m) / torch.sqrt(v + eps)
def _scatter_add(tgt, idx, src, axis=0):
    return tgt.clone().index_add_(axis, idx, src)
def _segment_sum(src, seg, n):
    out = torch.zeros((n,) + src.shape[1:], dtype=src.dtype)
    return out.index_add_(0, seg, src)
def _pad(x, pw):
    flat = tuple(v for pair in reversed(pw) for v in pair)
    return torch.nn.functional.pad(x, flat)

kernel_name = 'concat_heads__sliding_block__grouped_kv_mqa__prompt'

def setup_inputs():

    _w = (lambda a: (lambda t: t.to(torch.bfloat16) if t.is_floating_point() else t)(torch.as_tensor(a)))
    def _A_setup():
        B, S, D = 1, 2048, 640
        return {
            "x": _w((lambda *s: torch.randn(*s, dtype=torch.bfloat16) * 0.2)(B, S, D)),
            "wqkv": _w((lambda *s: torch.randn(*s, dtype=torch.bfloat16) * 0.8)(D, 3 * D)),
            "wo": _w((lambda *s: torch.randn(*s, dtype=torch.bfloat16) * 0.4)(D, D)),
        }
    _A_in = _A_setup()

    def _B_setup():
        B, S, D, H = 1, 2048, 640, 32
        Dh = D // H
        return {
            "x": _w((lambda *s: torch.randn(*s, dtype=torch.bfloat16) * 0.1)(B, S, D)),
            "wq": _w((lambda *s: torch.randn(*s, dtype=torch.bfloat16) * 0.8)(D, H * Dh)),
            "wk": _w((lambda *s: torch.randn(*s, dtype=torch.bfloat16) * 0.8)(D, Dh)),
            "wv": _w((lambda *s: torch.randn(*s, dtype=torch.bfloat16) * 0.8)(D, Dh)),
            "wo": _w((lambda *s: torch.randn(*s, dtype=torch.bfloat16) * 0.8)(H * Dh, D)),
        }
    _B_in = _B_setup()

    return {
        "A_x": _A_in["x"],
        "A_wqkv": _A_in["wqkv"],
        "A_wo": _A_in["wo"],
        "B_x": _B_in["x"],
        "B_wq": _B_in["wq"],
        "B_wk": _B_in["wk"],
        "B_wv": _B_in["wv"],
        "B_wo": _B_in["wo"],
    }

def reference(A_x, A_wqkv, A_wo, B_x, B_wq, B_wk, B_wv, B_wo):
    def _A_ref(x, wqkv, wo):
        B, S, D = x.shape
        H = 32; Dh = D // H; W = 256
        qkv = (lambda x, *d: x.permute(*d))((x @ wqkv).reshape(B, S, 3, H, Dh), 2, 0, 3, 1, 4)
        q, k, v = qkv[0], qkv[1], qkv[2]
        scores = torch.einsum("bhqd,bhkd->bhqk", q, k) * (Dh ** -0.5)
        idx = torch.arange(S)
        mask = (idx[:, None] - idx[None, :] >= 0) & (idx[:, None] - idx[None, :] < W)
        scores = torch.where(mask[None, None], scores, -1e9)
        p = _softmax(scores, axis=-1)
        o = torch.einsum("bhqk,bhkd->bhqd", p, v)
        return (lambda x, *d: x.permute(*d))(o, 0, 2, 1, 3).reshape(B, S, D) @ wo

    def _B_ref(x, wq, wk, wv, wo):
        B, S, D = x.shape
        H = 32
        Dh = D // H
        q = (lambda x, *d: x.permute(*d))((x @ wq).reshape(B, S, H, Dh), 0, 2, 1, 3)
        k = x @ wk
        v = x @ wv
        scores = torch.einsum("bhqd,bkd->bhqk", q, k) * (Dh ** -0.5)
        p = _softmax(scores, axis=-1)
        o = torch.einsum("bhqk,bkd->bhqd", p, v)
        return (lambda x, *d: x.permute(*d))(o, 0, 2, 1, 3).reshape(B, S, H * Dh) @ wo

    a = _A_ref(A_x, A_wqkv, A_wo)
    b = _B_ref(B_x, B_wq, B_wk, B_wv, B_wo)
    return torch.concatenate([a, b], axis=-1)
```

```asm
; @launch grid=(256,1,1) block=(512,1,1) lds=163840
.amdgcn_target "amdgcn-amd-amdhsa--gfx950"
.text
.globl concat_heads__sliding_block__grouped_kv_mqa__prompt_kernel
.p2align 8
.type concat_heads__sliding_block__grouped_kv_mqa__prompt_kernel,@function
concat_heads__sliding_block__grouped_kv_mqa__prompt_kernel:
    s_cmp_ge_u32 s2, 256
    s_cbranch_scc1 L_end
    s_load_dwordx2 s[32:33], s[0:1], 24
    s_load_dwordx2 s[36:37], s[0:1], 32
    s_load_dwordx4 s[4:7], s[0:1], 40
    s_load_dwordx2 s[52:53], s[0:1], 80
    s_load_dwordx2 s[20:21], s[0:1], 0
    s_load_dwordx2 s[24:25], s[0:1], 8
    s_load_dwordx2 s[28:29], s[0:1], 16
    s_load_dwordx2 s[44:45], s[0:1], 56
    s_load_dwordx2 s[48:49], s[0:1], 64
    v_lshrrev_b32 v1, 6, v0
    v_and_b32 v0, 63, v0
    v_readfirstlane_b32 s60, v1
    s_and_b32 s70, s2, 3
    s_bfe_u32 s71, s2, 0x10002
    s_bfe_u32 s73, s2, 0x30003
    s_lshl_b32 s63, s70, 3
    s_add_u32 s63, s63, s73
    s_lshr_b32 s74, s2, 6
    s_lshl_b32 s64, s71, 2
    s_add_u32 s64, s64, s74
    s_lshl_b32 s66, s60, 10
    s_and_b32 s81, s60, 3
    s_lshl_b32 s82, s81, 10
    s_bfe_u32 s76, s64, 0x10001
    v_lshlrev_b32 v27, 4, v0
    s_cmp_lt_u32 s60, 4
    s_cbranch_scc1 L_cons
    s_lshr_b32 s8, s2, 6
    s_bfe_u32 s72, s2, 0x30003
    s_mul_i32 s72, s72, 5
    s_lshr_b32 s72, s72, 2
    s_mul_i32 s8, s8, 5
    s_lshr_b32 s8, s8, 1
    s_add_u32 s8, s8, s72
    s_sub_u32 s72, s8, 10
    s_cselect_b32 s8, s8, s72
    s_add_u32 s9, s8, 1
    s_cmp_eq_u32 s9, 10
    s_cselect_b32 s9, 0, s9
    s_add_u32 s10, s9, 1
    s_cmp_eq_u32 s10, 10
    s_cselect_b32 s10, 0, s10
    s_lshl_b32 s70, s81, 3
    v_lshrrev_b32 v1, 3, v0
    v_add_u32 v1, s70, v1
    v_lshrrev_b32 v2, 1, v1
    v_xor_b32 v2, v2, v0
    v_and_b32 v2, 7, v2
    v_lshlrev_b32 v2, 4, v2
    s_lshl_b32 s71, s63, 6
    v_add_u32 v1, s71, v1
    v_mul_u32_u24 v1, 1280, v1
    v_add_u32 v22, v1, v2
    s_mov_b32 s34, 2621440
    s_mov_b32 s35, 0x20000
    s_mov_b32 s38, 819200
    s_mov_b32 s39, 0x20000
    s_mul_i32 s72, s64, 160
    s_lshl_b32 s70, s81, 6
    s_mul_i32 s71, s81, 320
    s_add_u32 s71, s71, 256
    v_add_u32 v1, s70, v0
    v_mul_u32_u24 v2, 6554, v1
    v_lshrrev_b32 v2, 16, v2
    v_mul_u32_u24 v3, 10, v2
    v_sub_u32 v1, v1, v3
    v_lshlrev_b32 v1, 4, v1
    v_and_b32 v3, 1, v2
    v_lshlrev_b32 v3, 2, v3
    v_bfe_u32 v240, v2, 1, 2
    v_and_b32 v2, 0xfff8, v2
    v_or3_b32 v2, v2, v3, v240
    v_mul_u32_u24 v2, 1280, v2
    v_add3_u32 v23, v1, v2, s72
    v_add_u32 v1, s71, v0
    v_mul_u32_u24 v2, 6554, v1
    v_lshrrev_b32 v2, 16, v2
    v_mul_u32_u24 v3, 10, v2
    v_sub_u32 v1, v1, v3
    v_lshlrev_b32 v1, 4, v1
    v_and_b32 v3, 1, v2
    v_lshlrev_b32 v3, 2, v3
    v_bfe_u32 v240, v2, 1, 2
    v_and_b32 v2, 0xfff8, v2
    v_or3_b32 v2, v2, v3, v240
    v_mul_u32_u24 v2, 1280, v2
    v_add3_u32 v24, v1, v2, s72
    s_sub_u32 s70, s82, 2048
    v_add_u32 v1, s70, v27
    s_add_u32 s70, s70, 18432
    s_mul_i32 s40, s81, 5120
    s_add_u32 s40, s40, 12288
    s_cmp_lt_u32 s81, 2
    s_cselect_b64 s[86:87], -1, 0
    s_cselect_b32 s40, s40, s70
    s_movk_i32 s70, 2560
    s_movk_i32 s71, 25600
    s_cselect_b32 s67, 81920, s70
    s_cselect_b32 s58, 819200, s71
    s_mov_b32 s59, 0x20000
    v_cndmask_b32 v24, v1, v24, s[86:87]
    s_waitcnt lgkmcnt(0)
    s_cmp_eq_u32 s76, 0
    s_cselect_b64 s[4:5], s[4:5], s[6:7]
    s_cmp_lt_u32 s81, 2
    s_cselect_b64 s[56:57], s[36:37], s[4:5]
    s_lshl_b32 s75, s8, 7
    s_add_u32 m0, s82, 0
    s_add_u32 s68, s75, 0
    buffer_load_dwordx4 v22, s[32:35], s68 offen lds
    s_add_u32 m0, s82, 4096
    s_add_u32 s68, s75, 40960
    buffer_load_dwordx4 v22, s[32:35], s68 offen lds
    s_mul_i32 s75, s8, 81920
    s_add_u32 m0, s82, 8192
    s_add_u32 s68, s75, 0
    buffer_load_dwordx4 v23, s[36:39], s68 offen lds
    s_add_u32 m0, s82, 13312
    s_add_u32 s68, s75, 40960
    buffer_load_dwordx4 v23, s[36:39], s68 offen lds
    s_mul_i32 s75, s8, s67
    s_add_u32 m0, s40, 0
    s_add_u32 s68, s75, 0
    buffer_load_dwordx4 v24, s[56:59], s68 offen lds
    s_cmp_eq_u32 s60, 6
    s_cbranch_scc0 Le1_1
    s_add_u32 m0, s40, 2048
    s_add_u32 s68, s75, 2048
    buffer_load_dwordx4 v24, s[56:59], s68 offen lds
Le1_1:
    s_lshl_b32 s75, s9, 7
    s_add_u32 m0, s82, 32768
    s_add_u32 s68, s75, 0
    buffer_load_dwordx4 v22, s[32:35], s68 offen lds
    s_add_u32 m0, s82, 36864
    s_add_u32 s68, s75, 40960
    buffer_load_dwordx4 v22, s[32:35], s68 offen lds
    s_mov_b32 s54, 17825792
    s_mov_b32 s55, 0x20000
    s_mov_b32 s22, 2621440
    s_mov_b32 s23, 0x20000
    s_mov_b32 s26, 2457600
    s_mov_b32 s27, 0x20000
    s_mov_b32 s30, 819200
    s_mov_b32 s31, 0x20000
    s_mov_b32 s46, 819200
    s_mov_b32 s47, 0x20000
    s_mov_b32 s50, 5242880
    s_mov_b32 s51, 0x20000
    s_and_b32 s70, s2, 3
    s_bfe_u32 s71, s2, 0x10002
    s_bfe_u32 s73, s2, 0x20003
    s_lshl_b32 s61, s70, 2
    s_add_u32 s61, s61, s73
    s_lshr_b32 s73, s2, 5
    s_lshl_b32 s62, s71, 3
    s_add_u32 s62, s62, s73
    s_min_u32 s43, s62, 14
    s_and_b32 s77, s64, 1
    s_bfe_u32 s83, s60, 0x10001
    s_lshl_b32 s83, s83, 1
    s_lshr_b32 s70, s60, 2
    s_add_u32 s83, s83, s70
    s_mov_b32 s84, 0
    s_mov_b32 s85, -1
    s_mov_b32 s90, 1051011932
    s_mov_b32 s79, 0
    s_mov_b32 s80, 0x400000
    v_mov_b32 v16, 0xdddddddd
    v_lshrrev_b32 v2, 4, v0
    v_lshlrev_b32 v3, 2, v2
    v_sub_u32 v1, v0, v3
    v_and_b32 v1, 15, v1
    v_lshlrev_b32 v1, 4, v1
    s_lshl_b32 s70, s81, 2
    v_add_u32 v2, s70, v2
    v_mul_u32_u24 v2, 3840, v2
    s_lshl_b32 s72, s43, 8
    v_add3_u32 v25, v2, v1, s72
    s_add_u32 s11, s10, 1
    s_cmp_eq_u32 s11, 10
    s_cselect_b32 s11, 0, s11
    s_add_u32 s12, s11, 1
    s_cmp_eq_u32 s12, 10
    s_cselect_b32 s12, 0, s12
    s_add_u32 s13, s12, 1
    s_cmp_eq_u32 s13, 10
    s_cselect_b32 s13, 0, s13
    s_add_u32 s14, s13, 1
    s_cmp_eq_u32 s14, 10
    s_cselect_b32 s14, 0, s14
    s_add_u32 s15, s14, 1
    s_cmp_eq_u32 s15, 10
    s_cselect_b32 s15, 0, s15
    s_add_u32 s16, s15, 1
    s_cmp_eq_u32 s16, 10
    s_cselect_b32 s16, 0, s16
    s_add_u32 s17, s16, 1
    s_cmp_eq_u32 s17, 10
    s_cselect_b32 s17, 0, s17
    s_lshl_b32 s75, s10, 7
    s_add_u32 m0, s82, 65536
    s_add_u32 s68, s75, 0
    buffer_load_dwordx4 v22, s[32:35], s68 offen lds
    s_add_u32 m0, s82, 69632
    s_add_u32 s68, s75, 40960
    buffer_load_dwordx4 v22, s[32:35], s68 offen lds
    s_mul_i32 s75, s9, 81920
    s_add_u32 m0, s82, 40960
    s_add_u32 s68, s75, 0
    buffer_load_dwordx4 v23, s[36:39], s68 offen lds
    s_add_u32 m0, s82, 46080
    s_add_u32 s68, s75, 40960
    buffer_load_dwordx4 v23, s[36:39], s68 offen lds
    s_mul_i32 s75, s9, s67
    s_add_u32 m0, s40, 32768
    s_add_u32 s68, s75, 0
    buffer_load_dwordx4 v24, s[56:59], s68 offen lds
    s_cmp_eq_u32 s60, 6
    s_cbranch_scc0 Le1_2
    s_add_u32 m0, s40, 34816
    s_add_u32 s68, s75, 2048
    buffer_load_dwordx4 v24, s[56:59], s68 offen lds
Le1_2:
    v_mov_b32 v1, 0
    buffer_load_dword v17, v1, s[52:55], 0 offen sc1
    s_cmp_eq_u32 s60, 7
    s_cbranch_scc0 L_ldB_N
    s_cmp_eq_u32 s76, 0
    s_cbranch_scc0 L_ldB_V
    s_mov_b32 s70, s77
    v_and_b32 v1, 31, v0
    v_bfe_u32 v2, v1, 1, 3
    v_lshrrev_b32 v3, 5, v0
    v_xor_b32 v2, v2, v3
    v_lshlrev_b32 v2, 4, v2
    s_lshl_b32 s70, s70, 12
    v_lshl_add_u32 v1, v1, 7, v2
    v_add_u32 v70, s70, v1
    v_xor_b32 v71, 32, v70
    v_xor_b32 v72, 64, v70
    v_xor_b32 v73, 0x60, v70
    v_bfe_u32 v1, v0, 2, 2
    v_lshrrev_b32 v2, 5, v0
    v_bfe_u32 v3, v0, 4, 1
    v_and_b32 v30, 3, v0
    v_lshl_add_u32 v3, v3, 2, v30
    v_min_u32 v3, 4, v3
    v_lshlrev_b32 v3, 3, v3
    v_lshl_add_u32 v1, v2, 3, v1
    v_mul_u32_u24 v1, 40, v1
    v_add_u32 v1, 18432, v1
    v_add_u32 v74, v1, v3
    s_waitcnt vmcnt(8)
    s_barrier
    ds_read_b128 v[184:187], v70 offset:0
    ds_read_b64_tr_b16 v[188:189], v74 offset:0
    ds_read_b64_tr_b16 v[190:191], v74 offset:160
    ds_read_b128 v[192:195], v71 offset:0
    ds_read_b64_tr_b16 v[196:197], v74 offset:640
    ds_read_b64_tr_b16 v[198:199], v74 offset:800
    ds_read_b128 v[200:203], v72 offset:0
    ds_read_b64_tr_b16 v[204:205], v74 offset:1280
    ds_read_b64_tr_b16 v[206:207], v74 offset:1440
    ds_read_b128 v[208:211], v73 offset:0
    ds_read_b64_tr_b16 v[212:213], v74 offset:1920
    ds_read_b64_tr_b16 v[214:215], v74 offset:2080
    s_mul_i32 s75, s10, 81920
    s_add_u32 m0, s82, 73728
    s_add_u32 s68, s75, 0
    buffer_load_dwordx4 v23, s[36:39], s68 offen lds
    s_waitcnt lgkmcnt(9)
    v_mfma_f32_32x32x16_bf16 v[112:127], v[188:191], v[184:187], 0
    s_add_u32 m0, s82, 78848
    s_add_u32 s68, s75, 40960
    buffer_load_dwordx4 v23, s[36:39], s68 offen lds
    s_waitcnt lgkmcnt(6)
    v_mfma_f32_32x32x16_bf16 v[112:127], v[196:199], v[192:195], v[112:127]
    s_mul_i32 s75, s10, s67
    s_add_u32 m0, s40, 65536
    s_add_u32 s68, s75, 0
    buffer_load_dwordx4 v24, s[56:59], s68 offen lds
    s_waitcnt lgkmcnt(3)
    v_mfma_f32_32x32x16_bf16 v[112:127], v[204:207], v[200:203], v[112:127]
    s_cmp_eq_u32 s60, 6
    s_cbranch_scc0 Le1_3
    s_add_u32 m0, s40, 67584
    s_add_u32 s68, s75, 2048
    buffer_load_dwordx4 v24, s[56:59], s68 offen lds
Le1_3:
    s_waitcnt lgkmcnt(0)
    v_mfma_f32_32x32x16_bf16 v[112:127], v[212:215], v[208:211], v[112:127]
    s_waitcnt vmcnt(4)
    s_barrier
    ds_read_b128 v[184:187], v70 offset:32768
    ds_read_b64_tr_b16 v[188:189], v74 offset:32768
    ds_read_b64_tr_b16 v[190:191], v74 offset:32928
    ds_read_b128 v[192:195], v71 offset:32768
    ds_read_b64_tr_b16 v[196:197], v74 offset:33408
    ds_read_b64_tr_b16 v[198:199], v74 offset:33568
    ds_read_b128 v[200:203], v72 offset:32768
    ds_read_b64_tr_b16 v[204:205], v74 offset:34048
    ds_read_b64_tr_b16 v[206:207], v74 offset:34208
    ds_read_b128 v[208:211], v73 offset:32768
    ds_read_b64_tr_b16 v[212:213], v74 offset:34688
    ds_read_b64_tr_b16 v[214:215], v74 offset:34848
    s_lshl_b32 s75, s11, 7
    s_add_u32 m0, s82, 98304
    s_add_u32 s68, s75, 0
    buffer_load_dwordx4 v22, s[32:35], s68 offen lds
    s_waitcnt lgkmcnt(9)
    v_mfma_f32_32x32x16_bf16 v[112:127], v[188:191], v[184:187], v[112:127]
    s_add_u32 m0, s82, 102400
    s_add_u32 s68, s75, 40960
    buffer_load_dwordx4 v22, s[32:35], s68 offen lds
    s_waitcnt lgkmcnt(6)
    v_mfma_f32_32x32x16_bf16 v[112:127], v[196:199], v[192:195], v[112:127]
    s_mul_i32 s75, s11, 81920
    s_add_u32 m0, s82, 106496
    s_add_u32 s68, s75, 0
    buffer_load_dwordx4 v23, s[36:39], s68 offen lds
    s_waitcnt lgkmcnt(3)
    v_mfma_f32_32x32x16_bf16 v[112:127], v[204:207], v[200:203], v[112:127]
    s_add_u32 m0, s82, 111616
    s_add_u32 s68, s75, 40960
    buffer_load_dwordx4 v23, s[36:39], s68 offen lds
    s_waitcnt lgkmcnt(0)
    v_mfma_f32_32x32x16_bf16 v[112:127], v[212:215], v[208:211], v[112:127]
    s_mul_i32 s75, s11, s67
    s_add_u32 m0, s40, 98304
    s_add_u32 s68, s75, 0
    buffer_load_dwordx4 v24, s[56:59], s68 offen lds
    s_cmp_eq_u32 s60, 6
    s_cbranch_scc0 Le1_4
    s_add_u32 m0, s40, 100352
    s_add_u32 s68, s75, 2048
    buffer_load_dwordx4 v24, s[56:59], s68 offen lds
Le1_4:
    s_waitcnt vmcnt(5)
    s_barrier
    v_add_u32 v70, 0x10000, v70
    ds_read_b128 v[184:187], v70 offset:0
    v_add_u32 v74, 0x10000, v74
    ds_read_b64_tr_b16 v[188:189], v74 offset:0
    ds_read_b64_tr_b16 v[190:191], v74 offset:160
    v_add_u32 v71, 0x10000, v71
    ds_read_b128 v[192:195], v71 offset:0
    ds_read_b64_tr_b16 v[196:197], v74 offset:640
    ds_read_b64_tr_b16 v[198:199], v74 offset:800
    v_add_u32 v72, 0x10000, v72
    ds_read_b128 v[200:203], v72 offset:0
    ds_read_b64_tr_b16 v[204:205], v74 offset:1280
    ds_read_b64_tr_b16 v[206:207], v74 offset:1440
    v_add_u32 v73, 0x10000, v73
    ds_read_b128 v[208:211], v73 offset:0
    ds_read_b64_tr_b16 v[212:213], v74 offset:1920
    ds_read_b64_tr_b16 v[214:215], v74 offset:2080
    s_lshl_b32 s75, s12, 7
    s_add_u32 m0, s82, 131072
    s_add_u32 s68, s75, 0
    buffer_load_dwordx4 v22, s[32:35], s68 offen lds
    s_waitcnt lgkmcnt(9)
    v_mfma_f32_32x32x16_bf16 v[112:127], v[188:191], v[184:187], v[112:127]
    s_add_u32 m0, s82, 135168
    s_add_u32 s68, s75, 40960
    buffer_load_dwordx4 v22, s[32:35], s68 offen lds
    s_waitcnt lgkmcnt(6)
    v_mfma_f32_32x32x16_bf16 v[112:127], v[196:199], v[192:195], v[112:127]
    s_mul_i32 s75, s12, 81920
    s_add_u32 m0, s82, 139264
    s_add_u32 s68, s75, 0
    buffer_load_dwordx4 v23, s[36:39], s68 offen lds
    s_waitcnt lgkmcnt(3)
    v_mfma_f32_32x32x16_bf16 v[112:127], v[204:207], v[200:203], v[112:127]
    s_add_u32 m0, s82, 144384
    s_add_u32 s68, s75, 40960
    buffer_load_dwordx4 v23, s[36:39], s68 offen lds
    s_waitcnt lgkmcnt(0)
    v_mfma_f32_32x32x16_bf16 v[112:127], v[212:215], v[208:211], v[112:127]
    s_mul_i32 s75, s12, s67
    s_add_u32 m0, s40, 131072
    s_add_u32 s68, s75, 0
    buffer_load_dwordx4 v24, s[56:59], s68 offen lds
    s_cmp_eq_u32 s60, 6
    s_cbranch_scc0 Le1_5
    s_add_u32 m0, s40, 133120
    s_add_u32 s68, s75, 2048
    buffer_load_dwordx4 v24, s[56:59], s68 offen lds
Le1_5:
    v_add_u32 v17, 0x9e3779b9, v17
    s_waitcnt vmcnt(5)
    s_barrier
    ds_read_b128 v[184:187], v70 offset:32768
    ds_read_b64_tr_b16 v[188:189], v74 offset:32768
    ds_read_b64_tr_b16 v[190:191], v74 offset:32928
    ds_read_b128 v[192:195], v71 offset:32768
    ds_read_b64_tr_b16 v[196:197], v74 offset:33408
    ds_read_b64_tr_b16 v[198:199], v74 offset:33568
    ds_read_b128 v[200:203], v72 offset:32768
    ds_read_b64_tr_b16 v[204:205], v74 offset:34048
    ds_read_b64_tr_b16 v[206:207], v74 offset:34208
    ds_read_b128 v[208:211], v73 offset:32768
    ds_read_b64_tr_b16 v[212:213], v74 offset:34688
    ds_read_b64_tr_b16 v[214:215], v74 offset:34848
    s_lshl_b32 s75, s13, 7
    s_add_u32 m0, s82, 0
    s_add_u32 s68, s75, 0
    buffer_load_dwordx4 v22, s[32:35], s68 offen lds
    s_waitcnt lgkmcnt(9)
    v_mfma_f32_32x32x16_bf16 v[112:127], v[188:191], v[184:187], v[112:127]
    s_add_u32 m0, s82, 4096
    s_add_u32 s68, s75, 40960
    buffer_load_dwordx4 v22, s[32:35], s68 offen lds
    s_waitcnt lgkmcnt(6)
    v_mfma_f32_32x32x16_bf16 v[112:127], v[196:199], v[192:195], v[112:127]
    s_mul_i32 s75, s13, 81920
    s_add_u32 m0, s82, 8192
    s_add_u32 s68, s75, 0
    buffer_load_dwordx4 v23, s[36:39], s68 offen lds
    s_waitcnt lgkmcnt(3)
    v_mfma_f32_32x32x16_bf16 v[112:127], v[204:207], v[200:203], v[112:127]
    s_add_u32 m0, s82, 13312
    s_add_u32 s68, s75, 40960
    buffer_load_dwordx4 v23, s[36:39], s68 offen lds
    s_waitcnt lgkmcnt(0)
    v_mfma_f32_32x32x16_bf16 v[112:127], v[212:215], v[208:211], v[112:127]
    s_mul_i32 s75, s13, s67
    s_add_u32 m0, s40, 0
    s_add_u32 s68, s75, 0
    buffer_load_dwordx4 v24, s[56:59], s68 offen lds
    s_cmp_eq_u32 s60, 6
    s_cbranch_scc0 Le1_6
    s_add_u32 m0, s40, 2048
    s_add_u32 s68, s75, 2048
    buffer_load_dwordx4 v24, s[56:59], s68 offen lds
Le1_6:
    s_waitcnt vmcnt(5)
    s_barrier
    v_add_u32 v70, 0x10000, v70
    ds_read_b128 v[184:187], v70 offset:0
    v_add_u32 v74, 0x10000, v74
    ds_read_b64_tr_b16 v[188:189], v74 offset:0
    ds_read_b64_tr_b16 v[190:191], v74 offset:160
    v_add_u32 v71, 0x10000, v71
    ds_read_b128 v[192:195], v71 offset:0
    ds_read_b64_tr_b16 v[196:197], v74 offset:640
    ds_read_b64_tr_b16 v[198:199], v74 offset:800
    v_add_u32 v72, 0x10000, v72
    ds_read_b128 v[200:203], v72 offset:0
    ds_read_b64_tr_b16 v[204:205], v74 offset:1280
    ds_read_b64_tr_b16 v[206:207], v74 offset:1440
    v_add_u32 v73, 0x10000, v73
    ds_read_b128 v[208:211], v73 offset:0
    ds_read_b64_tr_b16 v[212:213], v74 offset:1920
    ds_read_b64_tr_b16 v[214:215], v74 offset:2080
    s_lshl_b32 s75, s14, 7
    s_add_u32 m0, s82, 32768
    s_add_u32 s68, s75, 0
    buffer_load_dwordx4 v22, s[32:35], s68 offen lds
    s_waitcnt lgkmcnt(9)
    v_mfma_f32_32x32x16_bf16 v[112:127], v[188:191], v[184:187], v[112:127]
    s_add_u32 m0, s82, 36864
    s_add_u32 s68, s75, 40960
    buffer_load_dwordx4 v22, s[32:35], s68 offen lds
    s_waitcnt lgkmcnt(6)
    v_mfma_f32_32x32x16_bf16 v[112:127], v[196:199], v[192:195], v[112:127]
    s_mul_i32 s75, s14, 81920
    s_add_u32 m0, s82, 40960
    s_add_u32 s68, s75, 0
    buffer_load_dwordx4 v23, s[36:39], s68 offen lds
    s_waitcnt lgkmcnt(3)
    v_mfma_f32_32x32x16_bf16 v[112:127], v[204:207], v[200:203], v[112:127]
    s_add_u32 m0, s82, 46080
    s_add_u32 s68, s75, 40960
    buffer_load_dwordx4 v23, s[36:39], s68 offen lds
    s_waitcnt lgkmcnt(0)
    v_mfma_f32_32x32x16_bf16 v[112:127], v[212:215], v[208:211], v[112:127]
    s_mul_i32 s75, s14, s67
    s_add_u32 m0, s40, 32768
    s_add_u32 s68, s75, 0
    buffer_load_dwordx4 v24, s[56:59], s68 offen lds
    s_cmp_eq_u32 s60, 6
    s_cbranch_scc0 Le1_7
    s_add_u32 m0, s40, 34816
    s_add_u32 s68, s75, 2048
    buffer_load_dwordx4 v24, s[56:59], s68 offen lds
Le1_7:
    s_waitcnt vmcnt(5)
    s_barrier
    v_add_u32 v70, 0xfffe0000, v70
    ds_read_b128 v[184:187], v70 offset:0
    v_add_u32 v74, 0xfffe0000, v74
    ds_read_b64_tr_b16 v[188:189], v74 offset:0
    ds_read_b64_tr_b16 v[190:191], v74 offset:160
    v_add_u32 v71, 0xfffe0000, v71
    ds_read_b128 v[192:195], v71 offset:0
    ds_read_b64_tr_b16 v[196:197], v74 offset:640
    ds_read_b64_tr_b16 v[198:199], v74 offset:800
    v_add_u32 v72, 0xfffe0000, v72
    ds_read_b128 v[200:203], v72 offset:0
    ds_read_b64_tr_b16 v[204:205], v74 offset:1280
    ds_read_b64_tr_b16 v[206:207], v74 offset:1440
    v_add_u32 v73, 0xfffe0000, v73
    ds_read_b128 v[208:211], v73 offset:0
    ds_read_b64_tr_b16 v[212:213], v74 offset:1920
    ds_read_b64_tr_b16 v[214:215], v74 offset:2080
    s_lshl_b32 s75, s15, 7
    s_add_u32 m0, s82, 65536
    s_add_u32 s68, s75, 0
    buffer_load_dwordx4 v22, s[32:35], s68 offen lds
    s_waitcnt lgkmcnt(9)
    v_mfma_f32_32x32x16_bf16 v[112:127], v[188:191], v[184:187], v[112:127]
    s_add_u32 m0, s82, 69632
    s_add_u32 s68, s75, 40960
    buffer_load_dwordx4 v22, s[32:35], s68 offen lds
    s_waitcnt lgkmcnt(6)
    v_mfma_f32_32x32x16_bf16 v[112:127], v[196:199], v[192:195], v[112:127]
    s_mul_i32 s75, s15, 81920
    s_add_u32 m0, s82, 73728
    s_add_u32 s68, s75, 0
    buffer_load_dwordx4 v23, s[36:39], s68 offen lds
    s_waitcnt lgkmcnt(3)
    v_mfma_f32_32x32x16_bf16 v[112:127], v[204:207], v[200:203], v[112:127]
    s_add_u32 m0, s82, 78848
    s_add_u32 s68, s75, 40960
    buffer_load_dwordx4 v23, s[36:39], s68 offen lds
    s_waitcnt lgkmcnt(0)
    v_mfma_f32_32x32x16_bf16 v[112:127], v[212:215], v[208:211], v[112:127]
    s_mul_i32 s75, s15, s67
    s_add_u32 m0, s40, 65536
    s_add_u32 s68, s75, 0
    buffer_load_dwordx4 v24, s[56:59], s68 offen lds
    s_cmp_eq_u32 s60, 6
    s_cbranch_scc0 Le1_8
    s_add_u32 m0, s40, 67584
    s_add_u32 s68, s75, 2048
    buffer_load_dwordx4 v24, s[56:59], s68 offen lds
Le1_8:
    s_waitcnt vmcnt(5)
    s_barrier
    ds_read_b128 v[184:187], v70 offset:32768
    ds_read_b64_tr_b16 v[188:189], v74 offset:32768
    ds_read_b64_tr_b16 v[190:191], v74 offset:32928
    ds_read_b128 v[192:195], v71 offset:32768
    ds_read_b64_tr_b16 v[196:197], v74 offset:33408
    ds_read_b64_tr_b16 v[198:199], v74 offset:33568
    ds_read_b128 v[200:203], v72 offset:32768
    ds_read_b64_tr_b16 v[204:205], v74 offset:34048
    ds_read_b64_tr_b16 v[206:207], v74 offset:34208
    ds_read_b128 v[208:211], v73 offset:32768
    ds_read_b64_tr_b16 v[212:213], v74 offset:34688
    ds_read_b64_tr_b16 v[214:215], v74 offset:34848
    s_lshl_b32 s75, s16, 7
    s_add_u32 m0, s82, 98304
    s_add_u32 s68, s75, 0
    buffer_load_dwordx4 v22, s[32:35], s68 offen lds
    s_waitcnt lgkmcnt(9)
    v_mfma_f32_32x32x16_bf16 v[112:127], v[188:191], v[184:187], v[112:127]
    s_add_u32 m0, s82, 102400
    s_add_u32 s68, s75, 40960
    buffer_load_dwordx4 v22, s[32:35], s68 offen lds
    s_waitcnt lgkmcnt(6)
    v_mfma_f32_32x32x16_bf16 v[112:127], v[196:199], v[192:195], v[112:127]
    s_mul_i32 s75, s16, 81920
    s_add_u32 m0, s82, 106496
    s_add_u32 s68, s75, 0
    buffer_load_dwordx4 v23, s[36:39], s68 offen lds
    s_waitcnt lgkmcnt(3)
    v_mfma_f32_32x32x16_bf16 v[112:127], v[204:207], v[200:203], v[112:127]
    s_add_u32 m0, s82, 111616
    s_add_u32 s68, s75, 40960
    buffer_load_dwordx4 v23, s[36:39], s68 offen lds
    s_waitcnt lgkmcnt(0)
    v_mfma_f32_32x32x16_bf16 v[112:127], v[212:215], v[208:211], v[112:127]
    s_mul_i32 s75, s16, s67
    s_add_u32 m0, s40, 98304
    s_add_u32 s68, s75, 0
    buffer_load_dwordx4 v24, s[56:59], s68 offen lds
    s_cmp_eq_u32 s60, 6
    s_cbranch_scc0 Le1_9
    s_add_u32 m0, s40, 100352
    s_add_u32 s68, s75, 2048
    buffer_load_dwordx4 v24, s[56:59], s68 offen lds
Le1_9:
    s_waitcnt vmcnt(5)
    s_barrier
    v_add_u32 v70, 0x10000, v70
    ds_read_b128 v[184:187], v70 offset:0
    v_add_u32 v74, 0x10000, v74
    ds_read_b64_tr_b16 v[188:189], v74 offset:0
    ds_read_b64_tr_b16 v[190:191], v74 offset:160
    v_add_u32 v71, 0x10000, v71
    ds_read_b128 v[192:195], v71 offset:0
    ds_read_b64_tr_b16 v[196:197], v74 offset:640
    ds_read_b64_tr_b16 v[198:199], v74 offset:800
    v_add_u32 v72, 0x10000, v72
    ds_read_b128 v[200:203], v72 offset:0
    ds_read_b64_tr_b16 v[204:205], v74 offset:1280
    ds_read_b64_tr_b16 v[206:207], v74 offset:1440
    v_add_u32 v73, 0x10000, v73
    ds_read_b128 v[208:211], v73 offset:0
    ds_read_b64_tr_b16 v[212:213], v74 offset:1920
    ds_read_b64_tr_b16 v[214:215], v74 offset:2080
    s_lshl_b32 s75, s17, 7
    s_add_u32 m0, s82, 131072
    s_add_u32 s68, s75, 0
    buffer_load_dwordx4 v22, s[32:35], s68 offen lds
    s_waitcnt lgkmcnt(9)
    v_mfma_f32_32x32x16_bf16 v[112:127], v[188:191], v[184:187], v[112:127]
    s_add_u32 m0, s82, 135168
    s_add_u32 s68, s75, 40960
    buffer_load_dwordx4 v22, s[32:35], s68 offen lds
    s_waitcnt lgkmcnt(6)
    v_mfma_f32_32x32x16_bf16 v[112:127], v[196:199], v[192:195], v[112:127]
    s_mul_i32 s75, s17, 81920
    s_add_u32 m0, s82, 139264
    s_add_u32 s68, s75, 0
    buffer_load_dwordx4 v23, s[36:39], s68 offen lds
    s_waitcnt lgkmcnt(3)
    v_mfma_f32_32x32x16_bf16 v[112:127], v[204:207], v[200:203], v[112:127]
    s_add_u32 m0, s82, 144384
    s_add_u32 s68, s75, 40960
    buffer_load_dwordx4 v23, s[36:39], s68 offen lds
    s_waitcnt lgkmcnt(0)
    v_mfma_f32_32x32x16_bf16 v[112:127], v[212:215], v[208:211], v[112:127]
    s_mul_i32 s75, s17, s67
    s_add_u32 m0, s40, 131072
    s_add_u32 s68, s75, 0
    buffer_load_dwordx4 v24, s[56:59], s68 offen lds
    s_cmp_eq_u32 s60, 6
    s_cbranch_scc0 Le1_10
    s_add_u32 m0, s40, 133120
    s_add_u32 s68, s75, 2048
    buffer_load_dwordx4 v24, s[56:59], s68 offen lds
Le1_10:
    s_lshl_b32 s70, s61, 1
    s_sub_u32 s70, s70, s63
    s_mul_i32 s70, s70, 81920
    v_add_u32 v22, s70, v22
    s_and_b32 s70, s62, 7
    s_mul_i32 s72, s70, 5
    s_lshr_b32 s72, s72, 2
    s_and_b32 s8, s61, 3
    s_mul_i32 s8, s8, 5
    s_lshr_b32 s8, s8, 1
    s_add_u32 s8, s8, s72
    s_sub_u32 s72, s8, 10
    s_cselect_b32 s8, s8, s72
    s_add_u32 s9, s8, 1
    s_cmp_eq_u32 s9, 10
    s_cselect_b32 s9, 0, s9
    s_add_u32 s10, s9, 1
    s_cmp_eq_u32 s10, 10
    s_cselect_b32 s10, 0, s10
    s_add_u32 s11, s10, 1
    s_cmp_eq_u32 s11, 10
    s_cselect_b32 s11, 0, s11
    s_add_u32 s12, s11, 1
    s_cmp_eq_u32 s12, 10
    s_cselect_b32 s12, 0, s12
    s_add_u32 s13, s12, 1
    s_cmp_eq_u32 s13, 10
    s_cselect_b32 s13, 0, s13
    s_add_u32 s14, s13, 1
    s_cmp_eq_u32 s14, 10
    s_cselect_b32 s14, 0, s14
    s_add_u32 s15, s14, 1
    s_cmp_eq_u32 s15, 10
    s_cselect_b32 s15, 0, s15
    s_add_u32 s16, s15, 1
    s_cmp_eq_u32 s16, 10
    s_cselect_b32 s16, 0, s16
    s_add_u32 s17, s16, 1
    s_cmp_eq_u32 s17, 10
    s_cselect_b32 s17, 0, s17
    s_mul_i32 s75, s8, 245760
    s_add_u32 m0, s82, 16384
    s_add_u32 s68, s75, 0
    buffer_load_dwordx4 v25, s[24:27], s68 offen lds
    s_add_u32 m0, s82, 20480
    s_add_u32 s68, s75, 61440
    buffer_load_dwordx4 v25, s[24:27], s68 offen lds
    s_add_u32 m0, s82, 24576
    s_add_u32 s68, s75, 122880
    buffer_load_dwordx4 v25, s[24:27], s68 offen lds
    s_add_u32 m0, s82, 28672
    s_add_u32 s68, s75, 184320
    buffer_load_dwordx4 v25, s[24:27], s68 offen lds
    s_lshl_b32 s75, s8, 7
    s_add_u32 m0, s82, 0
    s_add_u32 s68, s75, 0
    buffer_load_dwordx4 v22, s[20:23], s68 offen lds
    s_add_u32 m0, s82, 4096
    s_add_u32 s68, s75, 40960
    buffer_load_dwordx4 v22, s[20:23], s68 offen lds
    s_add_u32 m0, s82, 8192
    s_add_u32 s68, s75, 81920
    buffer_load_dwordx4 v22, s[20:23], s68 offen lds
    s_add_u32 m0, s82, 12288
    s_add_u32 s68, s75, 122880
    buffer_load_dwordx4 v22, s[20:23], s68 offen lds
    s_waitcnt vmcnt(13)
    s_barrier
    ds_read_b128 v[184:187], v70 offset:32768
    ds_read_b64_tr_b16 v[188:189], v74 offset:32768
    ds_read_b64_tr_b16 v[190:191], v74 offset:32928
    ds_read_b128 v[192:195], v71 offset:32768
    ds_read_b64_tr_b16 v[196:197], v74 offset:33408
    ds_read_b64_tr_b16 v[198:199], v74 offset:33568
    ds_read_b128 v[200:203], v72 offset:32768
    ds_read_b64_tr_b16 v[204:205], v74 offset:34048
    ds_read_b64_tr_b16 v[206:207], v74 offset:34208
    ds_read_b128 v[208:211], v73 offset:32768
    ds_read_b64_tr_b16 v[212:213], v74 offset:34688
    ds_read_b64_tr_b16 v[214:215], v74 offset:34848
    s_mul_i32 s75, s9, 245760
    s_add_u32 m0, s82, 49152
    s_add_u32 s68, s75, 0
    buffer_load_dwordx4 v25, s[24:27], s68 offen lds
    s_waitcnt lgkmcnt(9)
    v_mfma_f32_32x32x16_bf16 v[112:127], v[188:191], v[184:187], v[112:127]
    s_add_u32 m0, s82, 53248
    s_add_u32 s68, s75, 61440
    buffer_load_dwordx4 v25, s[24:27], s68 offen lds
    s_waitcnt lgkmcnt(6)
    v_mfma_f32_32x32x16_bf16 v[112:127], v[196:199], v[192:195], v[112:127]
    s_add_u32 m0, s82, 57344
    s_add_u32 s68, s75, 122880
    buffer_load_dwordx4 v25, s[24:27], s68 offen lds
    s_waitcnt lgkmcnt(3)
    v_mfma_f32_32x32x16_bf16 v[112:127], v[204:207], v[200:203], v[112:127]
    s_add_u32 m0, s82, 61440
    s_add_u32 s68, s75, 184320
    buffer_load_dwordx4 v25, s[24:27], s68 offen lds
    s_waitcnt lgkmcnt(0)
    v_mfma_f32_32x32x16_bf16 v[112:127], v[212:215], v[208:211], v[112:127]
    s_waitcnt vmcnt(12)
    s_barrier
    v_add_u32 v70, 0x10000, v70
    ds_read_b128 v[184:187], v70 offset:0
    v_add_u32 v74, 0x10000, v74
    ds_read_b64_tr_b16 v[188:189], v74 offset:0
    ds_read_b64_tr_b16 v[190:191], v74 offset:160
    v_add_u32 v71, 0x10000, v71
    ds_read_b128 v[192:195], v71 offset:0
    ds_read_b64_tr_b16 v[196:197], v74 offset:640
    ds_read_b64_tr_b16 v[198:199], v74 offset:800
    v_add_u32 v72, 0x10000, v72
    ds_read_b128 v[200:203], v72 offset:0
    ds_read_b64_tr_b16 v[204:205], v74 offset:1280
    ds_read_b64_tr_b16 v[206:207], v74 offset:1440
    v_add_u32 v73, 0x10000, v73
    ds_read_b128 v[208:211], v73 offset:0
    ds_read_b64_tr_b16 v[212:213], v74 offset:1920
    ds_read_b64_tr_b16 v[214:215], v74 offset:2080
    s_mul_i32 s75, s10, 245760
    s_add_u32 m0, s82, 81920
    s_add_u32 s68, s75, 0
    buffer_load_dwordx4 v25, s[24:27], s68 offen lds
    s_waitcnt lgkmcnt(9)
    v_mfma_f32_32x32x16_bf16 v[112:127], v[188:191], v[184:187], v[112:127]
    s_add_u32 m0, s82, 86016
    s_add_u32 s68, s75, 61440
    buffer_load_dwordx4 v25, s[24:27], s68 offen lds
    s_waitcnt lgkmcnt(6)
    v_mfma_f32_32x32x16_bf16 v[112:127], v[196:199], v[192:195], v[112:127]
    s_add_u32 m0, s82, 90112
    s_add_u32 s68, s75, 122880
    buffer_load_dwordx4 v25, s[24:27], s68 offen lds
    s_waitcnt lgkmcnt(3)
    v_mfma_f32_32x32x16_bf16 v[112:127], v[204:207], v[200:203], v[112:127]
    s_add_u32 m0, s82, 94208
    s_add_u32 s68, s75, 184320
    buffer_load_dwordx4 v25, s[24:27], s68 offen lds
    s_waitcnt lgkmcnt(0)
    v_mfma_f32_32x32x16_bf16 v[112:127], v[212:215], v[208:211], v[112:127]
    s_lshl_b32 s75, s9, 7
    s_add_u32 m0, s82, 32768
    s_add_u32 s68, s75, 0
    buffer_load_dwordx4 v22, s[20:23], s68 offen lds
    s_add_u32 m0, s82, 36864
    s_add_u32 s68, s75, 40960
    buffer_load_dwordx4 v22, s[20:23], s68 offen lds
    s_add_u32 m0, s82, 40960
    s_add_u32 s68, s75, 81920
    buffer_load_dwordx4 v22, s[20:23], s68 offen lds
    s_add_u32 m0, s82, 45056
    s_add_u32 s68, s75, 122880
    buffer_load_dwordx4 v22, s[20:23], s68 offen lds
    s_mul_i32 s70, s63, 5376
    s_add_u32 s70, s70, 131072
    s_lshl_b32 s71, s77, 10
    s_add_u32 s71, s71, s70
    v_add_u32 v1, s71, v27
    s_lshl_b32 s71, s77, 8
    s_add_u32 s71, s71, s70
    s_add_u32 s71, s71, 2048
    v_and_b32 v2, 31, v0
    v_lshlrev_b32 v2, 3, v2
    v_add_u32 v2, s71, v2
    s_nop 0
    v_cvt_pk_bf16_f32 v232, v112, v113
    v_cvt_pk_bf16_f32 v233, v114, v115
    v_cvt_pk_bf16_f32 v234, v116, v117
    v_cvt_pk_bf16_f32 v235, v118, v119
    v_cvt_pk_bf16_f32 v236, v120, v121
    v_cvt_pk_bf16_f32 v237, v122, v123
    buffer_store_dwordx4 v[232:235], v1, s[52:55], 0 offen sc1
    buffer_store_dwordx2 v[236:237], v2, s[52:55], 0 offen sc1
    s_branch L_ldA
L_ldB_V:
    s_mov_b32 s70, s77
    v_and_b32 v1, 31, v0
    v_bfe_u32 v2, v1, 2, 1
    v_bfe_u32 v3, v1, 3, 1
    v_and_b32 v1, 0x13, v1
    v_lshl_or_b32 v1, v2, 3, v1
    v_lshl_or_b32 v1, v3, 2, v1
    v_bfe_u32 v2, v1, 1, 3
    v_lshrrev_b32 v3, 5, v0
    v_xor_b32 v2, v2, v3
    v_lshlrev_b32 v2, 4, v2
    s_lshl_b32 s70, s70, 12
    v_lshl_add_u32 v1, v1, 7, v2
    v_add_u32 v70, s70, v1
    v_xor_b32 v71, 32, v70
    v_xor_b32 v72, 64, v70
    v_xor_b32 v73, 0x60, v70
    v_bfe_u32 v1, v0, 2, 2
    v_lshrrev_b32 v2, 5, v0
    v_bfe_u32 v3, v0, 4, 1
    v_and_b32 v30, 3, v0
    v_lshl_add_u32 v3, v3, 2, v30
    v_min_u32 v3, 4, v3
    v_lshlrev_b32 v3, 3, v3
    v_lshl_add_u32 v1, v2, 3, v1
    v_mul_u32_u24 v1, 40, v1
    v_add_u32 v1, 18432, v1
    v_add_u32 v74, v1, v3
    s_waitcnt vmcnt(8)
    s_barrier
    ds_read_b128 v[184:187], v70 offset:0
    ds_read_b64_tr_b16 v[188:189], v74 offset:0
    ds_read_b64_tr_b16 v[190:191], v74 offset:160
    ds_read_b128 v[192:195], v71 offset:0
    ds_read_b64_tr_b16 v[196:197], v74 offset:640
    ds_read_b64_tr_b16 v[198:199], v74 offset:800
    ds_read_b128 v[200:203], v72 offset:0
    ds_read_b64_tr_b16 v[204:205], v74 offset:1280
    ds_read_b64_tr_b16 v[206:207], v74 offset:1440
    ds_read_b128 v[208:211], v73 offset:0
    ds_read_b64_tr_b16 v[212:213], v74 offset:1920
    ds_read_b64_tr_b16 v[214:215], v74 offset:2080
    s_mul_i32 s75, s10, 81920
    s_add_u32 m0, s82, 73728
    s_add_u32 s68, s75, 0
    buffer_load_dwordx4 v23, s[36:39], s68 offen lds
    s_waitcnt lgkmcnt(9)
    v_mfma_f32_32x32x16_bf16 v[112:127], v[184:187], v[188:191], 0
    s_add_u32 m0, s82, 78848
    s_add_u32 s68, s75, 40960
    buffer_load_dwordx4 v23, s[36:39], s68 offen lds
    s_waitcnt lgkmcnt(6)
    v_mfma_f32_32x32x16_bf16 v[112:127], v[192:195], v[196:199], v[112:127]
    s_mul_i32 s75, s10, s67
    s_add_u32 m0, s40, 65536
    s_add_u32 s68, s75, 0
    buffer_load_dwordx4 v24, s[56:59], s68 offen lds
    s_waitcnt lgkmcnt(3)
    v_mfma_f32_32x32x16_bf16 v[112:127], v[200:203], v[204:207], v[112:127]
    s_cmp_eq_u32 s60, 6
    s_cbranch_scc0 Le1_11
    s_add_u32 m0, s40, 67584
    s_add_u32 s68, s75, 2048
    buffer_load_dwordx4 v24, s[56:59], s68 offen lds
Le1_11:
    s_waitcnt lgkmcnt(0)
    v_mfma_f32_32x32x16_bf16 v[112:127], v[208:211], v[212:215], v[112:127]
    s_waitcnt vmcnt(4)
    s_barrier
    ds_read_b128 v[184:187], v70 offset:32768
    ds_read_b64_tr_b16 v[188:189], v74 offset:32768
    ds_read_b64_tr_b16 v[190:191], v74 offset:32928
    ds_read_b128 v[192:195], v71 offset:32768
    ds_read_b64_tr_b16 v[196:197], v74 offset:33408
    ds_read_b64_tr_b16 v[198:199], v74 offset:33568
    ds_read_b128 v[200:203], v72 offset:32768
    ds_read_b64_tr_b16 v[204:205], v74 offset:34048
    ds_read_b64_tr_b16 v[206:207], v74 offset:34208
    ds_read_b128 v[208:211], v73 offset:32768
    ds_read_b64_tr_b16 v[212:213], v74 offset:34688
    ds_read_b64_tr_b16 v[214:215], v74 offset:34848
    s_lshl_b32 s75, s11, 7
    s_add_u32 m0, s82, 98304
    s_add_u32 s68, s75, 0
    buffer_load_dwordx4 v22, s[32:35], s68 offen lds
    s_waitcnt lgkmcnt(9)
    v_mfma_f32_32x32x16_bf16 v[112:127], v[184:187], v[188:191], v[112:127]
    s_add_u32 m0, s82, 102400
    s_add_u32 s68, s75, 40960
    buffer_load_dwordx4 v22, s[32:35], s68 offen lds
    s_waitcnt lgkmcnt(6)
    v_mfma_f32_32x32x16_bf16 v[112:127], v[192:195], v[196:199], v[112:127]
    s_mul_i32 s75, s11, 81920
    s_add_u32 m0, s82, 106496
    s_add_u32 s68, s75, 0
    buffer_load_dwordx4 v23, s[36:39], s68 offen lds
    s_waitcnt lgkmcnt(3)
    v_mfma_f32_32x32x16_bf16 v[112:127], v[200:203], v[204:207], v[112:127]
    s_add_u32 m0, s82, 111616
    s_add_u32 s68, s75, 40960
    buffer_load_dwordx4 v23, s[36:39], s68 offen lds
    s_waitcnt lgkmcnt(0)
    v_mfma_f32_32x32x16_bf16 v[112:127], v[208:211], v[212:215], v[112:127]
    s_mul_i32 s75, s11, s67
    s_add_u32 m0, s40, 98304
    s_add_u32 s68, s75, 0
    buffer_load_dwordx4 v24, s[56:59], s68 offen lds
    s_cmp_eq_u32 s60, 6
    s_cbranch_scc0 Le1_12
    s_add_u32 m0, s40, 100352
    s_add_u32 s68, s75, 2048
    buffer_load_dwordx4 v24, s[56:59], s68 offen lds
Le1_12:
    s_waitcnt vmcnt(5)
    s_barrier
    v_add_u32 v70, 0x10000, v70
    ds_read_b128 v[184:187], v70 offset:0
    v_add_u32 v74, 0x10000, v74
    ds_read_b64_tr_b16 v[188:189], v74 offset:0
    ds_read_b64_tr_b16 v[190:191], v74 offset:160
    v_add_u32 v71, 0x10000, v71
    ds_read_b128 v[192:195], v71 offset:0
    ds_read_b64_tr_b16 v[196:197], v74 offset:640
    ds_read_b64_tr_b16 v[198:199], v74 offset:800
    v_add_u32 v72, 0x10000, v72
    ds_read_b128 v[200:203], v72 offset:0
    ds_read_b64_tr_b16 v[204:205], v74 offset:1280
    ds_read_b64_tr_b16 v[206:207], v74 offset:1440
    v_add_u32 v73, 0x10000, v73
    ds_read_b128 v[208:211], v73 offset:0
    ds_read_b64_tr_b16 v[212:213], v74 offset:1920
    ds_read_b64_tr_b16 v[214:215], v74 offset:2080
    s_lshl_b32 s75, s12, 7
    s_add_u32 m0, s82, 131072
    s_add_u32 s68, s75, 0
    buffer_load_dwordx4 v22, s[32:35], s68 offen lds
    s_waitcnt lgkmcnt(9)
    v_mfma_f32_32x32x16_bf16 v[112:127], v[184:187], v[188:191], v[112:127]
    s_add_u32 m0, s82, 135168
    s_add_u32 s68, s75, 40960
    buffer_load_dwordx4 v22, s[32:35], s68 offen lds
    s_waitcnt lgkmcnt(6)
    v_mfma_f32_32x32x16_bf16 v[112:127], v[192:195], v[196:199], v[112:127]
    s_mul_i32 s75, s12, 81920
    s_add_u32 m0, s82, 139264
    s_add_u32 s68, s75, 0
    buffer_load_dwordx4 v23, s[36:39], s68 offen lds
    s_waitcnt lgkmcnt(3)
    v_mfma_f32_32x32x16_bf16 v[112:127], v[200:203], v[204:207], v[112:127]
    s_add_u32 m0, s82, 144384
    s_add_u32 s68, s75, 40960
    buffer_load_dwordx4 v23, s[36:39], s68 offen lds
    s_waitcnt lgkmcnt(0)
    v_mfma_f32_32x32x16_bf16 v[112:127], v[208:211], v[212:215], v[112:127]
    s_mul_i32 s75, s12, s67
    s_add_u32 m0, s40, 131072
    s_add_u32 s68, s75, 0
    buffer_load_dwordx4 v24, s[56:59], s68 offen lds
    s_cmp_eq_u32 s60, 6
    s_cbranch_scc0 Le1_13
    s_add_u32 m0, s40, 133120
    s_add_u32 s68, s75, 2048
    buffer_load_dwordx4 v24, s[56:59], s68 offen lds
Le1_13:
    v_add_u32 v17, 0x9e3779b9, v17
    s_waitcnt vmcnt(5)
    s_barrier
    ds_read_b128 v[184:187], v70 offset:32768
    ds_read_b64_tr_b16 v[188:189], v74 offset:32768
    ds_read_b64_tr_b16 v[190:191], v74 offset:32928
    ds_read_b128 v[192:195], v71 offset:32768
    ds_read_b64_tr_b16 v[196:197], v74 offset:33408
    ds_read_b64_tr_b16 v[198:199], v74 offset:33568
    ds_read_b128 v[200:203], v72 offset:32768
    ds_read_b64_tr_b16 v[204:205], v74 offset:34048
    ds_read_b64_tr_b16 v[206:207], v74 offset:34208
    ds_read_b128 v[208:211], v73 offset:32768
    ds_read_b64_tr_b16 v[212:213], v74 offset:34688
    ds_read_b64_tr_b16 v[214:215], v74 offset:34848
    s_lshl_b32 s75, s13, 7
    s_add_u32 m0, s82, 0
    s_add_u32 s68, s75, 0
    buffer_load_dwordx4 v22, s[32:35], s68 offen lds
    s_waitcnt lgkmcnt(9)
    v_mfma_f32_32x32x16_bf16 v[112:127], v[184:187], v[188:191], v[112:127]
    s_add_u32 m0, s82, 4096
    s_add_u32 s68, s75, 40960
    buffer_load_dwordx4 v22, s[32:35], s68 offen lds
    s_waitcnt lgkmcnt(6)
    v_mfma_f32_32x32x16_bf16 v[112:127], v[192:195], v[196:199], v[112:127]
    s_mul_i32 s75, s13, 81920
    s_add_u32 m0, s82, 8192
    s_add_u32 s68, s75, 0
    buffer_load_dwordx4 v23, s[36:39], s68 offen lds
    s_waitcnt lgkmcnt(3)
    v_mfma_f32_32x32x16_bf16 v[112:127], v[200:203], v[204:207], v[112:127]
    s_add_u32 m0, s82, 13312
    s_add_u32 s68, s75, 40960
    buffer_load_dwordx4 v23, s[36:39], s68 offen lds
    s_waitcnt lgkmcnt(0)
    v_mfma_f32_32x32x16_bf16 v[112:127], v[208:211], v[212:215], v[112:127]
    s_mul_i32 s75, s13, s67
    s_add_u32 m0, s40, 0
    s_add_u32 s68, s75, 0
    buffer_load_dwordx4 v24, s[56:59], s68 offen lds
    s_cmp_eq_u32 s60, 6
    s_cbranch_scc0 Le1_14
    s_add_u32 m0, s40, 2048
    s_add_u32 s68, s75, 2048
    buffer_load_dwordx4 v24, s[56:59], s68 offen lds
Le1_14:
    s_waitcnt vmcnt(5)
    s_barrier
    v_add_u32 v70, 0x10000, v70
    ds_read_b128 v[184:187], v70 offset:0
    v_add_u32 v74, 0x10000, v74
    ds_read_b64_tr_b16 v[188:189], v74 offset:0
    ds_read_b64_tr_b16 v[190:191], v74 offset:160
    v_add_u32 v71, 0x10000, v71
    ds_read_b128 v[192:195], v71 offset:0
    ds_read_b64_tr_b16 v[196:197], v74 offset:640
    ds_read_b64_tr_b16 v[198:199], v74 offset:800
    v_add_u32 v72, 0x10000, v72
    ds_read_b128 v[200:203], v72 offset:0
    ds_read_b64_tr_b16 v[204:205], v74 offset:1280
    ds_read_b64_tr_b16 v[206:207], v74 offset:1440
    v_add_u32 v73, 0x10000, v73
    ds_read_b128 v[208:211], v73 offset:0
    ds_read_b64_tr_b16 v[212:213], v74 offset:1920
    ds_read_b64_tr_b16 v[214:215], v74 offset:2080
    s_lshl_b32 s75, s14, 7
    s_add_u32 m0, s82, 32768
    s_add_u32 s68, s75, 0
    buffer_load_dwordx4 v22, s[32:35], s68 offen lds
    s_waitcnt lgkmcnt(9)
    v_mfma_f32_32x32x16_bf16 v[112:127], v[184:187], v[188:191], v[112:127]
    s_add_u32 m0, s82, 36864
    s_add_u32 s68, s75, 40960
    buffer_load_dwordx4 v22, s[32:35], s68 offen lds
    s_waitcnt lgkmcnt(6)
    v_mfma_f32_32x32x16_bf16 v[112:127], v[192:195], v[196:199], v[112:127]
    s_mul_i32 s75, s14, 81920
    s_add_u32 m0, s82, 40960
    s_add_u32 s68, s75, 0
    buffer_load_dwordx4 v23, s[36:39], s68 offen lds
    s_waitcnt lgkmcnt(3)
    v_mfma_f32_32x32x16_bf16 v[112:127], v[200:203], v[204:207], v[112:127]
    s_add_u32 m0, s82, 46080
    s_add_u32 s68, s75, 40960
    buffer_load_dwordx4 v23, s[36:39], s68 offen lds
    s_waitcnt lgkmcnt(0)
    v_mfma_f32_32x32x16_bf16 v[112:127], v[208:211], v[212:215], v[112:127]
    s_mul_i32 s75, s14, s67
    s_add_u32 m0, s40, 32768
    s_add_u32 s68, s75, 0
    buffer_load_dwordx4 v24, s[56:59], s68 offen lds
    s_cmp_eq_u32 s60, 6
    s_cbranch_scc0 Le1_15
    s_add_u32 m0, s40, 34816
    s_add_u32 s68, s75, 2048
    buffer_load_dwordx4 v24, s[56:59], s68 offen lds
Le1_15:
    s_waitcnt vmcnt(5)
    s_barrier
    v_add_u32 v70, 0xfffe0000, v70
    ds_read_b128 v[184:187], v70 offset:0
    v_add_u32 v74, 0xfffe0000, v74
    ds_read_b64_tr_b16 v[188:189], v74 offset:0
    ds_read_b64_tr_b16 v[190:191], v74 offset:160
    v_add_u32 v71, 0xfffe0000, v71
    ds_read_b128 v[192:195], v71 offset:0
    ds_read_b64_tr_b16 v[196:197], v74 offset:640
    ds_read_b64_tr_b16 v[198:199], v74 offset:800
    v_add_u32 v72, 0xfffe0000, v72
    ds_read_b128 v[200:203], v72 offset:0
    ds_read_b64_tr_b16 v[204:205], v74 offset:1280
    ds_read_b64_tr_b16 v[206:207], v74 offset:1440
    v_add_u32 v73, 0xfffe0000, v73
    ds_read_b128 v[208:211], v73 offset:0
    ds_read_b64_tr_b16 v[212:213], v74 offset:1920
    ds_read_b64_tr_b16 v[214:215], v74 offset:2080
    s_lshl_b32 s75, s15, 7
    s_add_u32 m0, s82, 65536
    s_add_u32 s68, s75, 0
    buffer_load_dwordx4 v22, s[32:35], s68 offen lds
    s_waitcnt lgkmcnt(9)
    v_mfma_f32_32x32x16_bf16 v[112:127], v[184:187], v[188:191], v[112:127]
    s_add_u32 m0, s82, 69632
    s_add_u32 s68, s75, 40960
    buffer_load_dwordx4 v22, s[32:35], s68 offen lds
    s_waitcnt lgkmcnt(6)
    v_mfma_f32_32x32x16_bf16 v[112:127], v[192:195], v[196:199], v[112:127]
    s_mul_i32 s75, s15, 81920
    s_add_u32 m0, s82, 73728
    s_add_u32 s68, s75, 0
    buffer_load_dwordx4 v23, s[36:39], s68 offen lds
    s_waitcnt lgkmcnt(3)
    v_mfma_f32_32x32x16_bf16 v[112:127], v[200:203], v[204:207], v[112:127]
    s_add_u32 m0, s82, 78848
    s_add_u32 s68, s75, 40960
    buffer_load_dwordx4 v23, s[36:39], s68 offen lds
    s_waitcnt lgkmcnt(0)
    v_mfma_f32_32x32x16_bf16 v[112:127], v[208:211], v[212:215], v[112:127]
    s_mul_i32 s75, s15, s67
    s_add_u32 m0, s40, 65536
    s_add_u32 s68, s75, 0
    buffer_load_dwordx4 v24, s[56:59], s68 offen lds
    s_cmp_eq_u32 s60, 6
    s_cbranch_scc0 Le1_16
    s_add_u32 m0, s40, 67584
    s_add_u32 s68, s75, 2048
    buffer_load_dwordx4 v24, s[56:59], s68 offen lds
Le1_16:
    s_waitcnt vmcnt(5)
    s_barrier
    ds_read_b128 v[184:187], v70 offset:32768
    ds_read_b64_tr_b16 v[188:189], v74 offset:32768
    ds_read_b64_tr_b16 v[190:191], v74 offset:32928
    ds_read_b128 v[192:195], v71 offset:32768
    ds_read_b64_tr_b16 v[196:197], v74 offset:33408
    ds_read_b64_tr_b16 v[198:199], v74 offset:33568
    ds_read_b128 v[200:203], v72 offset:32768
    ds_read_b64_tr_b16 v[204:205], v74 offset:34048
    ds_read_b64_tr_b16 v[206:207], v74 offset:34208
    ds_read_b128 v[208:211], v73 offset:32768
    ds_read_b64_tr_b16 v[212:213], v74 offset:34688
    ds_read_b64_tr_b16 v[214:215], v74 offset:34848
    s_lshl_b32 s75, s16, 7
    s_add_u32 m0, s82, 98304
    s_add_u32 s68, s75, 0
    buffer_load_dwordx4 v22, s[32:35], s68 offen lds
    s_waitcnt lgkmcnt(9)
    v_mfma_f32_32x32x16_bf16 v[112:127], v[184:187], v[188:191], v[112:127]
    s_add_u32 m0, s82, 102400
    s_add_u32 s68, s75, 40960
    buffer_load_dwordx4 v22, s[32:35], s68 offen lds
    s_waitcnt lgkmcnt(6)
    v_mfma_f32_32x32x16_bf16 v[112:127], v[192:195], v[196:199], v[112:127]
    s_mul_i32 s75, s16, 81920
    s_add_u32 m0, s82, 106496
    s_add_u32 s68, s75, 0
    buffer_load_dwordx4 v23, s[36:39], s68 offen lds
    s_waitcnt lgkmcnt(3)
    v_mfma_f32_32x32x16_bf16 v[112:127], v[200:203], v[204:207], v[112:127]
    s_add_u32 m0, s82, 111616
    s_add_u32 s68, s75, 40960
    buffer_load_dwordx4 v23, s[36:39], s68 offen lds
    s_waitcnt lgkmcnt(0)
    v_mfma_f32_32x32x16_bf16 v[112:127], v[208:211], v[212:215], v[112:127]
    s_mul_i32 s75, s16, s67
    s_add_u32 m0, s40, 98304
    s_add_u32 s68, s75, 0
    buffer_load_dwordx4 v24, s[56:59], s68 offen lds
    s_cmp_eq_u32 s60, 6
    s_cbranch_scc0 Le1_17
    s_add_u32 m0, s40, 100352
    s_add_u32 s68, s75, 2048
    buffer_load_dwordx4 v24, s[56:59], s68 offen lds
Le1_17:
    s_waitcnt vmcnt(5)
    s_barrier
    v_add_u32 v70, 0x10000, v70
    ds_read_b128 v[184:187], v70 offset:0
    v_add_u32 v74, 0x10000, v74
    ds_read_b64_tr_b16 v[188:189], v74 offset:0
    ds_read_b64_tr_b16 v[190:191], v74 offset:160
    v_add_u32 v71, 0x10000, v71
    ds_read_b128 v[192:195], v71 offset:0
    ds_read_b64_tr_b16 v[196:197], v74 offset:640
    ds_read_b64_tr_b16 v[198:199], v74 offset:800
    v_add_u32 v72, 0x10000, v72
    ds_read_b128 v[200:203], v72 offset:0
    ds_read_b64_tr_b16 v[204:205], v74 offset:1280
    ds_read_b64_tr_b16 v[206:207], v74 offset:1440
    v_add_u32 v73, 0x10000, v73
    ds_read_b128 v[208:211], v73 offset:0
    ds_read_b64_tr_b16 v[212:213], v74 offset:1920
    ds_read_b64_tr_b16 v[214:215], v74 offset:2080
    s_lshl_b32 s75, s17, 7
    s_add_u32 m0, s82, 131072
    s_add_u32 s68, s75, 0
    buffer_load_dwordx4 v22, s[32:35], s68 offen lds
    s_waitcnt lgkmcnt(9)
    v_mfma_f32_32x32x16_bf16 v[112:127], v[184:187], v[188:191], v[112:127]
    s_add_u32 m0, s82, 135168
    s_add_u32 s68, s75, 40960
    buffer_load_dwordx4 v22, s[32:35], s68 offen lds
    s_waitcnt lgkmcnt(6)
    v_mfma_f32_32x32x16_bf16 v[112:127], v[192:195], v[196:199], v[112:127]
    s_mul_i32 s75, s17, 81920
    s_add_u32 m0, s82, 139264
    s_add_u32 s68, s75, 0
    buffer_load_dwordx4 v23, s[36:39], s68 offen lds
    s_waitcnt lgkmcnt(3)
    v_mfma_f32_32x32x16_bf16 v[112:127], v[200:203], v[204:207], v[112:127]
    s_add_u32 m0, s82, 144384
    s_add_u32 s68, s75, 40960
    buffer_load_dwordx4 v23, s[36:39], s68 offen lds
    s_waitcnt lgkmcnt(0)
    v_mfma_f32_32x32x16_bf16 v[112:127], v[208:211], v[212:215], v[112:127]
    s_mul_i32 s75, s17, s67
    s_add_u32 m0, s40, 131072
    s_add_u32 s68, s75, 0
    buffer_load_dwordx4 v24, s[56:59], s68 offen lds
    s_cmp_eq_u32 s60, 6
    s_cbranch_scc0 Le1_18
    s_add_u32 m0, s40, 133120
    s_add_u32 s68, s75, 2048
    buffer_load_dwordx4 v24, s[56:59], s68 offen lds
Le1_18:
    s_lshl_b32 s70, s61, 1
    s_sub_u32 s70, s70, s63
    s_mul_i32 s70, s70, 81920
    v_add_u32 v22, s70, v22
    s_and_b32 s70, s62, 7
    s_mul_i32 s72, s70, 5
    s_lshr_b32 s72, s72, 2
    s_and_b32 s8, s61, 3
    s_mul_i32 s8, s8, 5
    s_lshr_b32 s8, s8, 1
    s_add_u32 s8, s8, s72
    s_sub_u32 s72, s8, 10
    s_cselect_b32 s8, s8, s72
    s_add_u32 s9, s8, 1
    s_cmp_eq_u32 s9, 10
    s_cselect_b32 s9, 0, s9
    s_add_u32 s10, s9, 1
    s_cmp_eq_u32 s10, 10
    s_cselect_b32 s10, 0, s10
    s_add_u32 s11, s10, 1
    s_cmp_eq_u32 s11, 10
    s_cselect_b32 s11, 0, s11
    s_add_u32 s12, s11, 1
    s_cmp_eq_u32 s12, 10
    s_cselect_b32 s12, 0, s12
    s_add_u32 s13, s12, 1
    s_cmp_eq_u32 s13, 10
    s_cselect_b32 s13, 0, s13
    s_add_u32 s14, s13, 1
    s_cmp_eq_u32 s14, 10
    s_cselect_b32 s14, 0, s14
    s_add_u32 s15, s14, 1
    s_cmp_eq_u32 s15, 10
    s_cselect_b32 s15, 0, s15
    s_add_u32 s16, s15, 1
    s_cmp_eq_u32 s16, 10
    s_cselect_b32 s16, 0, s16
    s_add_u32 s17, s16, 1
    s_cmp_eq_u32 s17, 10
    s_cselect_b32 s17, 0, s17
    s_mul_i32 s75, s8, 245760
    s_add_u32 m0, s82, 16384
    s_add_u32 s68, s75, 0
    buffer_load_dwordx4 v25, s[24:27], s68 offen lds
    s_add_u32 m0, s82, 20480
    s_add_u32 s68, s75, 61440
    buffer_load_dwordx4 v25, s[24:27], s68 offen lds
    s_add_u32 m0, s82, 24576
    s_add_u32 s68, s75, 122880
    buffer_load_dwordx4 v25, s[24:27], s68 offen lds
    s_add_u32 m0, s82, 28672
    s_add_u32 s68, s75, 184320
    buffer_load_dwordx4 v25, s[24:27], s68 offen lds
    s_lshl_b32 s75, s8, 7
    s_add_u32 m0, s82, 0
    s_add_u32 s68, s75, 0
    buffer_load_dwordx4 v22, s[20:23], s68 offen lds
    s_add_u32 m0, s82, 4096
    s_add_u32 s68, s75, 40960
    buffer_load_dwordx4 v22, s[20:23], s68 offen lds
    s_add_u32 m0, s82, 8192
    s_add_u32 s68, s75, 81920
    buffer_load_dwordx4 v22, s[20:23], s68 offen lds
    s_add_u32 m0, s82, 12288
    s_add_u32 s68, s75, 122880
    buffer_load_dwordx4 v22, s[20:23], s68 offen lds
    s_waitcnt vmcnt(13)
    s_barrier
    ds_read_b128 v[184:187], v70 offset:32768
    ds_read_b64_tr_b16 v[188:189], v74 offset:32768
    ds_read_b64_tr_b16 v[190:191], v74 offset:32928
    ds_read_b128 v[192:195], v71 offset:32768
    ds_read_b64_tr_b16 v[196:197], v74 offset:33408
    ds_read_b64_tr_b16 v[198:199], v74 offset:33568
    ds_read_b128 v[200:203], v72 offset:32768
    ds_read_b64_tr_b16 v[204:205], v74 offset:34048
    ds_read_b64_tr_b16 v[206:207], v74 offset:34208
    ds_read_b128 v[208:211], v73 offset:32768
    ds_read_b64_tr_b16 v[212:213], v74 offset:34688
    ds_read_b64_tr_b16 v[214:215], v74 offset:34848
    s_mul_i32 s75, s9, 245760
    s_add_u32 m0, s82, 49152
    s_add_u32 s68, s75, 0
    buffer_load_dwordx4 v25, s[24:27], s68 offen lds
    s_waitcnt lgkmcnt(9)
    v_mfma_f32_32x32x16_bf16 v[112:127], v[184:187], v[188:191], v[112:127]
    s_add_u32 m0, s82, 53248
    s_add_u32 s68, s75, 61440
    buffer_load_dwordx4 v25, s[24:27], s68 offen lds
    s_waitcnt lgkmcnt(6)
    v_mfma_f32_32x32x16_bf16 v[112:127], v[192:195], v[196:199], v[112:127]
    s_add_u32 m0, s82, 57344
    s_add_u32 s68, s75, 122880
    buffer_load_dwordx4 v25, s[24:27], s68 offen lds
    s_waitcnt lgkmcnt(3)
    v_mfma_f32_32x32x16_bf16 v[112:127], v[200:203], v[204:207], v[112:127]
    s_add_u32 m0, s82, 61440
    s_add_u32 s68, s75, 184320
    buffer_load_dwordx4 v25, s[24:27], s68 offen lds
    s_waitcnt lgkmcnt(0)
    v_mfma_f32_32x32x16_bf16 v[112:127], v[208:211], v[212:215], v[112:127]
    s_waitcnt vmcnt(12)
    s_barrier
    v_add_u32 v70, 0x10000, v70
    ds_read_b128 v[184:187], v70 offset:0
    v_add_u32 v74, 0x10000, v74
    ds_read_b64_tr_b16 v[188:189], v74 offset:0
    ds_read_b64_tr_b16 v[190:191], v74 offset:160
    v_add_u32 v71, 0x10000, v71
    ds_read_b128 v[192:195], v71 offset:0
    ds_read_b64_tr_b16 v[196:197], v74 offset:640
    ds_read_b64_tr_b16 v[198:199], v74 offset:800
    v_add_u32 v72, 0x10000, v72
    ds_read_b128 v[200:203], v72 offset:0
    ds_read_b64_tr_b16 v[204:205], v74 offset:1280
    ds_read_b64_tr_b16 v[206:207], v74 offset:1440
    v_add_u32 v73, 0x10000, v73
    ds_read_b128 v[208:211], v73 offset:0
    ds_read_b64_tr_b16 v[212:213], v74 offset:1920
    ds_read_b64_tr_b16 v[214:215], v74 offset:2080
    s_mul_i32 s75, s10, 245760
    s_add_u32 m0, s82, 81920
    s_add_u32 s68, s75, 0
    buffer_load_dwordx4 v25, s[24:27], s68 offen lds
    s_waitcnt lgkmcnt(9)
    v_mfma_f32_32x32x16_bf16 v[112:127], v[184:187], v[188:191], v[112:127]
    s_add_u32 m0, s82, 86016
    s_add_u32 s68, s75, 61440
    buffer_load_dwordx4 v25, s[24:27], s68 offen lds
    s_waitcnt lgkmcnt(6)
    v_mfma_f32_32x32x16_bf16 v[112:127], v[192:195], v[196:199], v[112:127]
    s_add_u32 m0, s82, 90112
    s_add_u32 s68, s75, 122880
    buffer_load_dwordx4 v25, s[24:27], s68 offen lds
    s_waitcnt lgkmcnt(3)
    v_mfma_f32_32x32x16_bf16 v[112:127], v[200:203], v[204:207], v[112:127]
    s_add_u32 m0, s82, 94208
    s_add_u32 s68, s75, 184320
    buffer_load_dwordx4 v25, s[24:27], s68 offen lds
    s_waitcnt lgkmcnt(0)
    v_mfma_f32_32x32x16_bf16 v[112:127], v[208:211], v[212:215], v[112:127]
    s_lshl_b32 s75, s9, 7
    s_add_u32 m0, s82, 32768
    s_add_u32 s68, s75, 0
    buffer_load_dwordx4 v22, s[20:23], s68 offen lds
    s_add_u32 m0, s82, 36864
    s_add_u32 s68, s75, 40960
    buffer_load_dwordx4 v22, s[20:23], s68 offen lds
    s_add_u32 m0, s82, 40960
    s_add_u32 s68, s75, 81920
    buffer_load_dwordx4 v22, s[20:23], s68 offen lds
    s_add_u32 m0, s82, 45056
    s_add_u32 s68, s75, 122880
    buffer_load_dwordx4 v22, s[20:23], s68 offen lds
    s_mul_i32 s70, s63, 5376
    s_add_u32 s70, s70, 131072
    s_mul_i32 s71, s77, 1408
    s_add_u32 s71, s71, s70
    s_add_u32 s71, s71, 2560
    v_and_b32 v2, 31, v0
    v_lshrrev_b32 v3, 5, v0
    v_mul_u32_u24 v3, 352, v3
    v_lshl_add_u32 v1, v2, 4, v3
    v_add_u32 v1, s71, v1
    v_cmp_eq_u32 s[86:87], 20, v2
    v_cmp_lt_u32 s[88:89], 21, v2
    v_mov_b32 v30, 2130706432
    v_mov_b32 v3, 0x3f803f80
    v_cndmask_b32 v1, v1, v30, s[88:89]
    v_cndmask_b32 v3, 0, v3, s[86:87]
    v_cmp_lt_u32 s[86:87], 19, v2
    v_cvt_pk_bf16_f32 v232, v112, v113
    v_cvt_pk_bf16_f32 v233, v114, v115
    v_cvt_pk_bf16_f32 v234, v116, v117
    v_cvt_pk_bf16_f32 v235, v118, v119
    v_cvt_pk_bf16_f32 v236, v120, v121
    v_cvt_pk_bf16_f32 v237, v122, v123
    v_cvt_pk_bf16_f32 v238, v124, v125
    v_cvt_pk_bf16_f32 v239, v126, v127
    v_cndmask_b32 v232, v232, v3, s[86:87]
    v_cndmask_b32 v233, v233, v3, s[86:87]
    v_cndmask_b32 v234, v234, v3, s[86:87]
    v_cndmask_b32 v235, v235, v3, s[86:87]
    v_cndmask_b32 v236, v236, v3, s[86:87]
    v_cndmask_b32 v237, v237, v3, s[86:87]
    v_cndmask_b32 v238, v238, v3, s[86:87]
    v_cndmask_b32 v239, v239, v3, s[86:87]
    buffer_store_dwordx4 v[232:235], v1, s[52:55], 0 offen sc1
    buffer_store_dwordx4 v[236:239], v1, s[52:55], 0 offen offset:704 sc1
    s_branch L_ldA
L_ldB_N:
    s_waitcnt vmcnt(8)
    s_barrier
    s_mul_i32 s75, s10, 81920
    s_add_u32 m0, s82, 73728
    s_add_u32 s68, s75, 0
    buffer_load_dwordx4 v23, s[36:39], s68 offen lds
    s_add_u32 m0, s82, 78848
    s_add_u32 s68, s75, 40960
    buffer_load_dwordx4 v23, s[36:39], s68 offen lds
    s_mul_i32 s75, s10, s67
    s_add_u32 m0, s40, 65536
    s_add_u32 s68, s75, 0
    buffer_load_dwordx4 v24, s[56:59], s68 offen lds
    s_cmp_eq_u32 s60, 6
    s_cbranch_scc0 Le1_19
    s_add_u32 m0, s40, 67584
    s_add_u32 s68, s75, 2048
    buffer_load_dwordx4 v24, s[56:59], s68 offen lds
Le1_19:
    s_waitcnt vmcnt(4)
    s_barrier
    s_lshl_b32 s75, s11, 7
    s_add_u32 m0, s82, 98304
    s_add_u32 s68, s75, 0
    buffer_load_dwordx4 v22, s[32:35], s68 offen lds
    s_add_u32 m0, s82, 102400
    s_add_u32 s68, s75, 40960
    buffer_load_dwordx4 v22, s[32:35], s68 offen lds
    s_mul_i32 s75, s11, 81920
    s_add_u32 m0, s82, 106496
    s_add_u32 s68, s75, 0
    buffer_load_dwordx4 v23, s[36:39], s68 offen lds
    s_add_u32 m0, s82, 111616
    s_add_u32 s68, s75, 40960
    buffer_load_dwordx4 v23, s[36:39], s68 offen lds
    s_mul_i32 s75, s11, s67
    s_add_u32 m0, s40, 98304
    s_add_u32 s68, s75, 0
    buffer_load_dwordx4 v24, s[56:59], s68 offen lds
    s_cmp_eq_u32 s60, 6
    s_cbranch_scc0 Le1_20
    s_add_u32 m0, s40, 100352
    s_add_u32 s68, s75, 2048
    buffer_load_dwordx4 v24, s[56:59], s68 offen lds
Le1_20:
    s_waitcnt vmcnt(5)
    s_barrier
    s_lshl_b32 s75, s12, 7
    s_add_u32 m0, s82, 131072
    s_add_u32 s68, s75, 0
    buffer_load_dwordx4 v22, s[32:35], s68 offen lds
    s_add_u32 m0, s82, 135168
    s_add_u32 s68, s75, 40960
    buffer_load_dwordx4 v22, s[32:35], s68 offen lds
    s_mul_i32 s75, s12, 81920
    s_add_u32 m0, s82, 139264
    s_add_u32 s68, s75, 0
    buffer_load_dwordx4 v23, s[36:39], s68 offen lds
    s_add_u32 m0, s82, 144384
    s_add_u32 s68, s75, 40960
    buffer_load_dwordx4 v23, s[36:39], s68 offen lds
    s_mul_i32 s75, s12, s67
    s_add_u32 m0, s40, 131072
    s_add_u32 s68, s75, 0
    buffer_load_dwordx4 v24, s[56:59], s68 offen lds
    s_cmp_eq_u32 s60, 6
    s_cbranch_scc0 Le1_21
    s_add_u32 m0, s40, 133120
    s_add_u32 s68, s75, 2048
    buffer_load_dwordx4 v24, s[56:59], s68 offen lds
Le1_21:
    v_add_u32 v17, 0x9e3779b9, v17
    s_waitcnt vmcnt(5)
    s_barrier
    s_lshl_b32 s75, s13, 7
    s_add_u32 m0, s82, 0
    s_add_u32 s68, s75, 0
    buffer_load_dwordx4 v22, s[32:35], s68 offen lds
    s_add_u32 m0, s82, 4096
    s_add_u32 s68, s75, 40960
    buffer_load_dwordx4 v22, s[32:35], s68 offen lds
    s_mul_i32 s75, s13, 81920
    s_add_u32 m0, s82, 8192
    s_add_u32 s68, s75, 0
    buffer_load_dwordx4 v23, s[36:39], s68 offen lds
    s_add_u32 m0, s82, 13312
    s_add_u32 s68, s75, 40960
    buffer_load_dwordx4 v23, s[36:39], s68 offen lds
    s_mul_i32 s75, s13, s67
    s_add_u32 m0, s40, 0
    s_add_u32 s68, s75, 0
    buffer_load_dwordx4 v24, s[56:59], s68 offen lds
    s_cmp_eq_u32 s60, 6
    s_cbranch_scc0 Le1_22
    s_add_u32 m0, s40, 2048
    s_add_u32 s68, s75, 2048
    buffer_load_dwordx4 v24, s[56:59], s68 offen lds
Le1_22:
    s_waitcnt vmcnt(5)
    s_barrier
    s_lshl_b32 s75, s14, 7
    s_add_u32 m0, s82, 32768
    s_add_u32 s68, s75, 0
    buffer_load_dwordx4 v22, s[32:35], s68 offen lds
    s_add_u32 m0, s82, 36864
    s_add_u32 s68, s75, 40960
    buffer_load_dwordx4 v22, s[32:35], s68 offen lds
    s_mul_i32 s75, s14, 81920
    s_add_u32 m0, s82, 40960
    s_add_u32 s68, s75, 0
    buffer_load_dwordx4 v23, s[36:39], s68 offen lds
    s_add_u32 m0, s82, 46080
    s_add_u32 s68, s75, 40960
    buffer_load_dwordx4 v23, s[36:39], s68 offen lds
    s_mul_i32 s75, s14, s67
    s_add_u32 m0, s40, 32768
    s_add_u32 s68, s75, 0
    buffer_load_dwordx4 v24, s[56:59], s68 offen lds
    s_cmp_eq_u32 s60, 6
    s_cbranch_scc0 Le1_23
    s_add_u32 m0, s40, 34816
    s_add_u32 s68, s75, 2048
    buffer_load_dwordx4 v24, s[56:59], s68 offen lds
Le1_23:
    s_waitcnt vmcnt(5)
    s_barrier
    s_lshl_b32 s75, s15, 7
    s_add_u32 m0, s82, 65536
    s_add_u32 s68, s75, 0
    buffer_load_dwordx4 v22, s[32:35], s68 offen lds
    s_add_u32 m0, s82, 69632
    s_add_u32 s68, s75, 40960
    buffer_load_dwordx4 v22, s[32:35], s68 offen lds
    s_mul_i32 s75, s15, 81920
    s_add_u32 m0, s82, 73728
    s_add_u32 s68, s75, 0
    buffer_load_dwordx4 v23, s[36:39], s68 offen lds
    s_add_u32 m0, s82, 78848
    s_add_u32 s68, s75, 40960
    buffer_load_dwordx4 v23, s[36:39], s68 offen lds
    s_mul_i32 s75, s15, s67
    s_add_u32 m0, s40, 65536
    s_add_u32 s68, s75, 0
    buffer_load_dwordx4 v24, s[56:59], s68 offen lds
    s_cmp_eq_u32 s60, 6
    s_cbranch_scc0 Le1_24
    s_add_u32 m0, s40, 67584
    s_add_u32 s68, s75, 2048
    buffer_load_dwordx4 v24, s[56:59], s68 offen lds
Le1_24:
    s_waitcnt vmcnt(5)
    s_barrier
    s_lshl_b32 s75, s16, 7
    s_add_u32 m0, s82, 98304
    s_add_u32 s68, s75, 0
    buffer_load_dwordx4 v22, s[32:35], s68 offen lds
    s_add_u32 m0, s82, 102400
    s_add_u32 s68, s75, 40960
    buffer_load_dwordx4 v22, s[32:35], s68 offen lds
    s_mul_i32 s75, s16, 81920
    s_add_u32 m0, s82, 106496
    s_add_u32 s68, s75, 0
    buffer_load_dwordx4 v23, s[36:39], s68 offen lds
    s_add_u32 m0, s82, 111616
    s_add_u32 s68, s75, 40960
    buffer_load_dwordx4 v23, s[36:39], s68 offen lds
    s_mul_i32 s75, s16, s67
    s_add_u32 m0, s40, 98304
    s_add_u32 s68, s75, 0
    buffer_load_dwordx4 v24, s[56:59], s68 offen lds
    s_cmp_eq_u32 s60, 6
    s_cbranch_scc0 Le1_25
    s_add_u32 m0, s40, 100352
    s_add_u32 s68, s75, 2048
    buffer_load_dwordx4 v24, s[56:59], s68 offen lds
Le1_25:
    s_waitcnt vmcnt(5)
    s_barrier
    s_lshl_b32 s75, s17, 7
    s_add_u32 m0, s82, 131072
    s_add_u32 s68, s75, 0
    buffer_load_dwordx4 v22, s[32:35], s68 offen lds
    s_add_u32 m0, s82, 135168
    s_add_u32 s68, s75, 40960
    buffer_load_dwordx4 v22, s[32:35], s68 offen lds
    s_mul_i32 s75, s17, 81920
    s_add_u32 m0, s82, 139264
    s_add_u32 s68, s75, 0
    buffer_load_dwordx4 v23, s[36:39], s68 offen lds
    s_add_u32 m0, s82, 144384
    s_add_u32 s68, s75, 40960
    buffer_load_dwordx4 v23, s[36:39], s68 offen lds
    s_mul_i32 s75, s17, s67
    s_add_u32 m0, s40, 131072
    s_add_u32 s68, s75, 0
    buffer_load_dwordx4 v24, s[56:59], s68 offen lds
    s_cmp_eq_u32 s60, 6
    s_cbranch_scc0 Le1_26
    s_add_u32 m0, s40, 133120
    s_add_u32 s68, s75, 2048
    buffer_load_dwordx4 v24, s[56:59], s68 offen lds
Le1_26:
    s_lshl_b32 s70, s61, 1
    s_sub_u32 s70, s70, s63
    s_mul_i32 s70, s70, 81920
    v_add_u32 v22, s70, v22
    s_and_b32 s70, s62, 7
    s_mul_i32 s72, s70, 5
    s_lshr_b32 s72, s72, 2
    s_and_b32 s8, s61, 3
    s_mul_i32 s8, s8, 5
    s_lshr_b32 s8, s8, 1
    s_add_u32 s8, s8, s72
    s_sub_u32 s72, s8, 10
    s_cselect_b32 s8, s8, s72
    s_add_u32 s9, s8, 1
    s_cmp_eq_u32 s9, 10
    s_cselect_b32 s9, 0, s9
    s_add_u32 s10, s9, 1
    s_cmp_eq_u32 s10, 10
    s_cselect_b32 s10, 0, s10
    s_add_u32 s11, s10, 1
    s_cmp_eq_u32 s11, 10
    s_cselect_b32 s11, 0, s11
    s_add_u32 s12, s11, 1
    s_cmp_eq_u32 s12, 10
    s_cselect_b32 s12, 0, s12
    s_add_u32 s13, s12, 1
    s_cmp_eq_u32 s13, 10
    s_cselect_b32 s13, 0, s13
    s_add_u32 s14, s13, 1
    s_cmp_eq_u32 s14, 10
    s_cselect_b32 s14, 0, s14
    s_add_u32 s15, s14, 1
    s_cmp_eq_u32 s15, 10
    s_cselect_b32 s15, 0, s15
    s_add_u32 s16, s15, 1
    s_cmp_eq_u32 s16, 10
    s_cselect_b32 s16, 0, s16
    s_add_u32 s17, s16, 1
    s_cmp_eq_u32 s17, 10
    s_cselect_b32 s17, 0, s17
    s_mul_i32 s75, s8, 245760
    s_add_u32 m0, s82, 16384
    s_add_u32 s68, s75, 0
    buffer_load_dwordx4 v25, s[24:27], s68 offen lds
    s_add_u32 m0, s82, 20480
    s_add_u32 s68, s75, 61440
    buffer_load_dwordx4 v25, s[24:27], s68 offen lds
    s_add_u32 m0, s82, 24576
    s_add_u32 s68, s75, 122880
    buffer_load_dwordx4 v25, s[24:27], s68 offen lds
    s_add_u32 m0, s82, 28672
    s_add_u32 s68, s75, 184320
    buffer_load_dwordx4 v25, s[24:27], s68 offen lds
    s_lshl_b32 s75, s8, 7
    s_add_u32 m0, s82, 0
    s_add_u32 s68, s75, 0
    buffer_load_dwordx4 v22, s[20:23], s68 offen lds
    s_add_u32 m0, s82, 4096
    s_add_u32 s68, s75, 40960
    buffer_load_dwordx4 v22, s[20:23], s68 offen lds
    s_add_u32 m0, s82, 8192
    s_add_u32 s68, s75, 81920
    buffer_load_dwordx4 v22, s[20:23], s68 offen lds
    s_add_u32 m0, s82, 12288
    s_add_u32 s68, s75, 122880
    buffer_load_dwordx4 v22, s[20:23], s68 offen lds
    s_waitcnt vmcnt(13)
    s_barrier
    s_mul_i32 s75, s9, 245760
    s_add_u32 m0, s82, 49152
    s_add_u32 s68, s75, 0
    buffer_load_dwordx4 v25, s[24:27], s68 offen lds
    s_add_u32 m0, s82, 53248
    s_add_u32 s68, s75, 61440
    buffer_load_dwordx4 v25, s[24:27], s68 offen lds
    s_add_u32 m0, s82, 57344
    s_add_u32 s68, s75, 122880
    buffer_load_dwordx4 v25, s[24:27], s68 offen lds
    s_add_u32 m0, s82, 61440
    s_add_u32 s68, s75, 184320
    buffer_load_dwordx4 v25, s[24:27], s68 offen lds
    s_waitcnt vmcnt(12)
    s_barrier
    s_mul_i32 s75, s10, 245760
    s_add_u32 m0, s82, 81920
    s_add_u32 s68, s75, 0
    buffer_load_dwordx4 v25, s[24:27], s68 offen lds
    s_add_u32 m0, s82, 86016
    s_add_u32 s68, s75, 61440
    buffer_load_dwordx4 v25, s[24:27], s68 offen lds
    s_add_u32 m0, s82, 90112
    s_add_u32 s68, s75, 122880
    buffer_load_dwordx4 v25, s[24:27], s68 offen lds
    s_add_u32 m0, s82, 94208
    s_add_u32 s68, s75, 184320
    buffer_load_dwordx4 v25, s[24:27], s68 offen lds
    s_lshl_b32 s75, s9, 7
    s_add_u32 m0, s82, 32768
    s_add_u32 s68, s75, 0
    buffer_load_dwordx4 v22, s[20:23], s68 offen lds
    s_add_u32 m0, s82, 36864
    s_add_u32 s68, s75, 40960
    buffer_load_dwordx4 v22, s[20:23], s68 offen lds
    s_add_u32 m0, s82, 40960
    s_add_u32 s68, s75, 81920
    buffer_load_dwordx4 v22, s[20:23], s68 offen lds
    s_add_u32 m0, s82, 45056
    s_add_u32 s68, s75, 122880
    buffer_load_dwordx4 v22, s[20:23], s68 offen lds
L_ldA:
    s_waitcnt vmcnt(12)
    s_barrier
    s_lshl_b32 s75, s10, 7
    s_add_u32 m0, s82, 65536
    s_add_u32 s68, s75, 0
    buffer_load_dwordx4 v22, s[20:23], s68 offen lds
    s_add_u32 m0, s82, 69632
    s_add_u32 s68, s75, 40960
    buffer_load_dwordx4 v22, s[20:23], s68 offen lds
    s_add_u32 m0, s82, 73728
    s_add_u32 s68, s75, 81920
    buffer_load_dwordx4 v22, s[20:23], s68 offen lds
    s_add_u32 m0, s82, 77824
    s_add_u32 s68, s75, 122880
    buffer_load_dwordx4 v22, s[20:23], s68 offen lds
    s_waitcnt vmcnt(4)
    s_barrier
    s_add_u32 s70, s82, 155648
    v_add_u32 v1, s70, v27
    v_lshlrev_b32 v2, 3, v0
    s_add_u32 s70, s82, 159744
    v_add_u32 v2, s70, v2
    ds_read_b128 v[4:7], v1
    ds_read_b64 v[8:9], v2
    s_waitcnt lgkmcnt(0)
    s_mul_i32 s75, s11, 245760
    s_add_u32 m0, s82, 114688
    s_add_u32 s68, s75, 0
    buffer_load_dwordx4 v25, s[24:27], s68 offen lds
    s_add_u32 m0, s82, 118784
    s_add_u32 s68, s75, 61440
    buffer_load_dwordx4 v25, s[24:27], s68 offen lds
    s_add_u32 m0, s82, 122880
    s_add_u32 s68, s75, 122880
    buffer_load_dwordx4 v25, s[24:27], s68 offen lds
    s_add_u32 m0, s82, 126976
    s_add_u32 s68, s75, 184320
    buffer_load_dwordx4 v25, s[24:27], s68 offen lds
    s_lshl_b32 s75, s11, 7
    s_add_u32 m0, s82, 98304
    s_add_u32 s68, s75, 0
    buffer_load_dwordx4 v22, s[20:23], s68 offen lds
    s_add_u32 m0, s82, 102400
    s_add_u32 s68, s75, 40960
    buffer_load_dwordx4 v22, s[20:23], s68 offen lds
    s_add_u32 m0, s82, 106496
    s_add_u32 s68, s75, 81920
    buffer_load_dwordx4 v22, s[20:23], s68 offen lds
    s_add_u32 m0, s82, 110592
    s_add_u32 s68, s75, 122880
    buffer_load_dwordx4 v22, s[20:23], s68 offen lds
    s_cmp_eq_u32 s60, 7
    s_cbranch_scc0 Lf1_27
    s_waitcnt vmcnt(12)
    s_lshl_b32 s70, s2, 2
    s_add_u32 s70, s70, 4096
    v_mov_b32 v1, s70
    buffer_store_dword v17, v1, s[52:55], 0 offen sc1
Lf1_27:
    s_waitcnt vmcnt(8)
    s_barrier
    s_mul_i32 s75, s12, 245760
    s_add_u32 m0, s82, 147456
    s_add_u32 s68, s75, 0
    buffer_load_dwordx4 v25, s[24:27], s68 offen lds
    s_add_u32 m0, s82, 151552
    s_add_u32 s68, s75, 61440
    buffer_load_dwordx4 v25, s[24:27], s68 offen lds
    s_add_u32 m0, s82, 155648
    s_add_u32 s68, s75, 122880
    buffer_load_dwordx4 v25, s[24:27], s68 offen lds
    s_add_u32 m0, s82, 159744
    s_add_u32 s68, s75, 184320
    buffer_load_dwordx4 v25, s[24:27], s68 offen lds
    s_lshl_b32 s75, s12, 7
    s_add_u32 m0, s82, 131072
    s_add_u32 s68, s75, 0
    buffer_load_dwordx4 v22, s[20:23], s68 offen lds
    s_add_u32 m0, s82, 135168
    s_add_u32 s68, s75, 40960
    buffer_load_dwordx4 v22, s[20:23], s68 offen lds
    s_add_u32 m0, s82, 139264
    s_add_u32 s68, s75, 81920
    buffer_load_dwordx4 v22, s[20:23], s68 offen lds
    s_add_u32 m0, s82, 143360
    s_add_u32 s68, s75, 122880
    buffer_load_dwordx4 v22, s[20:23], s68 offen lds
    s_waitcnt vmcnt(8)
    s_barrier
    s_mul_i32 s75, s13, 245760
    s_add_u32 m0, s82, 16384
    s_add_u32 s68, s75, 0
    buffer_load_dwordx4 v25, s[24:27], s68 offen lds
    s_add_u32 m0, s82, 20480
    s_add_u32 s68, s75, 61440
    buffer_load_dwordx4 v25, s[24:27], s68 offen lds
    s_add_u32 m0, s82, 24576
    s_add_u32 s68, s75, 122880
    buffer_load_dwordx4 v25, s[24:27], s68 offen lds
    s_add_u32 m0, s82, 28672
    s_add_u32 s68, s75, 184320
    buffer_load_dwordx4 v25, s[24:27], s68 offen lds
    s_lshl_b32 s75, s13, 7
    s_add_u32 m0, s82, 0
    s_add_u32 s68, s75, 0
    buffer_load_dwordx4 v22, s[20:23], s68 offen lds
    s_add_u32 m0, s82, 4096
    s_add_u32 s68, s75, 40960
    buffer_load_dwordx4 v22, s[20:23], s68 offen lds
    s_add_u32 m0, s82, 8192
    s_add_u32 s68, s75, 81920
    buffer_load_dwordx4 v22, s[20:23], s68 offen lds
    s_add_u32 m0, s82, 12288
    s_add_u32 s68, s75, 122880
    buffer_load_dwordx4 v22, s[20:23], s68 offen lds
    v_and_b32 v2, 31, v0
    v_lshlrev_b32 v2, 4, v2
    v_lshrrev_b32 v3, 5, v0
    v_lshl_add_u32 v3, v3, 9, v2
    s_and_b32 s70, s60, 3
    s_lshl_b32 s71, s64, 2
    s_add_u32 s70, s70, s71
    s_lshr_b32 s71, s60, 2
    s_lshl_b32 s72, s63, 1
    s_add_u32 s71, s71, s72
    s_mul_i32 s71, s71, 40960
    s_add_u32 s71, s71, 9437184
    s_lshr_b32 s72, s70, 3
    s_mul_i32 s72, s72, 10240
    s_add_u32 s71, s71, s72
    s_and_b32 s72, s70, 7
    s_lshl_b32 s72, s72, 10
    s_add_u32 s72, s72, s71
    v_add_u32 v18, s72, v3
    s_bfe_u32 s72, s70, 0x20001
    s_lshl_b32 s72, s72, 9
    s_add_u32 s71, s71, s72
    s_and_b32 s72, s70, 1
    s_lshl_b32 s72, s72, 3
    s_add_u32 s71, s71, s72
    s_add_u32 s71, s71, 8192
    v_add_u32 v19, s71, v2
    v_mov_b32 v1, 2130706432
    v_cndmask_b32 v19, v19, v1, s[84:85]
    v_mov_b32 v248, -1
    v_mov_b32 v249, -1
    v_mov_b32 v250, -1
    v_mov_b32 v251, -1
    s_waitcnt vmcnt(8)
    s_barrier
    s_mul_i32 s75, s14, 245760
    s_add_u32 m0, s82, 49152
    s_add_u32 s68, s75, 0
    buffer_load_dwordx4 v25, s[24:27], s68 offen lds
    s_add_u32 m0, s82, 53248
    s_add_u32 s68, s75, 61440
    buffer_load_dwordx4 v25, s[24:27], s68 offen lds
    s_add_u32 m0, s82, 57344
    s_add_u32 s68, s75, 122880
    buffer_load_dwordx4 v25, s[24:27], s68 offen lds
    s_add_u32 m0, s82, 61440
    s_add_u32 s68, s75, 184320
    buffer_load_dwordx4 v25, s[24:27], s68 offen lds
    s_lshl_b32 s75, s14, 7
    s_add_u32 m0, s82, 32768
    s_add_u32 s68, s75, 0
    buffer_load_dwordx4 v22, s[20:23], s68 offen lds
    s_add_u32 m0, s82, 36864
    s_add_u32 s68, s75, 40960
    buffer_load_dwordx4 v22, s[20:23], s68 offen lds
    s_add_u32 m0, s82, 40960
    s_add_u32 s68, s75, 81920
    buffer_load_dwordx4 v22, s[20:23], s68 offen lds
    s_add_u32 m0, s82, 45056
    s_add_u32 s68, s75, 122880
    buffer_load_dwordx4 v22, s[20:23], s68 offen lds
    v_and_b32 v2, 31, v0
    v_lshlrev_b32 v2, 4, v2
    v_lshrrev_b32 v3, 5, v0
    v_lshl_add_u32 v3, v3, 9, v2
    s_and_b32 s70, s60, 1
    s_lshl_b32 s71, s62, 1
    s_add_u32 s70, s70, s71
    s_mov_b32 s71, s83
    s_lshl_b32 s72, s61, 2
    s_add_u32 s71, s71, s72
    s_mul_i32 s71, s71, 40960
    s_add_u32 s71, s71, 12058624
    s_lshr_b32 s72, s70, 3
    s_mul_i32 s72, s72, 10240
    s_add_u32 s71, s71, s72
    s_and_b32 s72, s70, 7
    s_lshl_b32 s72, s72, 10
    s_add_u32 s72, s72, s71
    v_add_u32 v20, s72, v3
    s_bfe_u32 s72, s70, 0x20001
    s_lshl_b32 s72, s72, 9
    s_add_u32 s71, s71, s72
    s_and_b32 s72, s70, 1
    s_lshl_b32 s72, s72, 3
    s_add_u32 s71, s71, s72
    s_add_u32 s71, s71, 8192
    v_add_u32 v21, s71, v2
    v_mov_b32 v1, 2130706432
    v_cndmask_b32 v21, v21, v1, s[84:85]
    s_waitcnt vmcnt(8)
    s_barrier
    s_mul_i32 s75, s15, 245760
    s_add_u32 m0, s82, 81920
    s_add_u32 s68, s75, 0
    buffer_load_dwordx4 v25, s[24:27], s68 offen lds
    s_add_u32 m0, s82, 86016
    s_add_u32 s68, s75, 61440
    buffer_load_dwordx4 v25, s[24:27], s68 offen lds
    s_add_u32 m0, s82, 90112
    s_add_u32 s68, s75, 122880
    buffer_load_dwordx4 v25, s[24:27], s68 offen lds
    s_add_u32 m0, s82, 94208
    s_add_u32 s68, s75, 184320
    buffer_load_dwordx4 v25, s[24:27], s68 offen lds
    s_lshl_b32 s75, s15, 7
    s_add_u32 m0, s82, 65536
    s_add_u32 s68, s75, 0
    buffer_load_dwordx4 v22, s[20:23], s68 offen lds
    s_add_u32 m0, s82, 69632
    s_add_u32 s68, s75, 40960
    buffer_load_dwordx4 v22, s[20:23], s68 offen lds
    s_add_u32 m0, s82, 73728
    s_add_u32 s68, s75, 81920
    buffer_load_dwordx4 v22, s[20:23], s68 offen lds
    s_add_u32 m0, s82, 77824
    s_add_u32 s68, s75, 122880
    buffer_load_dwordx4 v22, s[20:23], s68 offen lds
    s_and_b32 s71, s60, 1
    s_mul_i32 s71, s71, 34816
    s_lshr_b32 s73, s83, 1
    s_mul_i32 s73, s73, 5760
    s_add_u32 s71, s71, s73
    s_and_b32 s73, s83, 1
    s_lshl_b32 s73, s73, 3
    s_add_u32 s71, s71, s73
    s_add_u32 s71, s71, 65536
    s_lshl_b32 s73, s61, 2
    s_add_u32 s72, s83, s73
    s_min_u32 s72, s72, 8
    s_sub_u32 s78, 8, s72
    v_and_b32 v1, 31, v0
    v_lshlrev_b32 v1, 4, v1
    v_add_u32 v1, s71, v1
    v_lshrrev_b32 v3, 5, v0
    v_mul_u32_u24 v245, 576, v3
    v_add_u32 v245, v245, v1
    s_add_u32 s72, s71, 512
    v_add_u32 v1, 2304, v1
    v_mov_b32 v30, s72
    v_cndmask_b32 v246, v1, v30, s[84:85]
    v_bfe_u32 v1, v0, 4, 1
    v_and_b32 v2, 3, v0
    v_lshl_add_u32 v1, v1, 2, v2
    v_cmp_lt_u32 s[86:87], 4, v1
    v_mul_u32_u24 v1, 576, v1
    v_bfe_u32 v2, v0, 2, 2
    v_lshl_add_u32 v2, v3, 3, v2
    v_lshl_add_u32 v1, v2, 4, v1
    s_add_u32 s71, s71, 2880
    v_add_u32 v1, s71, v1
    v_cndmask_b32 v247, v1, v30, s[86:87]
    v_add_u32 v2, 64, v1
    v_cndmask_b32 v252, v2, v30, s[86:87]
    v_add_u32 v2, 256, v1
    v_cndmask_b32 v253, v2, v30, s[86:87]
    v_add_u32 v2, 320, v1
    v_cndmask_b32 v254, v2, v30, s[86:87]
    s_waitcnt vmcnt(8)
    s_barrier
    s_mul_i32 s75, s16, 245760
    s_add_u32 m0, s82, 114688
    s_add_u32 s68, s75, 0
    buffer_load_dwordx4 v25, s[24:27], s68 offen lds
    s_add_u32 m0, s82, 118784
    s_add_u32 s68, s75, 61440
    buffer_load_dwordx4 v25, s[24:27], s68 offen lds
    s_add_u32 m0, s82, 122880
    s_add_u32 s68, s75, 122880
    buffer_load_dwordx4 v25, s[24:27], s68 offen lds
    s_add_u32 m0, s82, 126976
    s_add_u32 s68, s75, 184320
    buffer_load_dwordx4 v25, s[24:27], s68 offen lds
    s_lshl_b32 s75, s16, 7
    s_add_u32 m0, s82, 98304
    s_add_u32 s68, s75, 0
    buffer_load_dwordx4 v22, s[20:23], s68 offen lds
    s_add_u32 m0, s82, 102400
    s_add_u32 s68, s75, 40960
    buffer_load_dwordx4 v22, s[20:23], s68 offen lds
    s_add_u32 m0, s82, 106496
    s_add_u32 s68, s75, 81920
    buffer_load_dwordx4 v22, s[20:23], s68 offen lds
    s_add_u32 m0, s82, 110592
    s_add_u32 s68, s75, 122880
    buffer_load_dwordx4 v22, s[20:23], s68 offen lds
    s_and_b32 s70, s60, 3
    s_lshr_b32 s71, s70, 1
    s_lshl_b32 s72, s63, 1
    s_add_u32 s71, s71, s72
    s_mul_i32 s71, s71, 40960
    s_and_b32 s70, s70, 1
    s_lshl_b32 s70, s70, 8
    s_add_u32 s71, s71, s70
    s_lshr_b32 s70, s60, 2
    s_mul_i32 s70, s70, 20480
    s_add_u32 s71, s71, s70
    v_lshrrev_b32 v1, 4, v0
    v_lshlrev_b32 v1, 9, v1
    v_and_b32 v2, 15, v0
    v_lshl_add_u32 v1, v2, 4, v1
    v_add_u32 v29, s71, v1
    s_waitcnt vmcnt(8)
    s_barrier
    s_mul_i32 s75, s17, 245760
    s_add_u32 m0, s82, 147456
    s_add_u32 s68, s75, 0
    buffer_load_dwordx4 v25, s[24:27], s68 offen lds
    s_add_u32 m0, s82, 151552
    s_add_u32 s68, s75, 61440
    buffer_load_dwordx4 v25, s[24:27], s68 offen lds
    s_add_u32 m0, s82, 155648
    s_add_u32 s68, s75, 122880
    buffer_load_dwordx4 v25, s[24:27], s68 offen lds
    s_add_u32 m0, s82, 159744
    s_add_u32 s68, s75, 184320
    buffer_load_dwordx4 v25, s[24:27], s68 offen lds
    s_lshl_b32 s75, s17, 7
    s_add_u32 m0, s82, 131072
    s_add_u32 s68, s75, 0
    buffer_load_dwordx4 v22, s[20:23], s68 offen lds
    s_add_u32 m0, s82, 135168
    s_add_u32 s68, s75, 40960
    buffer_load_dwordx4 v22, s[20:23], s68 offen lds
    s_add_u32 m0, s82, 139264
    s_add_u32 s68, s75, 81920
    buffer_load_dwordx4 v22, s[20:23], s68 offen lds
    s_add_u32 m0, s82, 143360
    s_add_u32 s68, s75, 122880
    buffer_load_dwordx4 v22, s[20:23], s68 offen lds
    s_lshr_b32 s70, s60, 2
    s_mul_i32 s70, s70, 5120
    v_add_u32 v240, s70, v27
    v_add_u32 v241, 0x10000, v240
    v_add_u32 v242, 0x20000, v240
    s_mul_i32 s70, s81, 5120
    s_add_u32 s70, s70, 65536
    v_add_u32 v243, s70, v27
    s_lshl_b32 s71, s63, 6
    s_lshl_b32 s72, s81, 4
    s_add_u32 s71, s71, s72
    v_and_b32 v2, 15, v0
    v_add_u32 v2, s71, v2
    v_mul_u32_u24 v2, 2560, v2
    v_lshrrev_b32 v3, 4, v0
    v_lshl_add_u32 v2, v3, 3, v2
    s_mul_i32 s71, s64, 160
    v_add_u32 v244, s71, v2
    v_and_b32 v1, 1, v3
    v_mul_u32_u24 v1, 24, v1
    v_add_u32 v26, v1, v244
    s_waitcnt vmcnt(8)
    s_barrier
    s_add_u32 m0, s82, 0
    s_add_u32 s68, s82, 131072
    buffer_load_dwordx4 v27, s[52:55], s68 offen sc1 lds
    s_add_u32 m0, s82, 4096
    s_add_u32 s68, s82, 135168
    buffer_load_dwordx4 v27, s[52:55], s68 offen sc1 lds
    s_add_u32 m0, s82, 8192
    s_add_u32 s68, s82, 139264
    buffer_load_dwordx4 v27, s[52:55], s68 offen sc1 lds
    s_add_u32 m0, s82, 12288
    s_add_u32 s68, s82, 143360
    buffer_load_dwordx4 v27, s[52:55], s68 offen sc1 lds
    s_add_u32 m0, s82, 16384
    s_add_u32 s68, s82, 147456
    buffer_load_dwordx4 v27, s[52:55], s68 offen sc1 lds
    s_cmp_eq_u32 s81, 0
    s_cbranch_scc0 Lkv_28
    s_add_u32 m0, s82, 20480
    s_add_u32 s68, s82, 151552
    buffer_load_dwordx4 v27, s[52:55], s68 offen sc1 lds
Lkv_28:
    s_add_u32 m0, s82, 21504
    s_add_u32 s68, s82, 152576
    buffer_load_dwordx4 v27, s[52:55], s68 offen sc1 lds
    s_add_u32 m0, s82, 25600
    s_add_u32 s68, s82, 156672
    buffer_load_dwordx4 v27, s[52:55], s68 offen sc1 lds
    s_add_u32 m0, s82, 29696
    s_add_u32 s68, s82, 160768
    buffer_load_dwordx4 v27, s[52:55], s68 offen sc1 lds
    s_add_u32 m0, s82, 33792
    s_add_u32 s68, s82, 164864
    buffer_load_dwordx4 v27, s[52:55], s68 offen sc1 lds
    s_add_u32 m0, s82, 37888
    s_add_u32 s68, s82, 168960
    buffer_load_dwordx4 v27, s[52:55], s68 offen sc1 lds
    s_cmp_eq_u32 s81, 0
    s_cbranch_scc0 Lkv_29
    s_add_u32 m0, s82, 41984
    s_add_u32 s68, s82, 173056
    buffer_load_dwordx4 v27, s[52:55], s68 offen sc1 lds
Lkv_29:
    s_waitcnt vmcnt(10)
    s_barrier
    s_add_u32 m0, s82, 43008
    s_add_u32 s68, s82, 174080
    buffer_load_dwordx4 v27, s[52:55], s68 offen sc1 lds
    s_add_u32 m0, s82, 47104
    s_add_u32 s68, s82, 178176
    buffer_load_dwordx4 v27, s[52:55], s68 offen sc1 lds
    s_add_u32 m0, s82, 51200
    s_add_u32 s68, s82, 182272
    buffer_load_dwordx4 v27, s[52:55], s68 offen sc1 lds
    s_add_u32 m0, s82, 55296
    s_add_u32 s68, s82, 186368
    buffer_load_dwordx4 v27, s[52:55], s68 offen sc1 lds
    s_add_u32 m0, s82, 59392
    s_add_u32 s68, s82, 190464
    buffer_load_dwordx4 v27, s[52:55], s68 offen sc1 lds
    s_cmp_eq_u32 s81, 0
    s_cbranch_scc0 Lkv_30
    s_add_u32 m0, s82, 63488
    s_add_u32 s68, s82, 194560
    buffer_load_dwordx4 v27, s[52:55], s68 offen sc1 lds
Lkv_30:
    v_and_b32 v3, 31, v0
    v_lshrrev_b32 v2, 5, v0
    v_lshlrev_b32 v2, 2, v2
    v_sub_u32 v3, v3, v2
    v_mov_b32 v30, 4048155338
    v_cmp_gt_i32 s[86:87], 0, v3
    v_cmp_gt_i32 s[88:89], 1, v3
    s_nop 0
    v_cndmask_b32 v32, 0, v30, s[86:87]
    v_cndmask_b32 v48, v30, 0, s[86:87]
    v_cndmask_b32 v33, 0, v30, s[88:89]
    v_cndmask_b32 v49, v30, 0, s[88:89]
    v_cmp_gt_i32 s[86:87], 2, v3
    v_cmp_gt_i32 s[88:89], 3, v3
    s_nop 0
    v_cndmask_b32 v34, 0, v30, s[86:87]
    v_cndmask_b32 v50, v30, 0, s[86:87]
    v_cndmask_b32 v35, 0, v30, s[88:89]
    v_cndmask_b32 v51, v30, 0, s[88:89]
    v_cmp_gt_i32 s[86:87], 8, v3
    v_cmp_gt_i32 s[88:89], 9, v3
    s_nop 0
    v_cndmask_b32 v36, 0, v30, s[86:87]
    v_cndmask_b32 v52, v30, 0, s[86:87]
    v_cndmask_b32 v37, 0, v30, s[88:89]
    v_cndmask_b32 v53, v30, 0, s[88:89]
    v_cmp_gt_i32 s[86:87], 10, v3
    v_cmp_gt_i32 s[88:89], 11, v3
    s_nop 0
    v_cndmask_b32 v38, 0, v30, s[86:87]
    v_cndmask_b32 v54, v30, 0, s[86:87]
    v_cndmask_b32 v39, 0, v30, s[88:89]
    v_cndmask_b32 v55, v30, 0, s[88:89]
    v_cmp_gt_i32 s[86:87], 16, v3
    v_cmp_gt_i32 s[88:89], 17, v3
    s_nop 0
    v_cndmask_b32 v40, 0, v30, s[86:87]
    v_cndmask_b32 v56, v30, 0, s[86:87]
    v_cndmask_b32 v41, 0, v30, s[88:89]
    v_cndmask_b32 v57, v30, 0, s[88:89]
    v_cmp_gt_i32 s[86:87], 18, v3
    v_cmp_gt_i32 s[88:89], 19, v3
    s_nop 0
    v_cndmask_b32 v42, 0, v30, s[86:87]
    v_cndmask_b32 v58, v30, 0, s[86:87]
    v_cndmask_b32 v43, 0, v30, s[88:89]
    v_cndmask_b32 v59, v30, 0, s[88:89]
    v_cmp_gt_i32 s[86:87], 24, v3
    v_cmp_gt_i32 s[88:89], 25, v3
    s_nop 0
    v_cndmask_b32 v44, 0, v30, s[86:87]
    v_cndmask_b32 v60, v30, 0, s[86:87]
    v_cndmask_b32 v45, 0, v30, s[88:89]
    v_cndmask_b32 v61, v30, 0, s[88:89]
    v_cmp_gt_i32 s[86:87], 26, v3
    v_cmp_gt_i32 s[88:89], 27, v3
    s_nop 0
    v_cndmask_b32 v46, 0, v30, s[86:87]
    v_cndmask_b32 v62, v30, 0, s[86:87]
    v_cndmask_b32 v47, 0, v30, s[88:89]
    v_cndmask_b32 v63, v30, 0, s[88:89]
    s_mul_i32 s71, s2, 13108
    s_lshr_b32 s71, s71, 16
    s_mul_i32 s72, s71, 5
    s_sub_u32 s70, s2, s72
    s_lshl_b32 s70, s70, 3
    s_add_u32 s70, s70, s60
    s_mul_i32 s18, s71, 3277
    s_lshr_b32 s18, s18, 16
    s_mul_i32 s74, s18, 20
    s_sub_u32 s71, s71, s74
    s_mul_i32 s73, s70, 13108
    s_lshr_b32 s73, s73, 16
    s_mul_i32 s74, s73, 5
    s_sub_u32 s72, s70, s74
    s_lshl_b32 s74, s18, 3
    s_add_u32 s74, s74, s73
    s_mul_i32 s19, s74, 102400
    s_mul_i32 s73, s73, 160
    s_lshl_b32 s74, s72, 10
    s_add_u32 s19, s19, s74
    s_lshl_b32 s72, s72, 5
    v_mov_b32 v1, s72
    s_cmp_ge_u32 s71, 10
    s_cselect_b32 s72, 1, 0
    s_mul_i32 s74, s72, 19
    s_lshl_b32 s75, s71, 1
    s_sub_u32 s75, s75, s74
    s_mul_i32 s75, s75, 5120
    s_add_u32 s19, s19, s75
    s_add_u32 s19, s19, 14680064
    s_mul_i32 s72, s71, 13108
    s_lshr_b32 s72, s72, 16
    s_mul_i32 s74, s72, 5
    s_sub_u32 s71, s71, s74
    s_mul_i32 s72, s72, 160
    s_mul_i32 s74, s71, 40
    s_cmp_eq_u32 s71, 4
    s_cselect_b64 s[86:87], -1, 0
    s_cselect_b32 s74, 0, s74
    s_add_u32 s72, s72, s74
    s_mul_i32 s72, s72, 1280
    s_add_u32 s72, s72, s73
    v_bfe_u32 v2, v0, 3, 2
    v_lshrrev_b32 v3, 1, v2
    v_mul_u32_u24 v3, 20, v3
    v_and_b32 v30, 1, v2
    v_lshl_add_u32 v3, v30, 2, v3
    v_lshrrev_b32 v30, 5, v0
    v_lshl_add_u32 v3, v30, 3, v3
    v_mul_u32_u24 v2, 40, v2
    v_mul_u32_u24 v30, 20, v30
    v_add3_u32 v2, v2, v30, 16
    v_cndmask_b32 v2, v3, v2, s[86:87]
    v_bfe_u32 v3, v0, 1, 2
    v_add_u32 v2, v2, v3
    v_mul_u32_u24 v2, 1280, v2
    v_and_b32 v3, 1, v0
    v_lshl_add_u32 v2, v3, 4, v2
    v_add3_u32 v28, v2, v1, s72
    v_mov_b32 v232, 2130706432
    v_mov_b32 v233, 2130706432
    v_mov_b32 v234, 2130706432
    v_mov_b32 v235, 2130706432
    v_mov_b32 v236, 2130706432
    v_mov_b32 v237, 2130706432
    v_mov_b32 v238, 2130706432
    v_mov_b32 v239, 2130706432
    s_waitcnt vmcnt(5)
    s_barrier
L_attnB:
    v_mov_b32 v189, v27
    v_lshlrev_b32 v190, 3, v0
    v_and_b32 v1, 31, v0
    v_min_u32 v1, 21, v1
    v_lshrrev_b32 v2, 5, v0
    v_mul_u32_u24 v2, 352, v2
    v_lshl_add_u32 v188, v1, 4, v2
    v_mov_b32 v1, 64512
    v_mov_b32 v2, 0
    ds_write_b32 v1, v2
    s_cmp_eq_u32 s62, 15
    s_cselect_b32 s11, 8, s60
    ds_read_b128 v[160:163], v189 offset:0
    ds_read_b128 v[164:167], v189 offset:1024
    ds_read_b64 v[168:169], v190 offset:2048
    v_mov_b32 v224, 0x3f803f80
    v_mov_b32 v225, 0
    v_mov_b32 v227, 0
    v_mov_b32 v229, 0
    v_mov_b32 v230, 0
    v_mov_b32 v231, 0
    s_waitcnt lgkmcnt(1)
    v_mfma_f32_32x32x16_bf16 v[64:79], v[160:163], v[4:7], 0
    v_mfma_f32_32x32x16_bf16 v[80:95], v[164:167], v[4:7], 0
    s_waitcnt lgkmcnt(0)
    ds_read_b128 v[160:163], v189 offset:5376
    ds_read_b128 v[164:167], v189 offset:6400
    ds_read_b128 v[172:175], v188 offset:2560
    ds_read_b128 v[176:179], v188 offset:3264
    ds_read_b128 v[180:183], v188 offset:3968
    s_nop 3
    v_mfma_f32_32x32x4_2b_bf16 v[64:95], v[168:169], v[8:9], v[64:95]
    ds_read_b64 v[168:169], v190 offset:7424
    v_mfma_f32_32x32x8_bf16 v[128:143], v[224:225], v[230:231], 0
    s_nop 15
    s_nop 1
    v_max3_f32 v1, v64, v65, v66
    v_max3_f32 v1, v1, v67, v68
    v_max3_f32 v1, v1, v69, v70
    v_max3_f32 v1, v1, v71, v72
    v_max3_f32 v1, v1, v73, v74
    v_max3_f32 v1, v1, v75, v76
    v_max3_f32 v1, v1, v77, v78
    v_max3_f32 v1, v1, v79, v80
    v_max3_f32 v1, v1, v81, v82
    v_max3_f32 v1, v1, v83, v84
    v_max3_f32 v1, v1, v85, v86
    v_max3_f32 v1, v1, v87, v88
    v_max3_f32 v1, v1, v89, v90
    v_max3_f32 v1, v1, v91, v92
    v_max3_f32 v1, v1, v93, v94
    v_max_f32 v1, v1, v95
L_attnB_main:
    v_mov_b32 v2, v1
    s_nop 1
    v_permlane32_swap_b32 v1, v2
    s_nop 0
    v_max_f32 v2, v2, v1
    v_cvt_pk_bf16_f32 v1, 0, -v2
    v_sub_f32 v2, -v2, v1
    v_cvt_pk_bf16_f32 v226, v1, v2
    v_cndmask_b32 v228, v226, 0, s[84:85]
    s_nop 0
    v_mfma_f32_32x32x4_2b_bf16 v[64:95], v[224:225], v[226:227], v[64:95]
    v_mfma_f32_32x32x8_bf16 v[144:159], v[224:225], v[228:229], 0
    s_nop 15
    s_waitcnt lgkmcnt(4)
    v_mfma_f32_32x32x16_bf16 v[96:111], v[160:163], v[4:7], v[144:159]
    ds_read_b128 v[160:163], v189 offset:10752
    s_cmp_lt_u32 s11, 4
    s_cbranch_scc0 Lqs_31
    buffer_store_dwordx4 v[192:195], v232, s[52:55], 0 offen sc1
    buffer_store_dwordx4 v[196:199], v233, s[52:55], 0 offen sc1
    buffer_store_dwordx4 v[200:203], v234, s[52:55], 0 offen sc1
    buffer_store_dwordx4 v[204:207], v235, s[52:55], 0 offen sc1
Lqs_31:
    v_exp_f32 v64, v64
    v_exp_f32 v65, v65
    v_exp_f32 v66, v66
    ds_read_b128 v[184:187], v188 offset:4672
    v_exp_f32 v67, v67
    v_exp_f32 v68, v68
    v_exp_f32 v69, v69
    v_mfma_f32_32x32x16_bf16 v[112:127], v[164:167], v[4:7], v[144:159]
    ds_read_b128 v[164:167], v189 offset:11776
    v_exp_f32 v70, v70
    v_exp_f32 v71, v71
    v_exp_f32 v72, v72
    v_exp_f32 v73, v73
    s_waitcnt lgkmcnt(3)
    v_smfmac_f32_32x32x32_bf16 v[128:143], v[172:175], v[64:71], v16
    ds_read_b128 v[172:175], v188 offset:7936
    v_exp_f32 v74, v74
    v_exp_f32 v75, v75
    v_exp_f32 v76, v76
    v_exp_f32 v77, v77
    v_mfma_f32_32x32x4_2b_bf16 v[96:127], v[168:169], v[8:9], v[96:127]
    ds_read_b64 v[168:169], v190 offset:12800
    v_exp_f32 v78, v78
    v_exp_f32 v79, v79
    v_exp_f32 v80, v80
    v_exp_f32 v81, v81
    v_exp_f32 v82, v82
    v_exp_f32 v83, v83
    v_exp_f32 v84, v84
    v_exp_f32 v85, v85
    v_smfmac_f32_32x32x32_bf16 v[128:143], v[176:179], v[72:79], v16
    ds_read_b128 v[176:179], v188 offset:8640
    v_exp_f32 v86, v86
    v_exp_f32 v87, v87
    v_exp_f32 v88, v88
    v_exp_f32 v89, v89
    v_smfmac_f32_32x32x32_bf16 v[128:143], v[180:183], v[80:87], v16
    ds_read_b128 v[180:183], v188 offset:9344
    v_exp_f32 v90, v90
    v_exp_f32 v91, v91
    v_exp_f32 v92, v92
    v_exp_f32 v93, v93
    v_exp_f32 v94, v94
    v_exp_f32 v95, v95
    s_waitcnt lgkmcnt(4)
    v_mfma_f32_32x32x16_bf16 v[64:79], v[160:163], v[4:7], v[144:159]
    ds_read_b128 v[160:163], v189 offset:16128
    s_cmp_lt_u32 s11, 4
    s_cbranch_scc0 Lqs_32
    buffer_store_dwordx4 v[208:211], v236, s[52:55], 0 offen sc1
    buffer_store_dwordx4 v[212:215], v237, s[52:55], 0 offen sc1
    buffer_store_dwordx4 v[216:219], v238, s[52:55], 0 offen sc1
    buffer_store_dwordx4 v[220:223], v239, s[52:55], 0 offen sc1
Lqs_32:
    v_exp_f32 v96, v96
    v_exp_f32 v97, v97
    v_exp_f32 v98, v98
    v_smfmac_f32_32x32x32_bf16 v[128:143], v[184:187], v[88:95], v16
    ds_read_b128 v[184:187], v188 offset:10048
    v_exp_f32 v99, v99
    v_exp_f32 v100, v100
    v_exp_f32 v101, v101
    v_mfma_f32_32x32x16_bf16 v[80:95], v[164:167], v[4:7], v[144:159]
    ds_read_b128 v[164:167], v189 offset:17152
    v_exp_f32 v102, v102
    v_exp_f32 v103, v103
    v_exp_f32 v104, v104
    v_exp_f32 v105, v105
    s_waitcnt lgkmcnt(5)
    v_smfmac_f32_32x32x32_bf16 v[128:143], v[172:175], v[96:103], v16
    ds_read_b128 v[172:175], v188 offset:13312
    v_exp_f32 v106, v106
    v_exp_f32 v107, v107
    v_exp_f32 v108, v108
    v_exp_f32 v109, v109
    v_mfma_f32_32x32x4_2b_bf16 v[64:95], v[168:169], v[8:9], v[64:95]
    ds_read_b64 v[168:169], v190 offset:18176
    v_exp_f32 v110, v110
    v_exp_f32 v111, v111
    v_exp_f32 v112, v112
    v_exp_f32 v113, v113
    v_exp_f32 v114, v114
    v_exp_f32 v115, v115
    v_exp_f32 v116, v116
    v_exp_f32 v117, v117
    s_waitcnt lgkmcnt(5)
    v_smfmac_f32_32x32x32_bf16 v[128:143], v[176:179], v[104:111], v16
    ds_read_b128 v[176:179], v188 offset:14016
    v_exp_f32 v118, v118
    v_exp_f32 v119, v119
    v_exp_f32 v120, v120
    v_exp_f32 v121, v121
    v_smfmac_f32_32x32x32_bf16 v[128:143], v[180:183], v[112:119], v16
    ds_read_b128 v[180:183], v188 offset:14720
    v_exp_f32 v122, v122
    v_exp_f32 v123, v123
    v_exp_f32 v124, v124
    v_exp_f32 v125, v125
    v_exp_f32 v126, v126
    v_exp_f32 v127, v127
    s_waitcnt lgkmcnt(4)
    v_mfma_f32_32x32x16_bf16 v[96:111], v[160:163], v[4:7], v[144:159]
    ds_read_b128 v[160:163], v189 offset:21504
    v_exp_f32 v64, v64
    v_exp_f32 v65, v65
    v_exp_f32 v66, v66
    v_smfmac_f32_32x32x32_bf16 v[128:143], v[184:187], v[120:127], v16
    ds_read_b128 v[184:187], v188 offset:15424
    v_exp_f32 v67, v67
    v_exp_f32 v68, v68
    v_exp_f32 v69, v69
    v_mfma_f32_32x32x16_bf16 v[112:127], v[164:167], v[4:7], v[144:159]
    ds_read_b128 v[164:167], v189 offset:22528
    v_exp_f32 v70, v70
    v_exp_f32 v71, v71
    v_exp_f32 v72, v72
    v_exp_f32 v73, v73
    s_waitcnt lgkmcnt(5)
    v_smfmac_f32_32x32x32_bf16 v[128:143], v[172:175], v[64:71], v16
    ds_read_b128 v[172:175], v188 offset:18688
    v_exp_f32 v74, v74
    v_exp_f32 v75, v75
    v_exp_f32 v76, v76
    v_exp_f32 v77, v77
    v_mfma_f32_32x32x4_2b_bf16 v[96:127], v[168:169], v[8:9], v[96:127]
    ds_read_b64 v[168:169], v190 offset:23552
    v_exp_f32 v78, v78
    v_exp_f32 v79, v79
    v_exp_f32 v80, v80
    v_exp_f32 v81, v81
    v_exp_f32 v82, v82
    v_exp_f32 v83, v83
    v_exp_f32 v84, v84
    v_exp_f32 v85, v85
    s_waitcnt lgkmcnt(5)
    v_smfmac_f32_32x32x32_bf16 v[128:143], v[176:179], v[72:79], v16
    ds_read_b128 v[176:179], v188 offset:19392
    v_exp_f32 v86, v86
    v_exp_f32 v87, v87
    v_exp_f32 v88, v88
    v_exp_f32 v89, v89
    v_smfmac_f32_32x32x32_bf16 v[128:143], v[180:183], v[80:87], v16
    ds_read_b128 v[180:183], v188 offset:20096
    v_exp_f32 v90, v90
    v_exp_f32 v91, v91
    v_exp_f32 v92, v92
    v_exp_f32 v93, v93
    v_exp_f32 v94, v94
    v_exp_f32 v95, v95
    s_waitcnt lgkmcnt(4)
    v_mfma_f32_32x32x16_bf16 v[64:79], v[160:163], v[4:7], v[144:159]
    ds_read_b128 v[160:163], v189 offset:26880
    v_exp_f32 v96, v96
    v_exp_f32 v97, v97
    v_exp_f32 v98, v98
    v_smfmac_f32_32x32x32_bf16 v[128:143], v[184:187], v[88:95], v16
    ds_read_b128 v[184:187], v188 offset:20800
    v_exp_f32 v99, v99
    v_exp_f32 v100, v100
    v_exp_f32 v101, v101
    v_mfma_f32_32x32x16_bf16 v[80:95], v[164:167], v[4:7], v[144:159]
    ds_read_b128 v[164:167], v189 offset:27904
    v_exp_f32 v102, v102
    v_exp_f32 v103, v103
    v_exp_f32 v104, v104
    v_exp_f32 v105, v105
    s_waitcnt lgkmcnt(5)
    v_smfmac_f32_32x32x32_bf16 v[128:143], v[172:175], v[96:103], v16
    ds_read_b128 v[172:175], v188 offset:24064
    v_exp_f32 v106, v106
    v_exp_f32 v107, v107
    v_exp_f32 v108, v108
    v_exp_f32 v109, v109
    v_mfma_f32_32x32x4_2b_bf16 v[64:95], v[168:169], v[8:9], v[64:95]
    ds_read_b64 v[168:169], v190 offset:28928
    v_exp_f32 v110, v110
    v_exp_f32 v111, v111
    v_exp_f32 v112, v112
    v_exp_f32 v113, v113
    v_exp_f32 v114, v114
    v_exp_f32 v115, v115
    v_exp_f32 v116, v116
    v_exp_f32 v117, v117
    s_waitcnt lgkmcnt(5)
    v_smfmac_f32_32x32x32_bf16 v[128:143], v[176:179], v[104:111], v16
    ds_read_b128 v[176:179], v188 offset:24768
    v_exp_f32 v118, v118
    v_exp_f32 v119, v119
    v_exp_f32 v120, v120
    v_exp_f32 v121, v121
    v_smfmac_f32_32x32x32_bf16 v[128:143], v[180:183], v[112:119], v16
    ds_read_b128 v[180:183], v188 offset:25472
    v_exp_f32 v122, v122
    v_exp_f32 v123, v123
    v_exp_f32 v124, v124
    v_exp_f32 v125, v125
    v_exp_f32 v126, v126
    v_exp_f32 v127, v127
    s_waitcnt lgkmcnt(4)
    v_mfma_f32_32x32x16_bf16 v[96:111], v[160:163], v[4:7], v[144:159]
    ds_read_b128 v[160:163], v189 offset:32256
    v_exp_f32 v64, v64
    v_exp_f32 v65, v65
    v_exp_f32 v66, v66
    v_smfmac_f32_32x32x32_bf16 v[128:143], v[184:187], v[120:127], v16
    ds_read_b128 v[184:187], v188 offset:26176
    v_exp_f32 v67, v67
    v_exp_f32 v68, v68
    v_exp_f32 v69, v69
    v_mfma_f32_32x32x16_bf16 v[112:127], v[164:167], v[4:7], v[144:159]
    ds_read_b128 v[164:167], v189 offset:33280
    v_exp_f32 v70, v70
    v_exp_f32 v71, v71
    v_exp_f32 v72, v72
    v_exp_f32 v73, v73
    s_waitcnt lgkmcnt(5)
    v_smfmac_f32_32x32x32_bf16 v[128:143], v[172:175], v[64:71], v16
    ds_read_b128 v[172:175], v188 offset:29440
    v_exp_f32 v74, v74
    v_exp_f32 v75, v75
    v_exp_f32 v76, v76
    v_exp_f32 v77, v77
    v_mfma_f32_32x32x4_2b_bf16 v[96:127], v[168:169], v[8:9], v[96:127]
    ds_read_b64 v[168:169], v190 offset:34304
    v_exp_f32 v78, v78
    v_exp_f32 v79, v79
    v_exp_f32 v80, v80
    v_exp_f32 v81, v81
    v_exp_f32 v82, v82
    v_exp_f32 v83, v83
    v_exp_f32 v84, v84
    v_exp_f32 v85, v85
    s_waitcnt lgkmcnt(5)
    v_smfmac_f32_32x32x32_bf16 v[128:143], v[176:179], v[72:79], v16
    ds_read_b128 v[176:179], v188 offset:30144
    v_exp_f32 v86, v86
    v_exp_f32 v87, v87
    v_exp_f32 v88, v88
    v_exp_f32 v89, v89
    v_smfmac_f32_32x32x32_bf16 v[128:143], v[180:183], v[80:87], v16
    ds_read_b128 v[180:183], v188 offset:30848
    v_exp_f32 v90, v90
    v_exp_f32 v91, v91
    v_exp_f32 v92, v92
    v_exp_f32 v93, v93
    v_exp_f32 v94, v94
    v_exp_f32 v95, v95
    s_waitcnt lgkmcnt(4)
    v_mfma_f32_32x32x16_bf16 v[64:79], v[160:163], v[4:7], v[144:159]
    ds_read_b128 v[160:163], v189 offset:37632
    v_exp_f32 v96, v96
    v_exp_f32 v97, v97
    v_exp_f32 v98, v98
    v_smfmac_f32_32x32x32_bf16 v[128:143], v[184:187], v[88:95], v16
    ds_read_b128 v[184:187], v188 offset:31552
    v_exp_f32 v99, v99
    v_exp_f32 v100, v100
    v_exp_f32 v101, v101
    v_mfma_f32_32x32x16_bf16 v[80:95], v[164:167], v[4:7], v[144:159]
    ds_read_b128 v[164:167], v189 offset:38656
    v_exp_f32 v102, v102
    v_exp_f32 v103, v103
    v_exp_f32 v104, v104
    v_exp_f32 v105, v105
    s_waitcnt lgkmcnt(5)
    v_smfmac_f32_32x32x32_bf16 v[128:143], v[172:175], v[96:103], v16
    ds_read_b128 v[172:175], v188 offset:34816
    v_exp_f32 v106, v106
    v_exp_f32 v107, v107
    v_exp_f32 v108, v108
    v_exp_f32 v109, v109
    v_mfma_f32_32x32x4_2b_bf16 v[64:95], v[168:169], v[8:9], v[64:95]
    ds_read_b64 v[168:169], v190 offset:39680
    s_cmp_ge_u32 s60, 4
    s_setprio 0
    s_cbranch_scc1 Lp_33
    s_setprio 1
Lp_33:
    v_exp_f32 v110, v110
    v_exp_f32 v111, v111
    v_exp_f32 v112, v112
    v_exp_f32 v113, v113
    v_exp_f32 v114, v114
    v_exp_f32 v115, v115
    v_exp_f32 v116, v116
    v_exp_f32 v117, v117
    s_waitcnt lgkmcnt(5)
    v_smfmac_f32_32x32x32_bf16 v[128:143], v[176:179], v[104:111], v16
    ds_read_b128 v[176:179], v188 offset:35520
    v_exp_f32 v118, v118
    v_exp_f32 v119, v119
    v_exp_f32 v120, v120
    v_exp_f32 v121, v121
    v_smfmac_f32_32x32x32_bf16 v[128:143], v[180:183], v[112:119], v16
    ds_read_b128 v[180:183], v188 offset:36224
    v_exp_f32 v122, v122
    v_exp_f32 v123, v123
    v_exp_f32 v124, v124
    v_exp_f32 v125, v125
    v_exp_f32 v126, v126
    v_exp_f32 v127, v127
    s_cmp_lt_u32 s60, 4
    s_cbranch_scc1 Lw_34
    s_waitcnt vmcnt(0)
Lw_34:
    s_barrier
    s_waitcnt lgkmcnt(4)
    v_mfma_f32_32x32x16_bf16 v[96:111], v[160:163], v[4:7], v[144:159]
    ds_read_b128 v[160:163], v189 offset:43008
    s_add_u32 m0, s66, 0
    s_add_u32 s68, s66, 195584
    buffer_load_dwordx4 v27, s[52:55], s68 offen sc1 lds
    v_exp_f32 v64, v64
    v_exp_f32 v65, v65
    v_exp_f32 v66, v66
    v_smfmac_f32_32x32x32_bf16 v[128:143], v[184:187], v[120:127], v16
    ds_read_b128 v[184:187], v188 offset:36928
    v_exp_f32 v67, v67
    v_exp_f32 v68, v68
    v_exp_f32 v69, v69
    v_mfma_f32_32x32x16_bf16 v[112:127], v[164:167], v[4:7], v[144:159]
    ds_read_b128 v[164:167], v189 offset:44032
    s_add_u32 m0, s66, 8192
    s_add_u32 s68, s66, 203776
    buffer_load_dwordx4 v27, s[52:55], s68 offen sc1 lds
    v_exp_f32 v70, v70
    v_exp_f32 v71, v71
    v_exp_f32 v72, v72
    v_exp_f32 v73, v73
    s_waitcnt lgkmcnt(5)
    v_smfmac_f32_32x32x32_bf16 v[128:143], v[172:175], v[64:71], v16
    ds_read_b128 v[172:175], v188 offset:40192
    v_exp_f32 v74, v74
    v_exp_f32 v75, v75
    v_exp_f32 v76, v76
    v_exp_f32 v77, v77
    v_mfma_f32_32x32x4_2b_bf16 v[96:127], v[168:169], v[8:9], v[96:127]
    ds_read_b64 v[168:169], v190 offset:45056
    v_exp_f32 v78, v78
    v_exp_f32 v79, v79
    v_exp_f32 v80, v80
    v_exp_f32 v81, v81
    v_exp_f32 v82, v82
    v_exp_f32 v83, v83
    v_exp_f32 v84, v84
    v_exp_f32 v85, v85
    s_waitcnt lgkmcnt(5)
    v_smfmac_f32_32x32x32_bf16 v[128:143], v[176:179], v[72:79], v16
    ds_read_b128 v[176:179], v188 offset:40896
    v_exp_f32 v86, v86
    v_exp_f32 v87, v87
    v_exp_f32 v88, v88
    v_exp_f32 v89, v89
    v_smfmac_f32_32x32x32_bf16 v[128:143], v[180:183], v[80:87], v16
    ds_read_b128 v[180:183], v188 offset:41600
    v_exp_f32 v90, v90
    v_exp_f32 v91, v91
    v_exp_f32 v92, v92
    v_exp_f32 v93, v93
    v_exp_f32 v94, v94
    v_exp_f32 v95, v95
    s_cmp_ge_u32 s60, 4
    s_setprio 1
    s_cbranch_scc1 Lp_35
    s_setprio 0
Lp_35:
    s_waitcnt lgkmcnt(4)
    v_mfma_f32_32x32x16_bf16 v[64:79], v[160:163], v[4:7], v[144:159]
    ds_read_b128 v[160:163], v189 offset:48384
    s_cmp_ge_u32 s60, 5
    s_cbranch_scc1 Lkv_36
    s_add_u32 m0, s66, 16384
    s_add_u32 s68, s66, 211968
    buffer_load_dwordx4 v27, s[52:55], s68 offen sc1 lds
Lkv_36:
    v_exp_f32 v96, v96
    v_exp_f32 v97, v97
    v_exp_f32 v98, v98
    v_smfmac_f32_32x32x32_bf16 v[128:143], v[184:187], v[88:95], v16
    ds_read_b128 v[184:187], v188 offset:42304
    v_exp_f32 v99, v99
    v_exp_f32 v100, v100
    v_exp_f32 v101, v101
    v_mfma_f32_32x32x16_bf16 v[80:95], v[164:167], v[4:7], v[144:159]
    ds_read_b128 v[164:167], v189 offset:49408
    s_cmp_eq_u32 s18, 0
    s_cselect_b64 s[56:57], s[44:45], s[28:29]
    s_mov_b32 s58, 819200
    s_add_u32 m0, s66, 139264
    s_mov_b32 s59, 0x20000
    buffer_load_dwordx4 v28, s[56:59], 0 offen lds
    v_exp_f32 v102, v102
    v_exp_f32 v103, v103
    v_exp_f32 v104, v104
    v_exp_f32 v105, v105
    s_waitcnt lgkmcnt(5)
    v_smfmac_f32_32x32x32_bf16 v[128:143], v[172:175], v[96:103], v16
    ds_read_b128 v[172:175], v188 offset:45568
    v_exp_f32 v106, v106
    v_exp_f32 v107, v107
    v_exp_f32 v108, v108
    v_exp_f32 v109, v109
    v_mfma_f32_32x32x4_2b_bf16 v[64:95], v[168:169], v[8:9], v[64:95]
    ds_read_b64 v[168:169], v190 offset:50432
    v_exp_f32 v110, v110
    v_exp_f32 v111, v111
    v_exp_f32 v112, v112
    v_exp_f32 v113, v113
    v_exp_f32 v114, v114
    v_exp_f32 v115, v115
    v_exp_f32 v116, v116
    v_exp_f32 v117, v117
    s_waitcnt lgkmcnt(5)
    v_smfmac_f32_32x32x32_bf16 v[128:143], v[176:179], v[104:111], v16
    ds_read_b128 v[176:179], v188 offset:46272
    v_exp_f32 v118, v118
    v_exp_f32 v119, v119
    v_exp_f32 v120, v120
    v_exp_f32 v121, v121
    v_smfmac_f32_32x32x32_bf16 v[128:143], v[180:183], v[112:119], v16
    ds_read_b128 v[180:183], v188 offset:46976
    v_exp_f32 v122, v122
    v_exp_f32 v123, v123
    v_exp_f32 v124, v124
    v_exp_f32 v125, v125
    v_exp_f32 v126, v126
    v_exp_f32 v127, v127
    s_waitcnt lgkmcnt(4)
    v_mfma_f32_32x32x16_bf16 v[96:111], v[160:163], v[4:7], v[144:159]
    ds_read_b128 v[160:163], v189 offset:53760
    buffer_store_dwordx4 v[248:251], v18, s[52:55], 0 offen sc1
    v_exp_f32 v64, v64
    v_exp_f32 v65, v65
    v_exp_f32 v66, v66
    v_smfmac_f32_32x32x32_bf16 v[128:143], v[184:187], v[120:127], v16
    ds_read_b128 v[184:187], v188 offset:47680
    v_exp_f32 v67, v67
    v_exp_f32 v68, v68
    v_exp_f32 v69, v69
    v_mfma_f32_32x32x16_bf16 v[112:127], v[164:167], v[4:7], v[144:159]
    ds_read_b128 v[164:167], v189 offset:54784
    buffer_store_dwordx2 v[248:249], v19, s[52:55], 0 offen sc1
    v_exp_f32 v70, v70
    v_exp_f32 v71, v71
    v_exp_f32 v72, v72
    v_exp_f32 v73, v73
    s_waitcnt lgkmcnt(5)
    v_smfmac_f32_32x32x32_bf16 v[128:143], v[172:175], v[64:71], v16
    ds_read_b128 v[172:175], v188 offset:50944
    v_exp_f32 v74, v74
    v_exp_f32 v75, v75
    v_exp_f32 v76, v76
    v_exp_f32 v77, v77
    v_mfma_f32_32x32x4_2b_bf16 v[96:127], v[168:169], v[8:9], v[96:127]
    ds_read_b64 v[168:169], v190 offset:55808
    v_exp_f32 v78, v78
    v_exp_f32 v79, v79
    v_exp_f32 v80, v80
    v_exp_f32 v81, v81
    v_exp_f32 v82, v82
    v_exp_f32 v83, v83
    v_exp_f32 v84, v84
    v_exp_f32 v85, v85
    s_waitcnt lgkmcnt(5)
    v_smfmac_f32_32x32x32_bf16 v[128:143], v[176:179], v[72:79], v16
    ds_read_b128 v[176:179], v188 offset:51648
    v_exp_f32 v86, v86
    v_exp_f32 v87, v87
    v_exp_f32 v88, v88
    v_exp_f32 v89, v89
    v_smfmac_f32_32x32x32_bf16 v[128:143], v[180:183], v[80:87], v16
    ds_read_b128 v[180:183], v188 offset:52352
    v_exp_f32 v90, v90
    v_exp_f32 v91, v91
    v_exp_f32 v92, v92
    v_exp_f32 v93, v93
    v_exp_f32 v94, v94
    v_exp_f32 v95, v95
    s_waitcnt lgkmcnt(4)
    v_mfma_f32_32x32x16_bf16 v[64:79], v[160:163], v[4:7], v[144:159]
    ds_read_b128 v[160:163], v189 offset:59136
    buffer_store_dwordx4 v[248:251], v20, s[52:55], 0 offen sc1
    v_exp_f32 v96, v96
    v_exp_f32 v97, v97
    v_exp_f32 v98, v98
    v_smfmac_f32_32x32x32_bf16 v[128:143], v[184:187], v[88:95], v16
    ds_read_b128 v[184:187], v188 offset:53056
    v_exp_f32 v99, v99
    v_exp_f32 v100, v100
    v_exp_f32 v101, v101
    v_mfma_f32_32x32x16_bf16 v[80:95], v[164:167], v[4:7], v[144:159]
    ds_read_b128 v[164:167], v189 offset:60160
    buffer_store_dwordx2 v[248:249], v21, s[52:55], 0 offen sc1
    v_exp_f32 v102, v102
    v_exp_f32 v103, v103
    v_exp_f32 v104, v104
    v_exp_f32 v105, v105
    s_waitcnt lgkmcnt(5)
    v_smfmac_f32_32x32x32_bf16 v[128:143], v[172:175], v[96:103], v16
    ds_read_b128 v[172:175], v188 offset:56320
    v_exp_f32 v106, v106
    v_exp_f32 v107, v107
    v_exp_f32 v108, v108
    v_exp_f32 v109, v109
    v_mfma_f32_32x32x4_2b_bf16 v[64:95], v[168:169], v[8:9], v[64:95]
    ds_read_b64 v[168:169], v190 offset:61184
    s_cmp_ge_u32 s60, 4
    s_setprio 0
    s_cbranch_scc1 Lp_37
    s_setprio 1
Lp_37:
    v_exp_f32 v110, v110
    v_exp_f32 v111, v111
    v_exp_f32 v112, v112
    v_exp_f32 v113, v113
    v_exp_f32 v114, v114
    v_exp_f32 v115, v115
    v_exp_f32 v116, v116
    v_exp_f32 v117, v117
    s_waitcnt lgkmcnt(5)
    v_smfmac_f32_32x32x32_bf16 v[128:143], v[176:179], v[104:111], v16
    ds_read_b128 v[176:179], v188 offset:57024
    v_exp_f32 v118, v118
    v_exp_f32 v119, v119
    v_exp_f32 v120, v120
    v_exp_f32 v121, v121
    v_smfmac_f32_32x32x32_bf16 v[128:143], v[180:183], v[112:119], v16
    ds_read_b128 v[180:183], v188 offset:57728
    v_exp_f32 v122, v122
    v_exp_f32 v123, v123
    v_exp_f32 v124, v124
    v_exp_f32 v125, v125
    v_exp_f32 v126, v126
    v_exp_f32 v127, v127
    s_waitcnt vmcnt(5)
    s_barrier
    s_cmp_eq_u32 s60, 0
    s_cbranch_scc0 Lf2_38
    s_lshl_b32 s70, s2, 2
    s_add_u32 s70, s70, 65536
    v_mov_b32 v1, s70
    buffer_store_dword v17, v1, s[52:55], 0 offen sc1
Lf2_38:
    s_waitcnt lgkmcnt(4)
    v_mfma_f32_32x32x16_bf16 v[96:111], v[160:163], v[4:7], v[144:159]
    ds_read_b128 v[160:163], v189 offset:0
    s_add_u32 m0, s66, 21504
    s_add_u32 s68, s66, 217088
    buffer_load_dwordx4 v27, s[52:55], s68 offen sc1 lds
    v_exp_f32 v64, v64
    v_exp_f32 v65, v65
    v_exp_f32 v66, v66
    v_smfmac_f32_32x32x32_bf16 v[128:143], v[184:187], v[120:127], v16
    ds_read_b128 v[184:187], v188 offset:58432
    v_exp_f32 v67, v67
    v_exp_f32 v68, v68
    v_exp_f32 v69, v69
    v_mfma_f32_32x32x16_bf16 v[112:127], v[164:167], v[4:7], v[144:159]
    ds_read_b128 v[164:167], v189 offset:1024
    v_exp_f32 v70, v70
    v_exp_f32 v71, v71
    v_exp_f32 v72, v72
    v_exp_f32 v73, v73
    s_waitcnt lgkmcnt(5)
    v_smfmac_f32_32x32x32_bf16 v[128:143], v[172:175], v[64:71], v16
    ds_read_b128 v[172:175], v188 offset:61696
    v_exp_f32 v74, v74
    v_exp_f32 v75, v75
    v_exp_f32 v76, v76
    v_exp_f32 v77, v77
    v_mfma_f32_32x32x4_2b_bf16 v[96:127], v[168:169], v[8:9], v[96:127]
    ds_read_b64 v[168:169], v190 offset:2048
    v_exp_f32 v78, v78
    v_exp_f32 v79, v79
    v_exp_f32 v80, v80
    v_exp_f32 v81, v81
    v_exp_f32 v82, v82
    v_exp_f32 v83, v83
    v_exp_f32 v84, v84
    v_exp_f32 v85, v85
    s_waitcnt lgkmcnt(5)
    v_smfmac_f32_32x32x32_bf16 v[128:143], v[176:179], v[72:79], v16
    ds_read_b128 v[176:179], v188 offset:62400
    v_exp_f32 v86, v86
    v_exp_f32 v87, v87
    v_exp_f32 v88, v88
    v_exp_f32 v89, v89
    v_smfmac_f32_32x32x32_bf16 v[128:143], v[180:183], v[80:87], v16
    ds_read_b128 v[180:183], v188 offset:63104
    v_exp_f32 v90, v90
    v_exp_f32 v91, v91
    v_exp_f32 v92, v92
    v_exp_f32 v93, v93
    v_exp_f32 v94, v94
    v_exp_f32 v95, v95
    s_cmp_ge_u32 s60, 4
    s_setprio 1
    s_cbranch_scc1 Lp_39
    s_setprio 0
Lp_39:
    s_waitcnt lgkmcnt(4)
    v_mfma_f32_32x32x16_bf16 v[64:79], v[160:163], v[4:7], v[144:159]
    ds_read_b128 v[160:163], v189 offset:5376
    s_add_u32 m0, s66, 29696
    s_add_u32 s68, s66, 225280
    buffer_load_dwordx4 v27, s[52:55], s68 offen sc1 lds
    v_exp_f32 v96, v96
    v_exp_f32 v97, v97
    v_exp_f32 v98, v98
    v_smfmac_f32_32x32x32_bf16 v[128:143], v[184:187], v[88:95], v16
    ds_read_b128 v[184:187], v188 offset:63808
    v_exp_f32 v99, v99
    v_exp_f32 v100, v100
    v_exp_f32 v101, v101
    v_mfma_f32_32x32x16_bf16 v[80:95], v[164:167], v[4:7], v[144:159]
    ds_read_b128 v[164:167], v189 offset:6400
    v_exp_f32 v102, v102
    v_exp_f32 v103, v103
    v_exp_f32 v104, v104
    v_exp_f32 v105, v105
    s_waitcnt lgkmcnt(5)
    v_smfmac_f32_32x32x32_bf16 v[128:143], v[172:175], v[96:103], v16
    ds_read_b128 v[172:175], v188 offset:2560
    v_exp_f32 v106, v106
    v_exp_f32 v107, v107
    v_exp_f32 v108, v108
    v_exp_f32 v109, v109
    v_mfma_f32_32x32x4_2b_bf16 v[64:95], v[168:169], v[8:9], v[64:95]
    ds_read_b64 v[168:169], v190 offset:7424
    v_exp_f32 v110, v110
    v_exp_f32 v111, v111
    v_exp_f32 v112, v112
    v_exp_f32 v113, v113
    v_exp_f32 v114, v114
    v_exp_f32 v115, v115
    v_exp_f32 v116, v116
    v_exp_f32 v117, v117
    s_waitcnt lgkmcnt(5)
    v_smfmac_f32_32x32x32_bf16 v[128:143], v[176:179], v[104:111], v16
    ds_read_b128 v[176:179], v188 offset:3264
    v_exp_f32 v118, v118
    v_exp_f32 v119, v119
    v_exp_f32 v120, v120
    v_exp_f32 v121, v121
    v_smfmac_f32_32x32x32_bf16 v[128:143], v[180:183], v[112:119], v16
    ds_read_b128 v[180:183], v188 offset:3968
    v_exp_f32 v122, v122
    v_exp_f32 v123, v123
    v_exp_f32 v124, v124
    v_exp_f32 v125, v125
    v_exp_f32 v126, v126
    v_exp_f32 v127, v127
    s_waitcnt lgkmcnt(4)
    v_mfma_f32_32x32x16_bf16 v[96:111], v[160:163], v[4:7], v[144:159]
    ds_read_b128 v[160:163], v189 offset:10752
    s_cmp_ge_u32 s60, 5
    s_cbranch_scc1 Lkv_40
    s_add_u32 m0, s66, 37888
    s_add_u32 s68, s66, 233472
    buffer_load_dwordx4 v27, s[52:55], s68 offen sc1 lds
Lkv_40:
    v_exp_f32 v64, v64
    v_exp_f32 v65, v65
    v_exp_f32 v66, v66
    v_smfmac_f32_32x32x32_bf16 v[128:143], v[184:187], v[120:127], v16
    ds_read_b128 v[184:187], v188 offset:4672
    v_exp_f32 v67, v67
    v_exp_f32 v68, v68
    v_exp_f32 v69, v69
    v_mfma_f32_32x32x16_bf16 v[112:127], v[164:167], v[4:7], v[144:159]
    ds_read_b128 v[164:167], v189 offset:11776
    s_add_u32 s70, s66, 139264
    v_lshlrev_b32 v1, 3, v0
    v_add_u32 v1, s70, v1
    s_waitcnt vmcnt(6)
    ds_read_b64_tr_b16 v[232:233], v1 offset:0
    ds_read_b64_tr_b16 v[234:235], v1 offset:512
    v_exp_f32 v70, v70
    v_exp_f32 v71, v71
    v_exp_f32 v72, v72
    v_exp_f32 v73, v73
    s_waitcnt lgkmcnt(7)
    v_smfmac_f32_32x32x32_bf16 v[128:143], v[172:175], v[64:71], v16
    ds_read_b128 v[172:175], v188 offset:7936
    v_exp_f32 v74, v74
    v_exp_f32 v75, v75
    v_exp_f32 v76, v76
    v_exp_f32 v77, v77
    v_mfma_f32_32x32x4_2b_bf16 v[96:127], v[168:169], v[8:9], v[96:127]
    ds_read_b64 v[168:169], v190 offset:12800
    s_waitcnt lgkmcnt(2)
    s_cmp_lt_u32 s18, 2
    s_cbranch_scc0 Lrp_41
    buffer_store_dwordx4 v[232:235], v27, s[52:55], s19 offen sc1
Lrp_41:
    v_exp_f32 v78, v78
    v_exp_f32 v79, v79
    v_exp_f32 v80, v80
    v_exp_f32 v81, v81
    v_exp_f32 v82, v82
    v_exp_f32 v83, v83
    v_exp_f32 v84, v84
    v_exp_f32 v85, v85
    v_smfmac_f32_32x32x32_bf16 v[128:143], v[176:179], v[72:79], v16
    ds_read_b128 v[176:179], v188 offset:8640
    v_exp_f32 v86, v86
    v_exp_f32 v87, v87
    v_exp_f32 v88, v88
    v_exp_f32 v89, v89
    v_smfmac_f32_32x32x32_bf16 v[128:143], v[180:183], v[80:87], v16
    ds_read_b128 v[180:183], v188 offset:9344
    v_exp_f32 v90, v90
    v_exp_f32 v91, v91
    v_exp_f32 v92, v92
    v_exp_f32 v93, v93
    v_exp_f32 v94, v94
    v_exp_f32 v95, v95
    v_mfma_f32_32x32x16_bf16 v[64:79], v[160:163], v[4:7], v[144:159]
    ds_read_b128 v[160:163], v189 offset:16128
    s_mul_i32 s42, s64, 102400
    s_add_u32 s42, s42, s66
    s_add_u32 s42, s42, 14680064
    s_cmp_eq_u32 s60, 0
    s_cbranch_scc0 Lpi_42
    s_mov_b32 s68, 65536
    buffer_load_dwordx4 v[22:25], v27, s[52:55], s68 offen sc1
Lpi_42:
    v_exp_f32 v96, v96
    v_exp_f32 v97, v97
    v_exp_f32 v98, v98
    v_smfmac_f32_32x32x32_bf16 v[128:143], v[184:187], v[88:95], v16
    ds_read_b128 v[184:187], v188 offset:10048
    v_exp_f32 v99, v99
    v_exp_f32 v100, v100
    v_exp_f32 v101, v101
    v_mfma_f32_32x32x16_bf16 v[80:95], v[164:167], v[4:7], v[144:159]
    ds_read_b128 v[164:167], v189 offset:17152
    v_exp_f32 v102, v102
    v_exp_f32 v103, v103
    v_exp_f32 v104, v104
    v_exp_f32 v105, v105
    s_waitcnt lgkmcnt(5)
    v_smfmac_f32_32x32x32_bf16 v[128:143], v[172:175], v[96:103], v16
    ds_read_b128 v[172:175], v188 offset:13312
    v_exp_f32 v106, v106
    v_exp_f32 v107, v107
    v_exp_f32 v108, v108
    v_exp_f32 v109, v109
    v_mfma_f32_32x32x4_2b_bf16 v[64:95], v[168:169], v[8:9], v[64:95]
    ds_read_b64 v[168:169], v190 offset:18176
    s_cmp_ge_u32 s60, 4
    s_setprio 0
    s_cbranch_scc1 Lp_43
    s_setprio 1
Lp_43:
    v_exp_f32 v110, v110
    v_exp_f32 v111, v111
    v_exp_f32 v112, v112
    v_exp_f32 v113, v113
    v_exp_f32 v114, v114
    v_exp_f32 v115, v115
    v_exp_f32 v116, v116
    v_exp_f32 v117, v117
    s_waitcnt lgkmcnt(5)
    v_smfmac_f32_32x32x32_bf16 v[128:143], v[176:179], v[104:111], v16
    ds_read_b128 v[176:179], v188 offset:14016
    v_exp_f32 v118, v118
    v_exp_f32 v119, v119
    v_exp_f32 v120, v120
    v_exp_f32 v121, v121
    v_smfmac_f32_32x32x32_bf16 v[128:143], v[180:183], v[112:119], v16
    ds_read_b128 v[180:183], v188 offset:14720
    v_exp_f32 v122, v122
    v_exp_f32 v123, v123
    v_exp_f32 v124, v124
    v_exp_f32 v125, v125
    v_exp_f32 v126, v126
    v_exp_f32 v127, v127
    s_cmp_eq_u32 s60, 0
    s_cbranch_scc0 Lok_44
    s_waitcnt vmcnt(0)
Lpoll_45:
    v_xor_b32 v1, v17, v22
    v_xor_b32 v2, v17, v23
    v_xor_b32 v3, v17, v24
    v_or3_b32 v1, v1, v2, v3
    v_xor_b32 v2, v17, v25
    v_or_b32 v1, v1, v2
    v_cmp_ne_u32 vcc, 0, v1
    s_nop 0
    s_cbranch_vccz Lok_44
    s_sub_u32 s80, s80, 1
    s_cbranch_scc1 L_end
    s_mov_b32 s68, 65536
    buffer_load_dwordx4 v[22:25], v27, s[52:55], s68 offen sc1
    s_waitcnt vmcnt(0)
    s_branch Lpoll_45
Lok_44:
    s_waitcnt vmcnt(0)
    s_barrier
    s_cmp_eq_u32 s60, 0
    s_cbranch_scc0 Lf2_46
    s_lshl_b32 s70, s2, 2
    s_add_u32 s70, s70, 98304
    v_mov_b32 v1, s70
    buffer_store_dword v17, v1, s[52:55], 0 offen sc1
Lf2_46:
    s_waitcnt lgkmcnt(4)
    v_mfma_f32_32x32x16_bf16 v[96:111], v[160:163], v[4:7], v[144:159]
    ds_read_b128 v[160:163], v189 offset:21504
    s_add_u32 m0, s66, 43008
    s_add_u32 s68, s66, 238592
    buffer_load_dwordx4 v27, s[52:55], s68 offen sc1 lds
    v_exp_f32 v64, v64
    v_exp_f32 v65, v65
    v_exp_f32 v66, v66
    v_smfmac_f32_32x32x32_bf16 v[128:143], v[184:187], v[120:127], v16
    ds_read_b128 v[184:187], v188 offset:15424
    v_exp_f32 v67, v67
    v_exp_f32 v68, v68
    v_exp_f32 v69, v69
    v_mfma_f32_32x32x16_bf16 v[112:127], v[164:167], v[4:7], v[144:159]
    ds_read_b128 v[164:167], v189 offset:22528
    s_add_u32 m0, s66, 51200
    s_add_u32 s68, s66, 246784
    buffer_load_dwordx4 v27, s[52:55], s68 offen sc1 lds
    v_exp_f32 v70, v70
    v_exp_f32 v71, v71
    v_exp_f32 v72, v72
    v_exp_f32 v73, v73
    s_waitcnt lgkmcnt(5)
    v_smfmac_f32_32x32x32_bf16 v[128:143], v[172:175], v[64:71], v16
    ds_read_b128 v[172:175], v188 offset:18688
    v_exp_f32 v74, v74
    v_exp_f32 v75, v75
    v_exp_f32 v76, v76
    v_exp_f32 v77, v77
    v_mfma_f32_32x32x4_2b_bf16 v[96:127], v[168:169], v[8:9], v[96:127]
    ds_read_b64 v[168:169], v190 offset:23552
    s_cmp_ge_u32 s60, 5
    s_cbranch_scc1 Lkv_47
    s_add_u32 m0, s66, 59392
    s_add_u32 s68, s66, 254976
    buffer_load_dwordx4 v27, s[52:55], s68 offen sc1 lds
Lkv_47:
    v_exp_f32 v78, v78
    v_exp_f32 v79, v79
    v_exp_f32 v80, v80
    v_exp_f32 v81, v81
    v_exp_f32 v82, v82
    v_exp_f32 v83, v83
    v_exp_f32 v84, v84
    v_exp_f32 v85, v85
    s_waitcnt lgkmcnt(5)
    v_smfmac_f32_32x32x32_bf16 v[128:143], v[176:179], v[72:79], v16
    ds_read_b128 v[176:179], v188 offset:19392
    v_exp_f32 v86, v86
    v_exp_f32 v87, v87
    v_exp_f32 v88, v88
    v_exp_f32 v89, v89
    v_smfmac_f32_32x32x32_bf16 v[128:143], v[180:183], v[80:87], v16
    ds_read_b128 v[180:183], v188 offset:20096
    v_exp_f32 v90, v90
    v_exp_f32 v91, v91
    v_exp_f32 v92, v92
    v_exp_f32 v93, v93
    v_exp_f32 v94, v94
    v_exp_f32 v95, v95
    s_cmp_ge_u32 s60, 4
    s_setprio 1
    s_cbranch_scc1 Lp_48
    s_setprio 0
Lp_48:
    s_waitcnt lgkmcnt(4)
    v_mfma_f32_32x32x16_bf16 v[64:79], v[160:163], v[4:7], v[144:159]
    ds_read_b128 v[160:163], v189 offset:26880
    s_lshr_b32 s8, s60, 2
    s_mul_i32 s9, s8, 34816
    s_add_u32 s9, s9, s82
    s_lshl_b32 s71, s62, 1
    s_add_u32 s8, s8, s71
    s_lshl_b32 s8, s8, 4
    s_add_u32 s8, s8, s61
    s_mul_i32 s8, s8, 11520
    s_add_u32 s8, s8, s82
    s_add_u32 m0, s9, 65536
    s_add_u32 s68, s8, 501248
    buffer_load_dwordx4 v27, s[52:55], s68 offen sc1 lds
    v_exp_f32 v96, v96
    v_exp_f32 v97, v97
    v_exp_f32 v98, v98
    v_smfmac_f32_32x32x32_bf16 v[128:143], v[184:187], v[88:95], v16
    ds_read_b128 v[184:187], v188 offset:20800
    v_exp_f32 v99, v99
    v_exp_f32 v100, v100
    v_exp_f32 v101, v101
    v_mfma_f32_32x32x16_bf16 v[80:95], v[164:167], v[4:7], v[144:159]
    ds_read_b128 v[164:167], v189 offset:27904
    s_add_u32 m0, s9, 69632
    s_add_u32 s68, s8, 505344
    buffer_load_dwordx4 v27, s[52:55], s68 offen sc1 lds
    v_exp_f32 v102, v102
    v_exp_f32 v103, v103
    v_exp_f32 v104, v104
    v_exp_f32 v105, v105
    s_waitcnt lgkmcnt(5)
    v_smfmac_f32_32x32x32_bf16 v[128:143], v[172:175], v[96:103], v16
    ds_read_b128 v[172:175], v188 offset:24064
    v_exp_f32 v106, v106
    v_exp_f32 v107, v107
    v_exp_f32 v108, v108
    v_exp_f32 v109, v109
    v_mfma_f32_32x32x4_2b_bf16 v[64:95], v[168:169], v[8:9], v[64:95]
    ds_read_b64 v[168:169], v190 offset:28928
    s_add_u32 m0, s9, 73728
    s_add_u32 s68, s8, 509440
    buffer_load_dwordx4 v27, s[52:55], s68 offen sc1 lds
    v_exp_f32 v110, v110
    v_exp_f32 v111, v111
    v_exp_f32 v112, v112
    v_exp_f32 v113, v113
    v_exp_f32 v114, v114
    v_exp_f32 v115, v115
    v_exp_f32 v116, v116
    v_exp_f32 v117, v117
    s_waitcnt lgkmcnt(5)
    v_smfmac_f32_32x32x32_bf16 v[128:143], v[176:179], v[104:111], v16
    ds_read_b128 v[176:179], v188 offset:24768
    v_exp_f32 v118, v118
    v_exp_f32 v119, v119
    v_exp_f32 v120, v120
    v_exp_f32 v121, v121
    v_smfmac_f32_32x32x32_bf16 v[128:143], v[180:183], v[112:119], v16
    ds_read_b128 v[180:183], v188 offset:25472
    v_exp_f32 v122, v122
    v_exp_f32 v123, v123
    v_exp_f32 v124, v124
    v_exp_f32 v125, v125
    v_exp_f32 v126, v126
    v_exp_f32 v127, v127
    s_waitcnt lgkmcnt(4)
    v_mfma_f32_32x32x16_bf16 v[96:111], v[160:163], v[4:7], v[144:159]
    ds_read_b128 v[160:163], v189 offset:32256
    s_add_u32 m0, s9, 77824
    s_add_u32 s68, s8, 513536
    buffer_load_dwordx4 v27, s[52:55], s68 offen sc1 lds
    v_exp_f32 v64, v64
    v_exp_f32 v65, v65
    v_exp_f32 v66, v66
    v_smfmac_f32_32x32x32_bf16 v[128:143], v[184:187], v[120:127], v16
    ds_read_b128 v[184:187], v188 offset:26176
    v_exp_f32 v67, v67
    v_exp_f32 v68, v68
    v_exp_f32 v69, v69
    v_mfma_f32_32x32x16_bf16 v[112:127], v[164:167], v[4:7], v[144:159]
    ds_read_b128 v[164:167], v189 offset:33280
    s_add_u32 m0, s9, 81920
    s_add_u32 s68, s8, 517632
    buffer_load_dwordx4 v27, s[52:55], s68 offen sc1 lds
    v_exp_f32 v70, v70
    v_exp_f32 v71, v71
    v_exp_f32 v72, v72
    v_exp_f32 v73, v73
    s_waitcnt lgkmcnt(5)
    v_smfmac_f32_32x32x32_bf16 v[128:143], v[172:175], v[64:71], v16
    ds_read_b128 v[172:175], v188 offset:29440
    v_exp_f32 v74, v74
    v_exp_f32 v75, v75
    v_exp_f32 v76, v76
    v_exp_f32 v77, v77
    v_mfma_f32_32x32x4_2b_bf16 v[96:127], v[168:169], v[8:9], v[96:127]
    ds_read_b64 v[168:169], v190 offset:34304
    s_add_u32 m0, s9, 86016
    s_add_u32 s68, s8, 521728
    buffer_load_dwordx4 v27, s[52:55], s68 offen sc1 lds
    v_exp_f32 v78, v78
    v_exp_f32 v79, v79
    v_exp_f32 v80, v80
    v_exp_f32 v81, v81
    v_exp_f32 v82, v82
    v_exp_f32 v83, v83
    v_exp_f32 v84, v84
    v_exp_f32 v85, v85
    s_waitcnt lgkmcnt(5)
    v_smfmac_f32_32x32x32_bf16 v[128:143], v[176:179], v[72:79], v16
    ds_read_b128 v[176:179], v188 offset:30144
    v_exp_f32 v86, v86
    v_exp_f32 v87, v87
    v_exp_f32 v88, v88
    v_exp_f32 v89, v89
    v_smfmac_f32_32x32x32_bf16 v[128:143], v[180:183], v[80:87], v16
    ds_read_b128 v[180:183], v188 offset:30848
    v_exp_f32 v90, v90
    v_exp_f32 v91, v91
    v_exp_f32 v92, v92
    v_exp_f32 v93, v93
    v_exp_f32 v94, v94
    v_exp_f32 v95, v95
    s_waitcnt lgkmcnt(4)
    v_mfma_f32_32x32x16_bf16 v[64:79], v[160:163], v[4:7], v[144:159]
    ds_read_b128 v[160:163], v189 offset:37632
    s_add_u32 m0, s9, 90112
    s_add_u32 s68, s8, 525824
    buffer_load_dwordx4 v27, s[52:55], s68 offen sc1 lds
    v_exp_f32 v96, v96
    v_exp_f32 v97, v97
    v_exp_f32 v98, v98
    v_smfmac_f32_32x32x32_bf16 v[128:143], v[184:187], v[88:95], v16
    ds_read_b128 v[184:187], v188 offset:31552
    v_exp_f32 v99, v99
    v_exp_f32 v100, v100
    v_exp_f32 v101, v101
    v_mfma_f32_32x32x16_bf16 v[80:95], v[164:167], v[4:7], v[144:159]
    ds_read_b128 v[164:167], v189 offset:38656
    s_add_u32 m0, s9, 94208
    s_add_u32 s68, s8, 529920
    buffer_load_dwordx4 v27, s[52:55], s68 offen sc1 lds
    v_exp_f32 v102, v102
    v_exp_f32 v103, v103
    v_exp_f32 v104, v104
    v_exp_f32 v105, v105
    s_waitcnt lgkmcnt(5)
    v_smfmac_f32_32x32x32_bf16 v[128:143], v[172:175], v[96:103], v16
    ds_read_b128 v[172:175], v188 offset:34816
    v_exp_f32 v106, v106
    v_exp_f32 v107, v107
    v_exp_f32 v108, v108
    v_exp_f32 v109, v109
    v_mfma_f32_32x32x4_2b_bf16 v[64:95], v[168:169], v[8:9], v[64:95]
    ds_read_b64 v[168:169], v190 offset:39680
    s_cmp_ge_u32 s60, 4
    s_setprio 0
    s_cbranch_scc1 Lp_49
    s_setprio 1
Lp_49:
    s_cmp_lt_u32 s81, 2
    s_cbranch_scc0 Lka_50
    s_add_u32 m0, s9, 98304
    s_add_u32 s68, s8, 534016
    buffer_load_dwordx4 v27, s[52:55], s68 offen sc1 lds
Lka_50:
    v_exp_f32 v110, v110
    v_exp_f32 v111, v111
    v_exp_f32 v112, v112
    v_exp_f32 v113, v113
    v_exp_f32 v114, v114
    v_exp_f32 v115, v115
    v_exp_f32 v116, v116
    v_exp_f32 v117, v117
    s_waitcnt lgkmcnt(5)
    v_smfmac_f32_32x32x32_bf16 v[128:143], v[176:179], v[104:111], v16
    ds_read_b128 v[176:179], v188 offset:35520
    v_exp_f32 v118, v118
    v_exp_f32 v119, v119
    v_exp_f32 v120, v120
    v_exp_f32 v121, v121
    v_smfmac_f32_32x32x32_bf16 v[128:143], v[180:183], v[112:119], v16
    ds_read_b128 v[180:183], v188 offset:36224
    v_exp_f32 v122, v122
    v_exp_f32 v123, v123
    v_exp_f32 v124, v124
    v_exp_f32 v125, v125
    v_exp_f32 v126, v126
    v_exp_f32 v127, v127
    s_waitcnt vmcnt(8)
    s_barrier
    s_waitcnt lgkmcnt(4)
    v_mfma_f32_32x32x16_bf16 v[96:111], v[160:163], v[4:7], v[144:159]
    ds_read_b128 v[160:163], v189 offset:43008
    s_add_u32 m0, s66, 0
    s_add_u32 s68, s66, 260096
    buffer_load_dwordx4 v27, s[52:55], s68 offen sc1 lds
    v_exp_f32 v64, v64
    v_exp_f32 v65, v65
    v_exp_f32 v66, v66
    v_smfmac_f32_32x32x32_bf16 v[128:143], v[184:187], v[120:127], v16
    ds_read_b128 v[184:187], v188 offset:36928
    v_exp_f32 v67, v67
    v_exp_f32 v68, v68
    v_exp_f32 v69, v69
    v_mfma_f32_32x32x16_bf16 v[112:127], v[164:167], v[4:7], v[144:159]
    ds_read_b128 v[164:167], v189 offset:44032
    s_and_b32 s70, s60, 1
    s_lshl_b32 s71, s62, 1
    s_add_u32 s70, s70, s71
    s_lshl_b32 s70, s70, 4
    s_add_u32 s70, s70, s61
    s_lshl_b32 s70, s70, 1
    s_lshr_b32 s71, s83, 1
    s_add_u32 s70, s70, s71
    s_mul_i32 s70, s70, 2560
    s_and_b32 s71, s83, 1
    s_lshl_b32 s71, s71, 3
    s_add_u32 s70, s70, s71
    s_add_u32 s70, s70, 6815744
    v_mov_b32 v2, 2130706432
    v_cndmask_b32 v2, v27, v2, s[84:85]
    buffer_load_dwordx2 v[12:13], v27, s[52:55], s70 offen sc1
    buffer_load_dwordx2 v[14:15], v27, s[52:55], s70 offen offset:1024 sc1
    buffer_load_dwordx2 v[10:11], v2, s[52:55], s70 offen offset:2048 sc1
    v_exp_f32 v70, v70
    v_exp_f32 v71, v71
    v_exp_f32 v72, v72
    v_exp_f32 v73, v73
    s_waitcnt lgkmcnt(5)
    v_smfmac_f32_32x32x32_bf16 v[128:143], v[172:175], v[64:71], v16
    ds_read_b128 v[172:175], v188 offset:40192
    v_exp_f32 v74, v74
    v_exp_f32 v75, v75
    v_exp_f32 v76, v76
    v_exp_f32 v77, v77
    v_mfma_f32_32x32x4_2b_bf16 v[96:127], v[168:169], v[8:9], v[96:127]
    ds_read_b64 v[168:169], v190 offset:45056
    v_exp_f32 v78, v78
    v_exp_f32 v79, v79
    v_exp_f32 v80, v80
    v_exp_f32 v81, v81
    v_exp_f32 v82, v82
    v_exp_f32 v83, v83
    v_exp_f32 v84, v84
    v_exp_f32 v85, v85
    s_waitcnt lgkmcnt(5)
    v_smfmac_f32_32x32x32_bf16 v[128:143], v[176:179], v[72:79], v16
    ds_read_b128 v[176:179], v188 offset:40896
    v_exp_f32 v86, v86
    v_exp_f32 v87, v87
    v_exp_f32 v88, v88
    v_exp_f32 v89, v89
    v_smfmac_f32_32x32x32_bf16 v[128:143], v[180:183], v[80:87], v16
    ds_read_b128 v[180:183], v188 offset:41600
    v_exp_f32 v90, v90
    v_exp_f32 v91, v91
    v_exp_f32 v92, v92
    v_exp_f32 v93, v93
    v_exp_f32 v94, v94
    v_exp_f32 v95, v95
    s_cmp_ge_u32 s60, 4
    s_setprio 1
    s_cbranch_scc1 Lp_51
    s_setprio 0
Lp_51:
    s_waitcnt lgkmcnt(4)
    v_mfma_f32_32x32x16_bf16 v[64:79], v[160:163], v[4:7], v[144:159]
    ds_read_b128 v[160:163], v189 offset:48384
    s_add_u32 m0, s66, 8192
    s_add_u32 s68, s66, 268288
    buffer_load_dwordx4 v27, s[52:55], s68 offen sc1 lds
    v_exp_f32 v96, v96
    v_exp_f32 v97, v97
    v_exp_f32 v98, v98
    v_smfmac_f32_32x32x32_bf16 v[128:143], v[184:187], v[88:95], v16
    ds_read_b128 v[184:187], v188 offset:42304
    v_exp_f32 v99, v99
    v_exp_f32 v100, v100
    v_exp_f32 v101, v101
    v_mfma_f32_32x32x16_bf16 v[80:95], v[164:167], v[4:7], v[144:159]
    ds_read_b128 v[164:167], v189 offset:49408
    v_exp_f32 v102, v102
    v_exp_f32 v103, v103
    v_exp_f32 v104, v104
    v_exp_f32 v105, v105
    s_waitcnt lgkmcnt(5)
    v_smfmac_f32_32x32x32_bf16 v[128:143], v[172:175], v[96:103], v16
    ds_read_b128 v[172:175], v188 offset:45568
    v_exp_f32 v106, v106
    v_exp_f32 v107, v107
    v_exp_f32 v108, v108
    v_exp_f32 v109, v109
    v_mfma_f32_32x32x4_2b_bf16 v[64:95], v[168:169], v[8:9], v[64:95]
    ds_read_b64 v[168:169], v190 offset:50432
    v_exp_f32 v110, v110
    v_exp_f32 v111, v111
    v_exp_f32 v112, v112
    v_exp_f32 v113, v113
    v_exp_f32 v114, v114
    v_exp_f32 v115, v115
    v_exp_f32 v116, v116
    v_exp_f32 v117, v117
    s_waitcnt lgkmcnt(5)
    v_smfmac_f32_32x32x32_bf16 v[128:143], v[176:179], v[104:111], v16
    ds_read_b128 v[176:179], v188 offset:46272
    v_exp_f32 v118, v118
    v_exp_f32 v119, v119
    v_exp_f32 v120, v120
    v_exp_f32 v121, v121
    v_smfmac_f32_32x32x32_bf16 v[128:143], v[180:183], v[112:119], v16
    ds_read_b128 v[180:183], v188 offset:46976
    v_exp_f32 v122, v122
    v_exp_f32 v123, v123
    v_exp_f32 v124, v124
    v_exp_f32 v125, v125
    v_exp_f32 v126, v126
    v_exp_f32 v127, v127
    s_waitcnt lgkmcnt(4)
    v_mfma_f32_32x32x16_bf16 v[96:111], v[160:163], v[4:7], v[144:159]
    ds_read_b128 v[160:163], v189 offset:53760
    s_cmp_ge_u32 s60, 5
    s_cbranch_scc1 Lkv_52
    s_add_u32 m0, s66, 16384
    s_add_u32 s68, s66, 276480
    buffer_load_dwordx4 v27, s[52:55], s68 offen sc1 lds
Lkv_52:
    v_exp_f32 v64, v64
    v_exp_f32 v65, v65
    v_exp_f32 v66, v66
    v_smfmac_f32_32x32x32_bf16 v[128:143], v[184:187], v[120:127], v16
    ds_read_b128 v[184:187], v188 offset:47680
    v_exp_f32 v67, v67
    v_exp_f32 v68, v68
    v_exp_f32 v69, v69
    v_mfma_f32_32x32x16_bf16 v[112:127], v[164:167], v[4:7], v[144:159]
    ds_read_b128 v[164:167], v189 offset:54784
    s_mul_i32 s42, s64, 102400
    s_add_u32 s42, s42, s66
    s_add_u32 s42, s42, 14680064
    s_cmp_eq_u32 s60, 0
    s_cbranch_scc0 Lpi_53
    s_mov_b32 s68, 98304
    buffer_load_dwordx4 v[22:25], v27, s[52:55], s68 offen sc1
Lpi_53:
    v_exp_f32 v70, v70
    v_exp_f32 v71, v71
    v_exp_f32 v72, v72
    v_exp_f32 v73, v73
    s_waitcnt lgkmcnt(5)
    v_smfmac_f32_32x32x32_bf16 v[128:143], v[172:175], v[64:71], v16
    ds_read_b128 v[172:175], v188 offset:50944
    v_exp_f32 v74, v74
    v_exp_f32 v75, v75
    v_exp_f32 v76, v76
    v_exp_f32 v77, v77
    v_mfma_f32_32x32x4_2b_bf16 v[96:127], v[168:169], v[8:9], v[96:127]
    ds_read_b64 v[168:169], v190 offset:55808
    v_exp_f32 v78, v78
    v_exp_f32 v79, v79
    v_exp_f32 v80, v80
    v_exp_f32 v81, v81
    v_exp_f32 v82, v82
    v_exp_f32 v83, v83
    v_exp_f32 v84, v84
    v_exp_f32 v85, v85
    s_waitcnt lgkmcnt(5)
    v_smfmac_f32_32x32x32_bf16 v[128:143], v[176:179], v[72:79], v16
    ds_read_b128 v[176:179], v188 offset:51648
    v_exp_f32 v86, v86
    v_exp_f32 v87, v87
    v_exp_f32 v88, v88
    v_exp_f32 v89, v89
    v_smfmac_f32_32x32x32_bf16 v[128:143], v[180:183], v[80:87], v16
    ds_read_b128 v[180:183], v188 offset:52352
    v_exp_f32 v90, v90
    v_exp_f32 v91, v91
    v_exp_f32 v92, v92
    v_exp_f32 v93, v93
    v_exp_f32 v94, v94
    v_exp_f32 v95, v95
    s_waitcnt lgkmcnt(4)
    v_mfma_f32_32x32x16_bf16 v[64:79], v[160:163], v[4:7], v[144:159]
    ds_read_b128 v[160:163], v189 offset:59136
    v_exp_f32 v96, v96
    v_exp_f32 v97, v97
    v_exp_f32 v98, v98
    v_smfmac_f32_32x32x32_bf16 v[128:143], v[184:187], v[88:95], v16
    ds_read_b128 v[184:187], v188 offset:53056
    v_exp_f32 v99, v99
    v_exp_f32 v100, v100
    v_exp_f32 v101, v101
    v_mfma_f32_32x32x16_bf16 v[80:95], v[164:167], v[4:7], v[144:159]
    ds_read_b128 v[164:167], v189 offset:60160
    v_exp_f32 v102, v102
    v_exp_f32 v103, v103
    v_exp_f32 v104, v104
    v_exp_f32 v105, v105
    s_waitcnt lgkmcnt(5)
    v_smfmac_f32_32x32x32_bf16 v[128:143], v[172:175], v[96:103], v16
    ds_read_b128 v[172:175], v188 offset:56320
    v_exp_f32 v106, v106
    v_exp_f32 v107, v107
    v_exp_f32 v108, v108
    v_exp_f32 v109, v109
    v_mfma_f32_32x32x4_2b_bf16 v[64:95], v[168:169], v[8:9], v[64:95]
    ds_read_b64 v[168:169], v190 offset:61184
    s_cmp_ge_u32 s60, 4
    s_setprio 0
    s_cbranch_scc1 Lp_54
    s_setprio 1
Lp_54:
    v_exp_f32 v110, v110
    v_exp_f32 v111, v111
    v_exp_f32 v112, v112
    v_exp_f32 v113, v113
    v_exp_f32 v114, v114
    v_exp_f32 v115, v115
    v_exp_f32 v116, v116
    v_exp_f32 v117, v117
    s_waitcnt lgkmcnt(5)
    v_smfmac_f32_32x32x32_bf16 v[128:143], v[176:179], v[104:111], v16
    ds_read_b128 v[176:179], v188 offset:57024
    v_exp_f32 v118, v118
    v_exp_f32 v119, v119
    v_exp_f32 v120, v120
    v_exp_f32 v121, v121
    v_smfmac_f32_32x32x32_bf16 v[128:143], v[180:183], v[112:119], v16
    ds_read_b128 v[180:183], v188 offset:57728
    v_exp_f32 v122, v122
    v_exp_f32 v123, v123
    v_exp_f32 v124, v124
    v_exp_f32 v125, v125
    v_exp_f32 v126, v126
    v_exp_f32 v127, v127
    s_cmp_eq_u32 s60, 0
    s_cbranch_scc0 Lok_55
    s_waitcnt vmcnt(0)
Lpoll_56:
    v_xor_b32 v1, v17, v22
    v_xor_b32 v2, v17, v23
    v_xor_b32 v3, v17, v24
    v_or3_b32 v1, v1, v2, v3
    v_xor_b32 v2, v17, v25
    v_or_b32 v1, v1, v2
    v_cmp_ne_u32 vcc, 0, v1
    s_nop 0
    s_cbranch_vccz Lok_55
    s_sub_u32 s80, s80, 1
    s_cbranch_scc1 L_end
    s_mov_b32 s68, 98304
    buffer_load_dwordx4 v[22:25], v27, s[52:55], s68 offen sc1
    s_waitcnt vmcnt(0)
    s_branch Lpoll_56
Lok_55:
    s_waitcnt vmcnt(0)
    s_barrier
    s_or_b32 s70, s2, s60
    s_cbranch_scc1 Lep_57
    v_mov_b32 v1, 0
    buffer_store_dword v17, v1, s[52:55], 0 offen sc1
Lep_57:
    v_min_u32 v1, 11, v0
    v_mul_u32_u24 v2, 5760, v1
    v_cmp_lt_u32 s[86:87], 5, v1
    v_add_u32 v2, 66048, v2
    v_add_u32 v3, 256, v2
    v_cndmask_b32 v1, v2, v3, s[86:87]
    v_mov_b32 v2, 0x3f803f80
    v_mov_b32 v3, 0x3f803f80
    ds_write2_b64 v1, v[2:3], v[2:3] offset1:1
    s_and_b32 s70, s83, 1
    s_mul_i32 s70, s70, 5744
    s_add_u32 s70, s70, 8
    v_add_u32 v212, s70, v245
    v_add_u32 v213, s70, v246
    v_add_u32 v214, s70, v247
    v_add_u32 v215, s70, v252
    v_add_u32 v216, s70, v253
    v_add_u32 v217, s70, v254
    s_waitcnt lgkmcnt(5)
    v_mfma_f32_32x32x16_bf16 v[96:111], v[160:163], v[4:7], v[144:159]
    ds_read_b128 v[160:163], v189 offset:0
    s_add_u32 m0, s66, 21504
    s_add_u32 s68, s66, 281600
    buffer_load_dwordx4 v27, s[52:55], s68 offen sc1 lds
    v_exp_f32 v64, v64
    v_exp_f32 v65, v65
    v_exp_f32 v66, v66
    v_smfmac_f32_32x32x32_bf16 v[128:143], v[184:187], v[120:127], v16
    ds_read_b128 v[184:187], v188 offset:58432
    v_exp_f32 v67, v67
    v_exp_f32 v68, v68
    v_exp_f32 v69, v69
    v_mfma_f32_32x32x16_bf16 v[112:127], v[164:167], v[4:7], v[144:159]
    ds_read_b128 v[164:167], v189 offset:1024
    s_add_u32 m0, s66, 29696
    s_add_u32 s68, s66, 289792
    buffer_load_dwordx4 v27, s[52:55], s68 offen sc1 lds
    v_exp_f32 v70, v70
    v_exp_f32 v71, v71
    v_exp_f32 v72, v72
    v_exp_f32 v73, v73
    s_waitcnt lgkmcnt(6)
    v_smfmac_f32_32x32x32_bf16 v[128:143], v[172:175], v[64:71], v16
    ds_read_b128 v[172:175], v188 offset:61696
    v_exp_f32 v74, v74
    v_exp_f32 v75, v75
    v_exp_f32 v76, v76
    v_exp_f32 v77, v77
    v_mfma_f32_32x32x4_2b_bf16 v[96:127], v[168:169], v[8:9], v[96:127]
    ds_read_b64 v[168:169], v190 offset:2048
    s_add_u32 m0, s66, 139264
    s_add_u32 s68, s42, 81920
    buffer_load_dwordx4 v27, s[52:55], s68 offen sc1 lds
    v_exp_f32 v78, v78
    v_exp_f32 v79, v79
    v_exp_f32 v80, v80
    v_exp_f32 v81, v81
    v_exp_f32 v82, v82
    v_exp_f32 v83, v83
    v_exp_f32 v84, v84
    v_exp_f32 v85, v85
    s_waitcnt lgkmcnt(6)
    v_smfmac_f32_32x32x32_bf16 v[128:143], v[176:179], v[72:79], v16
    ds_read_b128 v[176:179], v188 offset:62400
    s_add_u32 m0, s66, 147456
    s_add_u32 s68, s42, 90112
    buffer_load_dwordx4 v27, s[52:55], s68 offen sc1 lds
    v_exp_f32 v86, v86
    v_exp_f32 v87, v87
    v_exp_f32 v88, v88
    v_exp_f32 v89, v89
    v_smfmac_f32_32x32x32_bf16 v[128:143], v[180:183], v[80:87], v16
    ds_read_b128 v[180:183], v188 offset:63104
    v_exp_f32 v90, v90
    v_exp_f32 v91, v91
    v_exp_f32 v92, v92
    v_exp_f32 v93, v93
    v_exp_f32 v94, v94
    v_exp_f32 v95, v95
    s_cmp_ge_u32 s60, 4
    s_setprio 1
    s_cbranch_scc1 Lp_58
    s_setprio 0
Lp_58:
    s_waitcnt lgkmcnt(4)
    v_mfma_f32_32x32x16_bf16 v[64:79], v[160:163], v[4:7], v[144:159]
    ds_read_b64 v[160:161], v245 offset:23040
    ds_read_b64 v[162:163], v245 offset:24192
    s_cmp_ge_u32 s60, 5
    s_cbranch_scc1 Lkv_59
    s_add_u32 m0, s66, 37888
    s_add_u32 s68, s66, 297984
    buffer_load_dwordx4 v27, s[52:55], s68 offen sc1 lds
Lkv_59:
    v_exp_f32 v96, v96
    v_exp_f32 v97, v97
    v_exp_f32 v98, v98
    v_smfmac_f32_32x32x32_bf16 v[128:143], v[184:187], v[88:95], v16
    ds_read_b128 v[184:187], v188 offset:63808
    v_exp_f32 v99, v99
    v_exp_f32 v100, v100
    v_exp_f32 v101, v101
    v_mfma_f32_32x32x16_bf16 v[80:95], v[164:167], v[4:7], v[144:159]
    ds_read_b64 v[164:165], v212 offset:17280
    ds_read_b64 v[166:167], v212 offset:18432
    ds_read_b64 v[170:171], v213 offset:17280
    s_cmp_lt_u32 s60, 4
    s_cbranch_scc0 Lwo_60
    s_add_u32 m0, s66, 155648
    s_add_u32 s68, s42, 98304
    buffer_load_dwordx4 v27, s[52:55], s68 offen sc1 lds
Lwo_60:
    v_exp_f32 v102, v102
    v_exp_f32 v103, v103
    v_exp_f32 v104, v104
    v_exp_f32 v105, v105
    s_waitcnt lgkmcnt(8)
    v_smfmac_f32_32x32x32_bf16 v[128:143], v[172:175], v[96:103], v16
    v_exp_f32 v106, v106
    v_exp_f32 v107, v107
    v_exp_f32 v108, v108
    v_exp_f32 v109, v109
    v_mfma_f32_32x32x4_2b_bf16 v[64:95], v[168:169], v[8:9], v[64:95]
    ds_read_b64 v[168:169], v246 offset:23040
    v_exp_f32 v110, v110
    v_exp_f32 v111, v111
    v_exp_f32 v112, v112
    v_exp_f32 v113, v113
    v_exp_f32 v114, v114
    v_exp_f32 v115, v115
    v_exp_f32 v116, v116
    v_exp_f32 v117, v117
    s_waitcnt lgkmcnt(7)
    v_smfmac_f32_32x32x32_bf16 v[128:143], v[176:179], v[104:111], v16
    v_exp_f32 v118, v118
    v_exp_f32 v119, v119
    v_exp_f32 v120, v120
    v_exp_f32 v121, v121
    v_smfmac_f32_32x32x32_bf16 v[128:143], v[180:183], v[112:119], v16
    v_exp_f32 v122, v122
    v_exp_f32 v123, v123
    v_exp_f32 v124, v124
    v_exp_f32 v125, v125
    v_exp_f32 v126, v126
    v_exp_f32 v127, v127
    s_waitcnt lgkmcnt(4)
    s_nop 0
    v_smfmac_f32_32x32x32_bf16 v[128:143], v[184:187], v[120:127], v16
    s_waitcnt lgkmcnt(0)
    v_mfma_f32_32x32x16_bf16 v[96:111], v[160:163], v[12:15], v[32:47]
    v_mfma_f32_32x32x8_bf16 v[96:111], v[168:169], v[10:11], v[96:111]
    v_mfma_f32_32x32x16_bf16 v[112:127], v[164:167], v[12:15], 0
    v_mfma_f32_32x32x8_bf16 v[112:127], v[170:171], v[10:11], v[112:127]
    ds_read_b64_tr_b16 v[172:173], v247 offset:23040
    ds_read_b64_tr_b16 v[174:175], v252 offset:23040
    ds_read_b64_tr_b16 v[176:177], v253 offset:23040
    ds_read_b64_tr_b16 v[178:179], v254 offset:23040
    s_mov_b32 s10, 0x42200000
    v_mov_b32 v210, 0
    v_mov_b32 v211, 0
    s_nop 1
    v_mfma_f32_32x32x8_bf16 v[192:207], v[210:211], v[210:211], 0
    s_nop 1
    v_max3_f32 v208, v96, v97, v98
    v_max3_f32 v208, v208, v99, v100
    v_max3_f32 v208, v208, v101, v102
    v_max3_f32 v208, v208, v103, v104
    v_max3_f32 v208, v208, v105, v106
    v_max3_f32 v208, v208, v107, v108
    v_max3_f32 v208, v208, v109, v110
    v_max_f32 v208, v208, v111
    s_cmp_gt_u32 s78, 7
    s_cbranch_scc1 L_A_m
    v_max3_f32 v208, v208, v112, v113
    v_max3_f32 v208, v208, v114, v115
    v_max3_f32 v208, v208, v116, v117
    v_max3_f32 v208, v208, v118, v119
    v_max3_f32 v208, v208, v120, v121
    v_max3_f32 v208, v208, v122, v123
    v_max3_f32 v208, v208, v124, v125
    v_max3_f32 v208, v208, v126, v127
L_A_m:
    v_mov_b32 v2, v208
    v_mov_b32 v211, 0
    s_nop 0
    v_permlane32_swap_b32 v208, v2
    s_nop 0
    v_max_f32 v2, v2, v208
    v_add_f32 v2, s10, v2
    v_cvt_pk_bf16_f32 v1, 0, -v2
    v_sub_f32 v2, -v2, v1
    v_cvt_pk_bf16_f32 v2, v1, v2
    v_cndmask_b32 v210, 0, v2, s[84:85]
    v_cndmask_b32 v10, v10, v2, s[84:85]
    s_nop 0
    v_mfma_f32_32x32x8_bf16 v[96:111], v[168:169], v[210:211], v[96:111]
    v_mfma_f32_32x32x8_bf16 v[112:127], v[170:171], v[210:211], v[112:127]
    ds_read_b64 v[160:161], v245 offset:17280
    ds_read_b64 v[162:163], v245 offset:18432
    ds_read_b64 v[168:169], v246 offset:17280
    s_nop 5
    s_cmp_eq_u32 s78, 0
    s_cbranch_scc0 Lfull_65
    v_exp_f32 v96, v96
    v_exp_f32 v97, v97
    v_exp_f32 v98, v98
    ds_read_b64_tr_b16 v[180:181], v214 offset:17280
    ds_read_b64_tr_b16 v[182:183], v215 offset:17280
    v_exp_f32 v99, v99
    v_exp_f32 v100, v100
    v_exp_f32 v101, v101
    ds_read_b64_tr_b16 v[184:185], v216 offset:17280
    ds_read_b64_tr_b16 v[186:187], v217 offset:17280
    v_exp_f32 v102, v102
    v_exp_f32 v103, v103
    v_exp_f32 v104, v104
    ds_read_b64 v[164:165], v212 offset:11520
    ds_read_b64 v[166:167], v212 offset:12672
    v_exp_f32 v105, v105
    v_exp_f32 v106, v106
    v_exp_f32 v107, v107
    v_exp_f32 v108, v108
    s_waitcnt lgkmcnt(6)
    v_smfmac_f32_32x32x32_bf16 v[192:207], v[172:175], v[96:103], v16
    ds_read_b64 v[170:171], v213 offset:11520
    v_exp_f32 v109, v109
    v_exp_f32 v110, v110
    v_exp_f32 v111, v111
    v_exp_f32 v112, v112
    v_exp_f32 v113, v113
    v_exp_f32 v114, v114
    v_smfmac_f32_32x32x32_bf16 v[192:207], v[176:179], v[104:111], v16
    ds_read_b64_tr_b16 v[172:173], v247 offset:17280
    ds_read_b64_tr_b16 v[174:175], v252 offset:17280
    v_exp_f32 v115, v115
    v_exp_f32 v116, v116
    v_exp_f32 v117, v117
    v_mfma_f32_32x32x16_bf16 v[96:111], v[160:163], v[12:15], 0
    ds_read_b64_tr_b16 v[176:177], v253 offset:17280
    ds_read_b64_tr_b16 v[178:179], v254 offset:17280
    v_exp_f32 v118, v118
    v_exp_f32 v119, v119
    v_exp_f32 v120, v120
    v_mfma_f32_32x32x8_bf16 v[96:111], v[168:169], v[10:11], v[96:111]
    ds_read_b64 v[160:161], v245 offset:11520
    ds_read_b64 v[162:163], v245 offset:12672
    v_exp_f32 v121, v121
    v_exp_f32 v122, v122
    v_exp_f32 v123, v123
    v_exp_f32 v124, v124
    s_waitcnt lgkmcnt(6)
    v_smfmac_f32_32x32x32_bf16 v[192:207], v[180:183], v[112:119], v16
    ds_read_b64 v[168:169], v246 offset:11520
    v_exp_f32 v125, v125
    v_exp_f32 v126, v126
    v_exp_f32 v127, v127
    v_exp_f32 v96, v96
    v_exp_f32 v97, v97
    v_exp_f32 v98, v98
    v_smfmac_f32_32x32x32_bf16 v[192:207], v[184:187], v[120:127], v16
    ds_read_b64_tr_b16 v[180:181], v214 offset:11520
    ds_read_b64_tr_b16 v[182:183], v215 offset:11520
    v_exp_f32 v99, v99
    v_exp_f32 v100, v100
    v_exp_f32 v101, v101
    v_mfma_f32_32x32x16_bf16 v[112:127], v[164:167], v[12:15], 0
    ds_read_b64_tr_b16 v[184:185], v216 offset:11520
    ds_read_b64_tr_b16 v[186:187], v217 offset:11520
    v_exp_f32 v102, v102
    v_exp_f32 v103, v103
    v_exp_f32 v104, v104
    v_mfma_f32_32x32x8_bf16 v[112:127], v[170:171], v[10:11], v[112:127]
    ds_read_b64 v[164:165], v212 offset:5760
    ds_read_b64 v[166:167], v212 offset:6912
    v_exp_f32 v105, v105
    v_exp_f32 v106, v106
    v_exp_f32 v107, v107
    v_exp_f32 v108, v108
    s_waitcnt lgkmcnt(6)
    v_smfmac_f32_32x32x32_bf16 v[192:207], v[172:175], v[96:103], v16
    ds_read_b64 v[170:171], v213 offset:5760
    v_exp_f32 v109, v109
    v_exp_f32 v110, v110
    v_exp_f32 v111, v111
    v_exp_f32 v112, v112
    v_exp_f32 v113, v113
    v_exp_f32 v114, v114
    v_smfmac_f32_32x32x32_bf16 v[192:207], v[176:179], v[104:111], v16
    ds_read_b64_tr_b16 v[172:173], v247 offset:11520
    ds_read_b64_tr_b16 v[174:175], v252 offset:11520
    v_exp_f32 v115, v115
    v_exp_f32 v116, v116
    v_exp_f32 v117, v117
    v_mfma_f32_32x32x16_bf16 v[96:111], v[160:163], v[12:15], 0
    ds_read_b64_tr_b16 v[176:177], v253 offset:11520
    ds_read_b64_tr_b16 v[178:179], v254 offset:11520
    v_exp_f32 v118, v118
    v_exp_f32 v119, v119
    v_exp_f32 v120, v120
    v_mfma_f32_32x32x8_bf16 v[96:111], v[168:169], v[10:11], v[96:111]
    ds_read_b64 v[160:161], v245 offset:5760
    ds_read_b64 v[162:163], v245 offset:6912
    v_exp_f32 v121, v121
    v_exp_f32 v122, v122
    v_exp_f32 v123, v123
    v_exp_f32 v124, v124
    s_waitcnt lgkmcnt(6)
    v_smfmac_f32_32x32x32_bf16 v[192:207], v[180:183], v[112:119], v16
    ds_read_b64 v[168:169], v246 offset:5760
    v_exp_f32 v125, v125
    v_exp_f32 v126, v126
    v_exp_f32 v127, v127
    v_exp_f32 v96, v96
    v_exp_f32 v97, v97
    v_exp_f32 v98, v98
    v_smfmac_f32_32x32x32_bf16 v[192:207], v[184:187], v[120:127], v16
    ds_read_b64_tr_b16 v[180:181], v214 offset:5760
    ds_read_b64_tr_b16 v[182:183], v215 offset:5760
    v_exp_f32 v99, v99
    v_exp_f32 v100, v100
    v_exp_f32 v101, v101
    v_mfma_f32_32x32x16_bf16 v[112:127], v[164:167], v[12:15], 0
    ds_read_b64_tr_b16 v[184:185], v216 offset:5760
    ds_read_b64_tr_b16 v[186:187], v217 offset:5760
    v_exp_f32 v102, v102
    v_exp_f32 v103, v103
    v_exp_f32 v104, v104
    v_mfma_f32_32x32x8_bf16 v[112:127], v[170:171], v[10:11], v[112:127]
    ds_read_b64 v[164:165], v212 offset:0
    ds_read_b64 v[166:167], v212 offset:1152
    v_exp_f32 v105, v105
    v_exp_f32 v106, v106
    v_exp_f32 v107, v107
    v_exp_f32 v108, v108
    s_waitcnt lgkmcnt(6)
    v_smfmac_f32_32x32x32_bf16 v[192:207], v[172:175], v[96:103], v16
    ds_read_b64 v[170:171], v213 offset:0
    v_exp_f32 v109, v109
    v_exp_f32 v110, v110
    v_exp_f32 v111, v111
    v_exp_f32 v112, v112
    v_exp_f32 v113, v113
    v_exp_f32 v114, v114
    v_smfmac_f32_32x32x32_bf16 v[192:207], v[176:179], v[104:111], v16
    ds_read_b64_tr_b16 v[172:173], v247 offset:5760
    ds_read_b64_tr_b16 v[174:175], v252 offset:5760
    v_exp_f32 v115, v115
    v_exp_f32 v116, v116
    v_exp_f32 v117, v117
    v_mfma_f32_32x32x16_bf16 v[96:111], v[160:163], v[12:15], 0
    ds_read_b64_tr_b16 v[176:177], v253 offset:5760
    ds_read_b64_tr_b16 v[178:179], v254 offset:5760
    v_exp_f32 v118, v118
    v_exp_f32 v119, v119
    v_exp_f32 v120, v120
    v_mfma_f32_32x32x8_bf16 v[96:111], v[168:169], v[10:11], v[96:111]
    ds_read_b64 v[160:161], v245 offset:0
    ds_read_b64 v[162:163], v245 offset:1152
    v_exp_f32 v121, v121
    v_exp_f32 v122, v122
    v_exp_f32 v123, v123
    v_exp_f32 v124, v124
    s_waitcnt lgkmcnt(6)
    v_smfmac_f32_32x32x32_bf16 v[192:207], v[180:183], v[112:119], v16
    ds_read_b64 v[168:169], v246 offset:0
    v_exp_f32 v125, v125
    v_exp_f32 v126, v126
    v_exp_f32 v127, v127
    v_exp_f32 v96, v96
    v_exp_f32 v97, v97
    v_exp_f32 v98, v98
    v_smfmac_f32_32x32x32_bf16 v[192:207], v[184:187], v[120:127], v16
    ds_read_b64_tr_b16 v[180:181], v214 offset:0
    ds_read_b64_tr_b16 v[182:183], v215 offset:0
    v_exp_f32 v99, v99
    v_exp_f32 v100, v100
    v_exp_f32 v101, v101
    v_mfma_f32_32x32x16_bf16 v[112:127], v[164:167], v[12:15], 0
    ds_read_b64_tr_b16 v[184:185], v216 offset:0
    ds_read_b64_tr_b16 v[186:187], v217 offset:0
    v_exp_f32 v102, v102
    v_exp_f32 v103, v103
    v_exp_f32 v104, v104
    v_mfma_f32_32x32x8_bf16 v[112:127], v[170:171], v[10:11], v[112:127]
    v_exp_f32 v105, v105
    v_exp_f32 v106, v106
    v_exp_f32 v107, v107
    v_exp_f32 v108, v108
    s_waitcnt lgkmcnt(4)
    v_smfmac_f32_32x32x32_bf16 v[192:207], v[172:175], v[96:103], v16
    v_exp_f32 v109, v109
    v_exp_f32 v110, v110
    v_exp_f32 v111, v111
    s_nop 2
    v_exp_f32 v112, v112
    v_exp_f32 v113, v113
    v_exp_f32 v114, v114
    v_smfmac_f32_32x32x32_bf16 v[192:207], v[176:179], v[104:111], v16
    ds_read_b64_tr_b16 v[172:173], v247 offset:0
    ds_read_b64_tr_b16 v[174:175], v252 offset:0
    v_exp_f32 v115, v115
    v_exp_f32 v116, v116
    v_exp_f32 v117, v117
    v_mfma_f32_32x32x16_bf16 v[96:111], v[160:163], v[12:15], v[48:63]
    ds_read_b64_tr_b16 v[176:177], v253 offset:0
    ds_read_b64_tr_b16 v[178:179], v254 offset:0
    v_exp_f32 v118, v118
    v_exp_f32 v119, v119
    v_exp_f32 v120, v120
    v_mfma_f32_32x32x8_bf16 v[96:111], v[168:169], v[10:11], v[96:111]
    v_exp_f32 v121, v121
    v_exp_f32 v122, v122
    v_exp_f32 v123, v123
    v_exp_f32 v124, v124
    s_waitcnt lgkmcnt(4)
    v_smfmac_f32_32x32x32_bf16 v[192:207], v[180:183], v[112:119], v16
    v_exp_f32 v125, v125
    v_exp_f32 v126, v126
    v_exp_f32 v127, v127
    s_nop 2
    v_exp_f32 v96, v96
    v_exp_f32 v97, v97
    v_exp_f32 v98, v98
    v_smfmac_f32_32x32x32_bf16 v[192:207], v[184:187], v[120:127], v16
    v_exp_f32 v99, v99
    v_exp_f32 v100, v100
    v_exp_f32 v101, v101
    v_exp_f32 v102, v102
    v_exp_f32 v103, v103
    v_exp_f32 v104, v104
    v_exp_f32 v105, v105
    v_exp_f32 v106, v106
    v_exp_f32 v107, v107
    v_exp_f32 v108, v108
    s_waitcnt lgkmcnt(0)
    v_smfmac_f32_32x32x32_bf16 v[192:207], v[172:175], v[96:103], v16
    v_exp_f32 v109, v109
    v_exp_f32 v110, v110
    v_exp_f32 v111, v111
    s_nop 1
Lstub_62:
    v_smfmac_f32_32x32x32_bf16 v[192:207], v[176:179], v[104:111], v16
Lfin_64:
    s_waitcnt lgkmcnt(0)
    ds_read_b128 v[160:163], v189 offset:5376
    ds_read_b128 v[164:167], v189 offset:6400
    ds_read_b128 v[172:175], v188 offset:2560
    ds_read_b64 v[168:169], v190 offset:7424
    ds_read_b128 v[176:179], v188 offset:3264
    ds_read_b128 v[180:183], v188 offset:3968
    s_nop 4
    v_mov_b32 v1, v200
    v_mov_b32 v2, v200
    s_nop 1
    v_permlane32_swap_b32 v1, v2
    s_mov_b32 s70, 1820327936
    v_cmp_nge_f32 vcc, s70, v2
    s_cmp_eq_u32 s10, 0
    s_cbranch_scc1 Lgood_66
    s_cbranch_vccnz L_A_fallback
Lgood_66:
    v_rcp_f32 v2, v2
    s_nop 0
    v_pk_mul_f32 v[192:193], v[192:193], v[2:3] op_sel_hi:[1,0]
    v_pk_mul_f32 v[194:195], v[194:195], v[2:3] op_sel_hi:[1,0]
    v_pk_mul_f32 v[196:197], v[196:197], v[2:3] op_sel_hi:[1,0]
    v_pk_mul_f32 v[198:199], v[198:199], v[2:3] op_sel_hi:[1,0]
    v_pk_mul_f32 v[200:201], v[200:201], v[2:3] op_sel_hi:[1,0]
    v_pk_mul_f32 v[202:203], v[202:203], v[2:3] op_sel_hi:[1,0]
    v_cvt_pk_bf16_f32 v192, v192, v193
    v_cvt_pk_bf16_f32 v193, v194, v195
    v_cvt_pk_bf16_f32 v194, v196, v197
    v_cvt_pk_bf16_f32 v195, v198, v199
    v_cvt_pk_bf16_f32 v196, v200, v201
    v_cvt_pk_bf16_f32 v197, v202, v203
    v_min_u32 v192, -2, v192
    v_min_u32 v193, -2, v193
    v_min_u32 v194, -2, v194
    v_min_u32 v195, -2, v195
    v_min_u32 v196, -2, v196
    v_min_u32 v197, -2, v197
    buffer_store_dwordx4 v[192:195], v20, s[52:55], 0 offen sc1
    buffer_store_dwordx2 v[196:197], v21, s[52:55], 0 offen sc1
    s_waitcnt lgkmcnt(4)
    v_mfma_f32_32x32x16_bf16 v[96:111], v[160:163], v[4:7], v[144:159]
    ds_read_b128 v[160:163], v189 offset:10752
    v_exp_f32 v64, v64
    v_exp_f32 v65, v65
    v_exp_f32 v66, v66
    ds_read_b128 v[184:187], v188 offset:4672
    v_exp_f32 v67, v67
    v_exp_f32 v68, v68
    v_exp_f32 v69, v69
    v_mfma_f32_32x32x16_bf16 v[112:127], v[164:167], v[4:7], v[144:159]
    ds_read_b128 v[164:167], v189 offset:11776
    v_exp_f32 v70, v70
    v_exp_f32 v71, v71
    v_exp_f32 v72, v72
    v_exp_f32 v73, v73
    s_waitcnt lgkmcnt(5)
    v_smfmac_f32_32x32x32_bf16 v[128:143], v[172:175], v[64:71], v16
    ds_read_b128 v[172:175], v188 offset:7936
    v_exp_f32 v74, v74
    v_exp_f32 v75, v75
    v_exp_f32 v76, v76
    v_exp_f32 v77, v77
    v_mfma_f32_32x32x4_2b_bf16 v[96:127], v[168:169], v[8:9], v[96:127]
    ds_read_b64 v[168:169], v190 offset:12800
    v_exp_f32 v78, v78
    v_exp_f32 v79, v79
    v_exp_f32 v80, v80
    v_exp_f32 v81, v81
    v_exp_f32 v82, v82
    v_exp_f32 v83, v83
    v_exp_f32 v84, v84
    v_exp_f32 v85, v85
    s_waitcnt lgkmcnt(5)
    v_smfmac_f32_32x32x32_bf16 v[128:143], v[176:179], v[72:79], v16
    ds_read_b128 v[176:179], v188 offset:8640
    v_exp_f32 v86, v86
    v_exp_f32 v87, v87
    v_exp_f32 v88, v88
    v_exp_f32 v89, v89
    v_smfmac_f32_32x32x32_bf16 v[128:143], v[180:183], v[80:87], v16
    ds_read_b128 v[180:183], v188 offset:9344
    v_exp_f32 v90, v90
    v_exp_f32 v91, v91
    v_exp_f32 v92, v92
    v_exp_f32 v93, v93
    v_exp_f32 v94, v94
    v_exp_f32 v95, v95
    s_waitcnt lgkmcnt(4)
    v_mfma_f32_32x32x16_bf16 v[64:79], v[160:163], v[4:7], v[144:159]
    ds_read_b128 v[160:163], v189 offset:16128
    v_exp_f32 v96, v96
    v_exp_f32 v97, v97
    v_exp_f32 v98, v98
    v_smfmac_f32_32x32x32_bf16 v[128:143], v[184:187], v[88:95], v16
    ds_read_b128 v[184:187], v188 offset:10048
    v_exp_f32 v99, v99
    v_exp_f32 v100, v100
    v_exp_f32 v101, v101
    v_mfma_f32_32x32x16_bf16 v[80:95], v[164:167], v[4:7], v[144:159]
    ds_read_b128 v[164:167], v189 offset:17152
    v_exp_f32 v102, v102
    v_exp_f32 v103, v103
    v_exp_f32 v104, v104
    v_exp_f32 v105, v105
    s_waitcnt lgkmcnt(5)
    v_smfmac_f32_32x32x32_bf16 v[128:143], v[172:175], v[96:103], v16
    ds_read_b128 v[172:175], v188 offset:13312
    v_exp_f32 v106, v106
    v_exp_f32 v107, v107
    v_exp_f32 v108, v108
    v_exp_f32 v109, v109
    v_mfma_f32_32x32x4_2b_bf16 v[64:95], v[168:169], v[8:9], v[64:95]
    ds_read_b64 v[168:169], v190 offset:18176
    s_cmp_ge_u32 s60, 4
    s_setprio 0
    s_cbranch_scc1 Lp_67
    s_setprio 1
Lp_67:
    v_exp_f32 v110, v110
    v_exp_f32 v111, v111
    v_exp_f32 v112, v112
    v_exp_f32 v113, v113
    v_exp_f32 v114, v114
    v_exp_f32 v115, v115
    v_exp_f32 v116, v116
    v_exp_f32 v117, v117
    s_waitcnt lgkmcnt(5)
    v_smfmac_f32_32x32x32_bf16 v[128:143], v[176:179], v[104:111], v16
    ds_read_b128 v[176:179], v188 offset:14016
    v_exp_f32 v118, v118
    v_exp_f32 v119, v119
    v_exp_f32 v120, v120
    v_exp_f32 v121, v121
    v_smfmac_f32_32x32x32_bf16 v[128:143], v[180:183], v[112:119], v16
    ds_read_b128 v[180:183], v188 offset:14720
    v_exp_f32 v122, v122
    v_exp_f32 v123, v123
    v_exp_f32 v124, v124
    v_exp_f32 v125, v125
    v_exp_f32 v126, v126
    v_exp_f32 v127, v127
    s_waitcnt vmcnt(2)
    s_barrier
    s_waitcnt lgkmcnt(4)
    v_mfma_f32_32x32x16_bf16 v[96:111], v[160:163], v[4:7], v[144:159]
    ds_read_b128 v[160:163], v189 offset:21504
    s_add_u32 m0, s66, 65536
    s_add_u32 s68, s42, 819200
    buffer_load_dwordx4 v27, s[52:55], s68 offen sc1 lds
    v_exp_f32 v64, v64
    v_exp_f32 v65, v65
    v_exp_f32 v66, v66
    v_smfmac_f32_32x32x32_bf16 v[128:143], v[184:187], v[120:127], v16
    ds_read_b128 v[184:187], v188 offset:15424
    s_add_u32 m0, s66, 73728
    s_add_u32 s68, s42, 827392
    buffer_load_dwordx4 v27, s[52:55], s68 offen sc1 lds
    v_exp_f32 v67, v67
    v_exp_f32 v68, v68
    v_exp_f32 v69, v69
    v_mfma_f32_32x32x16_bf16 v[112:127], v[164:167], v[4:7], v[144:159]
    ds_read_b128 v[164:167], v189 offset:22528
    s_add_u32 m0, s66, 81920
    s_add_u32 s68, s42, 835584
    buffer_load_dwordx4 v27, s[52:55], s68 offen sc1 lds
    v_exp_f32 v70, v70
    v_exp_f32 v71, v71
    v_exp_f32 v72, v72
    v_exp_f32 v73, v73
    s_waitcnt lgkmcnt(5)
    v_smfmac_f32_32x32x32_bf16 v[128:143], v[172:175], v[64:71], v16
    ds_read_b128 v[172:175], v188 offset:18688
    s_add_u32 m0, s66, 90112
    s_add_u32 s68, s42, 843776
    buffer_load_dwordx4 v27, s[52:55], s68 offen sc1 lds
    v_exp_f32 v74, v74
    v_exp_f32 v75, v75
    v_exp_f32 v76, v76
    v_exp_f32 v77, v77
    v_mfma_f32_32x32x4_2b_bf16 v[96:127], v[168:169], v[8:9], v[96:127]
    ds_read_b64 v[168:169], v190 offset:23552
    ds_read_b128 v[192:195], v242 offset:8192
    v_exp_f32 v78, v78
    v_exp_f32 v79, v79
    v_exp_f32 v80, v80
    v_exp_f32 v81, v81
    v_exp_f32 v82, v82
    v_exp_f32 v83, v83
    v_exp_f32 v84, v84
    v_exp_f32 v85, v85
    s_waitcnt lgkmcnt(6)
    v_smfmac_f32_32x32x32_bf16 v[128:143], v[176:179], v[72:79], v16
    ds_read_b128 v[176:179], v188 offset:19392
    ds_read_b128 v[196:199], v242 offset:9216
    v_exp_f32 v86, v86
    v_exp_f32 v87, v87
    v_exp_f32 v88, v88
    v_exp_f32 v89, v89
    v_smfmac_f32_32x32x32_bf16 v[128:143], v[180:183], v[80:87], v16
    ds_read_b128 v[180:183], v188 offset:20096
    ds_read_b128 v[200:203], v242 offset:10240
    v_exp_f32 v90, v90
    v_exp_f32 v91, v91
    v_exp_f32 v92, v92
    v_exp_f32 v93, v93
    v_exp_f32 v94, v94
    v_exp_f32 v95, v95
    s_cmp_ge_u32 s60, 4
    s_setprio 1
    s_cbranch_scc1 Lp_68
    s_setprio 0
Lp_68:
    s_waitcnt lgkmcnt(7)
    v_mfma_f32_32x32x16_bf16 v[64:79], v[160:163], v[4:7], v[144:159]
    ds_read_b128 v[160:163], v189 offset:26880
    s_add_u32 m0, s66, 98304
    s_add_u32 s68, s42, 851968
    buffer_load_dwordx4 v27, s[52:55], s68 offen sc1 lds
    v_exp_f32 v96, v96
    v_exp_f32 v97, v97
    v_exp_f32 v98, v98
    v_smfmac_f32_32x32x32_bf16 v[128:143], v[184:187], v[88:95], v16
    ds_read_b128 v[184:187], v188 offset:20800
    s_add_u32 m0, s66, 106496
    s_add_u32 s68, s42, 860160
    buffer_load_dwordx4 v27, s[52:55], s68 offen sc1 lds
    v_exp_f32 v99, v99
    v_exp_f32 v100, v100
    v_exp_f32 v101, v101
    v_mfma_f32_32x32x16_bf16 v[80:95], v[164:167], v[4:7], v[144:159]
    ds_read_b128 v[164:167], v189 offset:27904
    s_add_u32 m0, s66, 114688
    s_add_u32 s68, s42, 868352
    buffer_load_dwordx4 v27, s[52:55], s68 offen sc1 lds
    v_exp_f32 v102, v102
    v_exp_f32 v103, v103
    v_exp_f32 v104, v104
    v_exp_f32 v105, v105
    s_waitcnt lgkmcnt(8)
    v_smfmac_f32_32x32x32_bf16 v[128:143], v[172:175], v[96:103], v16
    ds_read_b128 v[172:175], v188 offset:24064
    s_add_u32 m0, s66, 122880
    s_add_u32 s68, s42, 876544
    buffer_load_dwordx4 v27, s[52:55], s68 offen sc1 lds
    v_exp_f32 v106, v106
    v_exp_f32 v107, v107
    v_exp_f32 v108, v108
    v_exp_f32 v109, v109
    v_mfma_f32_32x32x4_2b_bf16 v[64:95], v[168:169], v[8:9], v[64:95]
    ds_read_b64 v[168:169], v190 offset:28928
    ds_read_b128 v[204:207], v242 offset:11264
    v_exp_f32 v110, v110
    v_exp_f32 v111, v111
    v_exp_f32 v112, v112
    v_exp_f32 v113, v113
    v_exp_f32 v114, v114
    v_exp_f32 v115, v115
    v_exp_f32 v116, v116
    v_exp_f32 v117, v117
    s_waitcnt lgkmcnt(7)
    v_smfmac_f32_32x32x32_bf16 v[128:143], v[176:179], v[104:111], v16
    ds_read_b128 v[176:179], v188 offset:24768
    ds_read_b128 v[208:211], v242 offset:12288
    v_exp_f32 v118, v118
    v_exp_f32 v119, v119
    v_exp_f32 v120, v120
    v_exp_f32 v121, v121
    v_smfmac_f32_32x32x32_bf16 v[128:143], v[180:183], v[112:119], v16
    ds_read_b128 v[180:183], v188 offset:25472
    ds_read_b128 v[212:215], v242 offset:18432
    v_exp_f32 v122, v122
    v_exp_f32 v123, v123
    v_exp_f32 v124, v124
    v_exp_f32 v125, v125
    v_exp_f32 v126, v126
    v_exp_f32 v127, v127
    s_waitcnt lgkmcnt(7)
    v_mfma_f32_32x32x16_bf16 v[96:111], v[160:163], v[4:7], v[144:159]
    ds_read_b128 v[160:163], v189 offset:32256
    s_cmp_lt_u32 s60, 6
    s_cbranch_scc0 Lwo_69
    s_add_u32 m0, s66, 131072
    s_add_u32 s68, s42, 884736
    buffer_load_dwordx4 v27, s[52:55], s68 offen sc1 lds
Lwo_69:
    v_exp_f32 v64, v64
    v_exp_f32 v65, v65
    v_exp_f32 v66, v66
    v_smfmac_f32_32x32x32_bf16 v[128:143], v[184:187], v[120:127], v16
    ds_read_b128 v[184:187], v188 offset:26176
    s_add_u32 m0, s66, 43008
    s_add_u32 s68, s42, 911360
    buffer_load_dwordx4 v27, s[52:55], s68 offen sc1 lds
    v_exp_f32 v67, v67
    v_exp_f32 v68, v68
    v_exp_f32 v69, v69
    v_mfma_f32_32x32x16_bf16 v[112:127], v[164:167], v[4:7], v[144:159]
    ds_read_b128 v[164:167], v189 offset:33280
    s_cmp_lt_u32 s60, 2
    s_cbranch_scc0 Lwo_70
    s_add_u32 m0, s66, 51200
    s_add_u32 s68, s42, 919552
    buffer_load_dwordx4 v27, s[52:55], s68 offen sc1 lds
Lwo_70:
    v_exp_f32 v70, v70
    v_exp_f32 v71, v71
    v_exp_f32 v72, v72
    v_exp_f32 v73, v73
    s_waitcnt lgkmcnt(8)
    v_smfmac_f32_32x32x32_bf16 v[128:143], v[172:175], v[64:71], v16
    ds_read_b128 v[172:175], v188 offset:29440
    s_mov_b32 s68, 12058624
    buffer_load_dwordx4 v[32:35], v29, s[52:55], s68 offen offset:0 sc1
    v_exp_f32 v74, v74
    v_exp_f32 v75, v75
    v_exp_f32 v76, v76
    v_exp_f32 v77, v77
    v_mfma_f32_32x32x4_2b_bf16 v[96:127], v[168:169], v[8:9], v[96:127]
    ds_read_b64 v[168:169], v190 offset:34304
    ds_read_b128 v[216:219], v242 offset:19456
    v_exp_f32 v78, v78
    v_exp_f32 v79, v79
    v_exp_f32 v80, v80
    v_exp_f32 v81, v81
    v_exp_f32 v82, v82
    v_exp_f32 v83, v83
    v_exp_f32 v84, v84
    v_exp_f32 v85, v85
    s_waitcnt lgkmcnt(7)
    v_smfmac_f32_32x32x32_bf16 v[128:143], v[176:179], v[72:79], v16
    ds_read_b128 v[176:179], v188 offset:30144
    ds_read_b128 v[220:223], v242 offset:20480
    v_exp_f32 v86, v86
    v_exp_f32 v87, v87
    v_exp_f32 v88, v88
    v_exp_f32 v89, v89
    v_smfmac_f32_32x32x32_bf16 v[128:143], v[180:183], v[80:87], v16
    ds_read_b128 v[180:183], v188 offset:30848
    ds_read_b128 v[224:227], v242 offset:21504
    v_exp_f32 v90, v90
    v_exp_f32 v91, v91
    v_exp_f32 v92, v92
    v_exp_f32 v93, v93
    v_exp_f32 v94, v94
    v_exp_f32 v95, v95
    s_waitcnt lgkmcnt(7)
    v_mfma_f32_32x32x16_bf16 v[64:79], v[160:163], v[4:7], v[144:159]
    ds_read_b128 v[160:163], v189 offset:37632
    s_mov_b32 s68, 12058624
    buffer_load_dwordx4 v[36:39], v29, s[52:55], s68 offen offset:2048 sc1
    v_exp_f32 v96, v96
    v_exp_f32 v97, v97
    v_exp_f32 v98, v98
    v_smfmac_f32_32x32x32_bf16 v[128:143], v[184:187], v[88:95], v16
    ds_read_b128 v[184:187], v188 offset:31552
    v_exp_f32 v99, v99
    v_exp_f32 v100, v100
    v_exp_f32 v101, v101
    v_mfma_f32_32x32x16_bf16 v[80:95], v[164:167], v[4:7], v[144:159]
    ds_read_b128 v[164:167], v189 offset:38656
    s_mov_b32 s68, 12062720
    buffer_load_dwordx4 v[40:43], v29, s[52:55], s68 offen offset:0 sc1
    v_exp_f32 v102, v102
    v_exp_f32 v103, v103
    v_exp_f32 v104, v104
    v_exp_f32 v105, v105
    s_waitcnt lgkmcnt(8)
    v_smfmac_f32_32x32x32_bf16 v[128:143], v[172:175], v[96:103], v16
    ds_read_b128 v[172:175], v188 offset:34816
    v_exp_f32 v106, v106
    v_exp_f32 v107, v107
    v_exp_f32 v108, v108
    v_exp_f32 v109, v109
    v_mfma_f32_32x32x4_2b_bf16 v[64:95], v[168:169], v[8:9], v[64:95]
    ds_read_b64 v[168:169], v190 offset:39680
    s_cmp_ge_u32 s60, 4
    s_setprio 0
    s_cbranch_scc1 Lp_71
    s_setprio 1
Lp_71:
    s_mov_b32 s68, 12062720
    buffer_load_dwordx4 v[44:47], v29, s[52:55], s68 offen offset:2048 sc1
    v_exp_f32 v110, v110
    v_exp_f32 v111, v111
    v_exp_f32 v112, v112
    v_exp_f32 v113, v113
    v_exp_f32 v114, v114
    v_exp_f32 v115, v115
    v_exp_f32 v116, v116
    v_exp_f32 v117, v117
    s_waitcnt lgkmcnt(6)
    v_smfmac_f32_32x32x32_bf16 v[128:143], v[176:179], v[104:111], v16
    ds_read_b128 v[176:179], v188 offset:35520
    s_mov_b32 s68, 12066816
    buffer_load_dwordx4 v[48:51], v29, s[52:55], s68 offen offset:0 sc1
    v_exp_f32 v118, v118
    v_exp_f32 v119, v119
    v_exp_f32 v120, v120
    v_exp_f32 v121, v121
    v_smfmac_f32_32x32x32_bf16 v[128:143], v[180:183], v[112:119], v16
    ds_read_b128 v[180:183], v188 offset:36224
    ds_read_b128 v[228:231], v242 offset:22528
    v_exp_f32 v122, v122
    v_exp_f32 v123, v123
    v_exp_f32 v124, v124
    v_exp_f32 v125, v125
    v_exp_f32 v126, v126
    v_exp_f32 v127, v127
    s_waitcnt vmcnt(5)
    s_waitcnt lgkmcnt(0)
    s_barrier
    v_mfma_f32_32x32x16_bf16 v[96:111], v[160:163], v[4:7], v[144:159]
    s_add_u32 m0, s66, 139264
    s_add_u32 s68, s42, 890880
    buffer_load_dwordx4 v27, s[52:55], s68 offen sc1 lds
    v_exp_f32 v64, v64
    v_exp_f32 v65, v65
    v_exp_f32 v66, v66
    v_smfmac_f32_32x32x32_bf16 v[128:143], v[184:187], v[120:127], v16
    ds_read_b128 v[184:187], v188 offset:36928
    s_add_u32 m0, s66, 147456
    s_add_u32 s68, s42, 899072
    buffer_load_dwordx4 v27, s[52:55], s68 offen sc1 lds
    v_exp_f32 v67, v67
    v_exp_f32 v68, v68
    v_exp_f32 v69, v69
    v_mfma_f32_32x32x16_bf16 v[112:127], v[164:167], v[4:7], v[144:159]
    s_cmp_lt_u32 s60, 4
    s_cbranch_scc0 Lwo_72
    s_add_u32 m0, s66, 155648
    s_add_u32 s68, s42, 907264
    buffer_load_dwordx4 v27, s[52:55], s68 offen sc1 lds
Lwo_72:
    v_exp_f32 v70, v70
    v_exp_f32 v71, v71
    v_exp_f32 v72, v72
    v_exp_f32 v73, v73
    v_smfmac_f32_32x32x32_bf16 v[128:143], v[172:175], v[64:71], v16
    ds_read_b128 v[172:175], v188 offset:40192
    s_mov_b32 s68, 12066816
    buffer_load_dwordx4 v[52:55], v29, s[52:55], s68 offen offset:2048 sc1
    v_exp_f32 v74, v74
    v_exp_f32 v75, v75
    v_exp_f32 v76, v76
    v_exp_f32 v77, v77
    v_mfma_f32_32x32x4_2b_bf16 v[96:127], v[168:169], v[8:9], v[96:127]
    s_mov_b32 s68, 12070912
    buffer_load_dwordx4 v[56:59], v29, s[52:55], s68 offen offset:0 sc1
    v_exp_f32 v78, v78
    v_exp_f32 v79, v79
    v_exp_f32 v80, v80
    v_exp_f32 v81, v81
    v_exp_f32 v82, v82
    v_exp_f32 v83, v83
    v_exp_f32 v84, v84
    v_exp_f32 v85, v85
    v_smfmac_f32_32x32x32_bf16 v[128:143], v[176:179], v[72:79], v16
    ds_read_b128 v[176:179], v188 offset:40896
    s_mov_b32 s68, 12070912
    buffer_load_dwordx4 v[60:63], v29, s[52:55], s68 offen offset:2048 sc1
    v_exp_f32 v86, v86
    v_exp_f32 v87, v87
    v_exp_f32 v88, v88
    v_exp_f32 v89, v89
    v_smfmac_f32_32x32x32_bf16 v[128:143], v[180:183], v[80:87], v16
    ds_read_b128 v[180:183], v188 offset:41600
    s_mov_b32 s68, 12075008
    buffer_load_dwordx4 v[232:235], v29, s[52:55], s68 offen offset:0 sc1
    v_exp_f32 v90, v90
    v_exp_f32 v91, v91
    v_exp_f32 v92, v92
    v_exp_f32 v93, v93
    v_exp_f32 v94, v94
    v_exp_f32 v95, v95
    s_cmp_ge_u32 s60, 4
    s_setprio 1
    s_cbranch_scc1 Lp_73
    s_setprio 0
Lp_73:
    s_mov_b32 s68, 12075008
    buffer_load_dwordx4 v[236:239], v29, s[52:55], s68 offen offset:2048 sc1
    v_exp_f32 v96, v96
    v_exp_f32 v97, v97
    v_exp_f32 v98, v98
    s_waitcnt lgkmcnt(3)
    v_smfmac_f32_32x32x32_bf16 v[128:143], v[184:187], v[88:95], v16
    ds_read_b128 v[184:187], v188 offset:42304
    v_exp_f32 v99, v99
    v_exp_f32 v100, v100
    v_exp_f32 v101, v101
    s_add_u32 m0, s66, 53248
    s_add_u32 s68, s42, 0
    buffer_load_dwordx4 v27, s[52:55], s68 offen sc1 lds
    v_exp_f32 v102, v102
    v_exp_f32 v103, v103
    v_exp_f32 v104, v104
    v_exp_f32 v105, v105
    s_waitcnt lgkmcnt(3)
    v_smfmac_f32_32x32x32_bf16 v[128:143], v[172:175], v[96:103], v16
    s_cmp_lt_u32 s60, 2
    s_cbranch_scc0 Lwo_74
    s_add_u32 m0, s66, 61440
    s_add_u32 s68, s42, 8192
    buffer_load_dwordx4 v27, s[52:55], s68 offen sc1 lds
Lwo_74:
    v_exp_f32 v106, v106
    v_exp_f32 v107, v107
    v_exp_f32 v108, v108
    v_exp_f32 v109, v109
    s_add_u32 m0, s66, 0
    s_add_u32 s68, s42, 10240
    buffer_load_dwordx4 v27, s[52:55], s68 offen sc1 lds
    v_exp_f32 v110, v110
    v_exp_f32 v111, v111
    v_exp_f32 v112, v112
    v_exp_f32 v113, v113
    v_exp_f32 v114, v114
    v_exp_f32 v115, v115
    v_exp_f32 v116, v116
    v_exp_f32 v117, v117
    s_waitcnt lgkmcnt(1)
    v_smfmac_f32_32x32x32_bf16 v[128:143], v[176:179], v[104:111], v16
    s_add_u32 m0, s66, 8192
    s_add_u32 s68, s42, 18432
    buffer_load_dwordx4 v27, s[52:55], s68 offen sc1 lds
    v_exp_f32 v118, v118
    v_exp_f32 v119, v119
    v_exp_f32 v120, v120
    v_exp_f32 v121, v121
    v_smfmac_f32_32x32x32_bf16 v[128:143], v[180:183], v[112:119], v16
    s_cmp_lt_u32 s60, 4
    s_cbranch_scc0 Lwo_75
    s_add_u32 m0, s66, 16384
    s_add_u32 s68, s42, 26624
    buffer_load_dwordx4 v27, s[52:55], s68 offen sc1 lds
Lwo_75:
    v_exp_f32 v122, v122
    v_exp_f32 v123, v123
    v_exp_f32 v124, v124
    v_exp_f32 v125, v125
    v_exp_f32 v126, v126
    v_exp_f32 v127, v127
    s_waitcnt lgkmcnt(0)
    s_nop 0
    v_smfmac_f32_32x32x32_bf16 v[128:143], v[184:187], v[120:127], v16
    ds_read_b128 v[64:67], v241 offset:0
    ds_read_b128 v[68:71], v241 offset:1024
    ds_read_b128 v[72:75], v241 offset:2048
    ds_read_b128 v[76:79], v241 offset:3072
    ds_read_b128 v[80:83], v241 offset:4096
    s_nop 6
    v_mov_b32 v1, v136
    v_mov_b32 v2, v136
    s_nop 1
    v_permlane32_swap_b32 v1, v2
    s_mov_b32 s70, 1602224128
    v_cmp_nge_f32 vcc, s70, v2
    s_cmp_lg_u32 s79, 0
    s_cbranch_scc1 Lgood_77
    s_cbranch_vccz Lgood_77
    v_mov_b32 v1, 64512
    v_mov_b32 v2, 1
    ds_write_b32 v1, v2
    s_branch Lbad_76
Lgood_77:
    v_rcp_f32 v2, v2
    s_nop 0
    v_pk_mul_f32 v[128:129], v[128:129], v[2:3] op_sel_hi:[1,0]
    v_pk_mul_f32 v[130:131], v[130:131], v[2:3] op_sel_hi:[1,0]
    v_pk_mul_f32 v[132:133], v[132:133], v[2:3] op_sel_hi:[1,0]
    v_pk_mul_f32 v[134:135], v[134:135], v[2:3] op_sel_hi:[1,0]
    v_pk_mul_f32 v[136:137], v[136:137], v[2:3] op_sel_hi:[1,0]
    v_pk_mul_f32 v[138:139], v[138:139], v[2:3] op_sel_hi:[1,0]
    v_cvt_pk_bf16_f32 v128, v128, v129
    v_cvt_pk_bf16_f32 v129, v130, v131
    v_cvt_pk_bf16_f32 v130, v132, v133
    v_cvt_pk_bf16_f32 v131, v134, v135
    v_cvt_pk_bf16_f32 v132, v136, v137
    v_cvt_pk_bf16_f32 v133, v138, v139
    v_min_u32 v128, -2, v128
    v_min_u32 v129, -2, v129
    v_min_u32 v130, -2, v130
    v_min_u32 v131, -2, v131
    v_min_u32 v132, -2, v132
    v_min_u32 v133, -2, v133
    buffer_store_dwordx4 v[128:131], v18, s[52:55], 0 offen sc1
    buffer_store_dwordx2 v[132:133], v19, s[52:55], 0 offen sc1
Lbad_76:
    s_movk_i32 s75, 1280
    s_waitcnt vmcnt(16)
    v_max3_u32 v1, v32, v33, v34
    v_max_u32 v1, v1, v35
    v_cmp_eq_u32 vcc, -1, v1
    s_nop 0
    s_cbranch_vccnz Lofretry_79
Lofok_78:
    s_waitcnt lgkmcnt(4)
    v_mfma_f32_16x16x32_bf16 v[104:107], v[64:67], v[32:35], 0
    ds_read_b128 v[84:87], v241 offset:10240
    s_waitcnt lgkmcnt(4)
    v_mfma_f32_16x16x32_bf16 v[108:111], v[68:71], v[32:35], 0
    ds_read_b128 v[88:91], v241 offset:11264
    s_waitcnt vmcnt(15)
    v_max3_u32 v1, v36, v37, v38
    s_waitcnt lgkmcnt(4)
    v_mfma_f32_16x16x32_bf16 v[112:115], v[72:75], v[32:35], 0
    ds_read_b128 v[92:95], v241 offset:12288
    v_max_u32 v1, v1, v39
    s_waitcnt lgkmcnt(4)
    v_mfma_f32_16x16x32_bf16 v[116:119], v[76:79], v[32:35], 0
    ds_read_b128 v[96:99], v241 offset:13312
    v_cmp_eq_u32 vcc, -1, v1
    s_waitcnt lgkmcnt(4)
    v_mfma_f32_16x16x32_bf16 v[120:123], v[80:83], v[32:35], 0
    ds_read_b128 v[100:103], v241 offset:14336
    s_cbranch_vccnz Lofretry_81
Lofok_80:
    s_waitcnt lgkmcnt(4)
    v_mfma_f32_16x16x32_bf16 v[104:107], v[84:87], v[36:39], v[104:107]
    ds_read_b128 v[64:67], v241 offset:20480
    s_waitcnt lgkmcnt(4)
    v_mfma_f32_16x16x32_bf16 v[108:111], v[88:91], v[36:39], v[108:111]
    ds_read_b128 v[68:71], v241 offset:21504
    s_waitcnt vmcnt(14)
    v_max3_u32 v1, v40, v41, v42
    s_waitcnt lgkmcnt(4)
    v_mfma_f32_16x16x32_bf16 v[112:115], v[92:95], v[36:39], v[112:115]
    ds_read_b128 v[72:75], v241 offset:22528
    v_max_u32 v1, v1, v43
    s_waitcnt lgkmcnt(4)
    v_mfma_f32_16x16x32_bf16 v[116:119], v[96:99], v[36:39], v[116:119]
    ds_read_b128 v[76:79], v241 offset:23552
    v_cmp_eq_u32 vcc, -1, v1
    s_waitcnt lgkmcnt(4)
    v_mfma_f32_16x16x32_bf16 v[120:123], v[100:103], v[36:39], v[120:123]
    ds_read_b128 v[80:83], v241 offset:24576
    s_cbranch_vccnz Lofretry_83
Lofok_82:
    s_waitcnt lgkmcnt(4)
    v_mfma_f32_16x16x32_bf16 v[104:107], v[64:67], v[40:43], v[104:107]
    ds_read_b128 v[84:87], v241 offset:30720
    s_waitcnt lgkmcnt(4)
    v_mfma_f32_16x16x32_bf16 v[108:111], v[68:71], v[40:43], v[108:111]
    ds_read_b128 v[88:91], v241 offset:31744
    s_waitcnt vmcnt(13)
    v_max3_u32 v1, v44, v45, v46
    s_waitcnt lgkmcnt(4)
    v_mfma_f32_16x16x32_bf16 v[112:115], v[72:75], v[40:43], v[112:115]
    ds_read_b128 v[92:95], v241 offset:32768
    v_max_u32 v1, v1, v47
    s_waitcnt lgkmcnt(4)
    v_mfma_f32_16x16x32_bf16 v[116:119], v[76:79], v[40:43], v[116:119]
    ds_read_b128 v[96:99], v241 offset:33792
    v_cmp_eq_u32 vcc, -1, v1
    s_waitcnt lgkmcnt(4)
    v_mfma_f32_16x16x32_bf16 v[120:123], v[80:83], v[40:43], v[120:123]
    ds_read_b128 v[100:103], v241 offset:34816
    s_cbranch_vccnz Lofretry_85
Lofok_84:
    s_waitcnt vmcnt(10)
    s_barrier
    v_mov_b32 v2, 64512
    ds_read_b32 v3, v2
    s_waitcnt lgkmcnt(5)
    v_mfma_f32_16x16x32_bf16 v[104:107], v[84:87], v[44:47], v[104:107]
    ds_read_b128 v[64:67], v241 offset:40960
    s_waitcnt lgkmcnt(5)
    v_mfma_f32_16x16x32_bf16 v[108:111], v[88:91], v[44:47], v[108:111]
    ds_read_b128 v[68:71], v241 offset:41984
    v_max3_u32 v1, v48, v49, v50
    s_waitcnt lgkmcnt(5)
    v_mfma_f32_16x16x32_bf16 v[112:115], v[92:95], v[44:47], v[112:115]
    ds_read_b128 v[72:75], v241 offset:43008
    v_max_u32 v1, v1, v51
    s_waitcnt lgkmcnt(5)
    v_mfma_f32_16x16x32_bf16 v[116:119], v[96:99], v[44:47], v[116:119]
    ds_read_b128 v[76:79], v241 offset:44032
    v_cmp_eq_u32 vcc, -1, v1
    s_waitcnt lgkmcnt(5)
    v_mfma_f32_16x16x32_bf16 v[120:123], v[100:103], v[44:47], v[120:123]
    ds_read_b128 v[80:83], v241 offset:45056
    s_cbranch_vccnz Lofretry_87
Lofok_86:
    s_waitcnt lgkmcnt(5)
    v_readfirstlane_b32 s70, v3
    s_nop 0
    s_cmp_lg_u32 s70, s79
    s_cbranch_scc1 L_fallback
    s_waitcnt lgkmcnt(4)
    v_mfma_f32_16x16x32_bf16 v[104:107], v[64:67], v[48:51], v[104:107]
    ds_read_b128 v[84:87], v241 offset:51200
    s_add_u32 m0, s66, 21504
    s_add_u32 s68, s42, 30720
    buffer_load_dwordx4 v27, s[52:55], s68 offen sc1 lds
    s_waitcnt lgkmcnt(4)
    v_mfma_f32_16x16x32_bf16 v[108:111], v[68:71], v[48:51], v[108:111]
    ds_read_b128 v[88:91], v241 offset:52224
    s_waitcnt vmcnt(10)
    v_max3_u32 v1, v52, v53, v54
    s_add_u32 m0, s66, 29696
    s_add_u32 s68, s42, 38912
    buffer_load_dwordx4 v27, s[52:55], s68 offen sc1 lds
    s_waitcnt lgkmcnt(4)
    v_mfma_f32_16x16x32_bf16 v[112:115], v[72:75], v[48:51], v[112:115]
    ds_read_b128 v[92:95], v241 offset:53248
    v_max_u32 v1, v1, v55
    s_waitcnt lgkmcnt(4)
    v_mfma_f32_16x16x32_bf16 v[116:119], v[76:79], v[48:51], v[116:119]
    ds_read_b128 v[96:99], v241 offset:54272
    v_cmp_eq_u32 vcc, -1, v1
    s_waitcnt lgkmcnt(4)
    v_mfma_f32_16x16x32_bf16 v[120:123], v[80:83], v[48:51], v[120:123]
    ds_read_b128 v[100:103], v241 offset:55296
    s_cbranch_vccnz Lofretry_89
Lofok_88:
    s_waitcnt lgkmcnt(4)
    v_mfma_f32_16x16x32_bf16 v[104:107], v[84:87], v[52:55], v[104:107]
    ds_read_b128 v[64:67], v241 offset:61440
    s_cmp_lt_u32 s60, 4
    s_cbranch_scc0 Lwo_90
    s_add_u32 m0, s66, 37888
    s_add_u32 s68, s42, 47104
    buffer_load_dwordx4 v27, s[52:55], s68 offen sc1 lds
Lwo_90:
    s_waitcnt lgkmcnt(4)
    v_mfma_f32_16x16x32_bf16 v[108:111], v[88:91], v[52:55], v[108:111]
    ds_read_b128 v[68:71], v241 offset:62464
    s_waitcnt vmcnt(10)
    v_max3_u32 v1, v56, v57, v58
    s_add_u32 m0, s66, 65536
    s_add_u32 s68, s42, 51200
    buffer_load_dwordx4 v27, s[52:55], s68 offen sc1 lds
    s_waitcnt lgkmcnt(4)
    v_mfma_f32_16x16x32_bf16 v[112:115], v[92:95], v[52:55], v[112:115]
    ds_read_b128 v[72:75], v241 offset:63488
    v_max_u32 v1, v1, v59
    s_waitcnt lgkmcnt(4)
    v_mfma_f32_16x16x32_bf16 v[116:119], v[96:99], v[52:55], v[116:119]
    ds_read_b128 v[76:79], v241 offset:64512
    v_cmp_eq_u32 vcc, -1, v1
    s_waitcnt lgkmcnt(4)
    v_mfma_f32_16x16x32_bf16 v[120:123], v[100:103], v[52:55], v[120:123]
    ds_read_b128 v[80:83], v242 offset:0
    s_cbranch_vccnz Lofretry_92
Lofok_91:
    s_waitcnt lgkmcnt(4)
    v_mfma_f32_16x16x32_bf16 v[104:107], v[64:67], v[56:59], v[104:107]
    ds_read_b128 v[84:87], v242 offset:8192
    s_add_u32 m0, s66, 73728
    s_add_u32 s68, s42, 59392
    buffer_load_dwordx4 v27, s[52:55], s68 offen sc1 lds
    s_waitcnt lgkmcnt(4)
    v_mfma_f32_16x16x32_bf16 v[108:111], v[68:71], v[56:59], v[108:111]
    ds_read_b128 v[88:91], v242 offset:9216
    s_waitcnt vmcnt(11)
    v_max3_u32 v1, v60, v61, v62
    s_add_u32 m0, s66, 81920
    s_add_u32 s68, s42, 67584
    buffer_load_dwordx4 v27, s[52:55], s68 offen sc1 lds
    s_waitcnt lgkmcnt(4)
    v_mfma_f32_16x16x32_bf16 v[112:115], v[72:75], v[56:59], v[112:115]
    ds_read_b128 v[92:95], v242 offset:10240
    v_max_u32 v1, v1, v63
    s_waitcnt lgkmcnt(4)
    v_mfma_f32_16x16x32_bf16 v[116:119], v[76:79], v[56:59], v[116:119]
    ds_read_b128 v[96:99], v242 offset:11264
    v_cmp_eq_u32 vcc, -1, v1
    s_waitcnt lgkmcnt(4)
    v_mfma_f32_16x16x32_bf16 v[120:123], v[80:83], v[56:59], v[120:123]
    ds_read_b128 v[100:103], v242 offset:12288
    s_cbranch_vccnz Lofretry_94
Lofok_93:
    s_waitcnt lgkmcnt(4)
    v_mfma_f32_16x16x32_bf16 v[104:107], v[84:87], v[60:63], v[104:107]
    ds_read_b128 v[64:67], v242 offset:18432
    s_cmp_lt_u32 s60, 6
    s_cbranch_scc0 Lwo_95
    s_add_u32 m0, s66, 90112
    s_add_u32 s68, s42, 75776
    buffer_load_dwordx4 v27, s[52:55], s68 offen sc1 lds
Lwo_95:
    s_waitcnt lgkmcnt(4)
    v_mfma_f32_16x16x32_bf16 v[108:111], v[88:91], v[60:63], v[108:111]
    ds_read_b128 v[68:71], v242 offset:19456
    s_waitcnt vmcnt(11)
    v_max3_u32 v1, v232, v233, v234
    s_mov_b32 s68, 9437184
    buffer_load_dwordx4 v[144:147], v29, s[52:55], s68 offen offset:0 sc1
    s_waitcnt lgkmcnt(4)
    v_mfma_f32_16x16x32_bf16 v[112:115], v[92:95], v[60:63], v[112:115]
    ds_read_b128 v[72:75], v242 offset:20480
    v_max_u32 v1, v1, v235
    s_waitcnt lgkmcnt(4)
    v_mfma_f32_16x16x32_bf16 v[116:119], v[96:99], v[60:63], v[116:119]
    ds_read_b128 v[76:79], v242 offset:21504
    v_cmp_eq_u32 vcc, -1, v1
    s_waitcnt lgkmcnt(4)
    v_mfma_f32_16x16x32_bf16 v[120:123], v[100:103], v[60:63], v[120:123]
    ds_read_b128 v[80:83], v242 offset:22528
    s_cbranch_vccnz Lofretry_97
Lofok_96:
    s_waitcnt lgkmcnt(4)
    v_mfma_f32_16x16x32_bf16 v[104:107], v[64:67], v[232:235], v[104:107]
    ds_read_b128 v[84:87], v240 offset:43008
    s_mov_b32 s68, 9437184
    buffer_load_dwordx4 v[148:151], v29, s[52:55], s68 offen offset:2048 sc1
    s_waitcnt lgkmcnt(4)
    v_mfma_f32_16x16x32_bf16 v[108:111], v[68:71], v[232:235], v[108:111]
    ds_read_b128 v[88:91], v240 offset:44032
    s_waitcnt vmcnt(12)
    v_max3_u32 v1, v236, v237, v238
    s_mov_b32 s68, 9441280
    buffer_load_dwordx4 v[152:155], v29, s[52:55], s68 offen offset:0 sc1
    s_waitcnt lgkmcnt(4)
    v_mfma_f32_16x16x32_bf16 v[112:115], v[72:75], v[232:235], v[112:115]
    ds_read_b128 v[92:95], v240 offset:45056
    v_max_u32 v1, v1, v239
    s_waitcnt lgkmcnt(4)
    v_mfma_f32_16x16x32_bf16 v[116:119], v[76:79], v[232:235], v[116:119]
    ds_read_b128 v[96:99], v240 offset:46080
    v_cmp_eq_u32 vcc, -1, v1
    s_waitcnt lgkmcnt(4)
    v_mfma_f32_16x16x32_bf16 v[120:123], v[80:83], v[232:235], v[120:123]
    ds_read_b128 v[100:103], v240 offset:47104
    s_cbranch_vccnz Lofretry_99
Lofok_98:
    s_waitcnt vmcnt(6)
    s_barrier
    s_waitcnt lgkmcnt(4)
    v_mfma_f32_16x16x32_bf16 v[104:107], v[84:87], v[236:239], v[104:107]
    ds_read_b128 v[64:67], v240 offset:53248
    s_mov_b32 s68, 9441280
    buffer_load_dwordx4 v[156:159], v29, s[52:55], s68 offen offset:2048 sc1
    s_waitcnt lgkmcnt(4)
    v_mfma_f32_16x16x32_bf16 v[108:111], v[88:91], v[236:239], v[108:111]
    ds_read_b128 v[68:71], v240 offset:54272
    s_waitcnt vmcnt(3)
    v_max3_u32 v1, v144, v145, v146
    s_mov_b32 s68, 9445376
    buffer_load_dwordx4 v[160:163], v29, s[52:55], s68 offen offset:0 sc1
    s_waitcnt lgkmcnt(4)
    v_mfma_f32_16x16x32_bf16 v[112:115], v[92:95], v[236:239], v[112:115]
    ds_read_b128 v[72:75], v240 offset:55296
    v_max_u32 v1, v1, v147
    s_waitcnt lgkmcnt(4)
    v_mfma_f32_16x16x32_bf16 v[116:119], v[96:99], v[236:239], v[116:119]
    ds_read_b128 v[76:79], v240 offset:56320
    v_cmp_eq_u32 vcc, -1, v1
    s_waitcnt lgkmcnt(4)
    v_mfma_f32_16x16x32_bf16 v[120:123], v[100:103], v[236:239], v[120:123]
    ds_read_b128 v[80:83], v240 offset:57344
    s_cbranch_vccnz Lofretry_101
Lofok_100:
    s_waitcnt lgkmcnt(4)
    v_mfma_f32_16x16x32_bf16 v[124:127], v[64:67], v[144:147], 0
    ds_read_b128 v[84:87], v240 offset:0
    s_mov_b32 s68, 9445376
    buffer_load_dwordx4 v[164:167], v29, s[52:55], s68 offen offset:2048 sc1
    s_waitcnt lgkmcnt(4)
    v_mfma_f32_16x16x32_bf16 v[128:131], v[68:71], v[144:147], 0
    ds_read_b128 v[88:91], v240 offset:1024
    s_waitcnt vmcnt(4)
    v_max3_u32 v1, v148, v149, v150
    s_mov_b32 s68, 9449472
    buffer_load_dwordx4 v[168:171], v29, s[52:55], s68 offen offset:0 sc1
    s_waitcnt lgkmcnt(4)
    v_mfma_f32_16x16x32_bf16 v[132:135], v[72:75], v[144:147], 0
    ds_read_b128 v[92:95], v240 offset:2048
    v_max_u32 v1, v1, v151
    s_waitcnt lgkmcnt(4)
    v_mfma_f32_16x16x32_bf16 v[136:139], v[76:79], v[144:147], 0
    ds_read_b128 v[96:99], v240 offset:3072
    v_cmp_eq_u32 vcc, -1, v1
    s_waitcnt lgkmcnt(4)
    v_mfma_f32_16x16x32_bf16 v[140:143], v[80:83], v[144:147], 0
    ds_read_b128 v[100:103], v240 offset:4096
    s_cbranch_vccnz Lofretry_103
Lofok_102:
    s_cmp_ge_u32 s60, 4
    s_cbranch_scc1 Lhi_104
    ds_write_b128 v243, v[120:123] offset:31744
    ds_write_b128 v243, v[116:119] offset:30720
    s_branch Ljoin_105
Lhi_104:
    ds_write_b128 v243, v[112:115] offset:34816
    ds_write_b128 v243, v[108:111] offset:33792
    ds_write_b128 v243, v[104:107] offset:32768
Ljoin_105:
    s_waitcnt lgkmcnt(6)
    v_mfma_f32_16x16x32_bf16 v[124:127], v[84:87], v[148:151], v[124:127]
    ds_read_b128 v[64:67], v240 offset:10240
    s_mov_b32 s68, 9449472
    buffer_load_dwordx4 v[172:175], v29, s[52:55], s68 offen offset:2048 sc1
    s_waitcnt lgkmcnt(6)
    v_mfma_f32_16x16x32_bf16 v[128:131], v[88:91], v[148:151], v[128:131]
    ds_read_b128 v[68:71], v240 offset:11264
    s_waitcnt vmcnt(5)
    v_max3_u32 v1, v152, v153, v154
    s_mov_b32 s68, 9453568
    buffer_load_dwordx4 v[176:179], v29, s[52:55], s68 offen offset:0 sc1
    s_waitcnt lgkmcnt(6)
    v_mfma_f32_16x16x32_bf16 v[132:135], v[92:95], v[148:151], v[132:135]
    ds_read_b128 v[72:75], v240 offset:12288
    v_max_u32 v1, v1, v155
    s_waitcnt lgkmcnt(6)
    v_mfma_f32_16x16x32_bf16 v[136:139], v[96:99], v[148:151], v[136:139]
    ds_read_b128 v[76:79], v240 offset:13312
    v_cmp_eq_u32 vcc, -1, v1
    s_waitcnt lgkmcnt(6)
    v_mfma_f32_16x16x32_bf16 v[140:143], v[100:103], v[148:151], v[140:143]
    ds_read_b128 v[80:83], v240 offset:14336
    s_cbranch_vccnz Lofretry_107
Lofok_106:
    s_waitcnt lgkmcnt(4)
    v_mfma_f32_16x16x32_bf16 v[124:127], v[64:67], v[152:155], v[124:127]
    ds_read_b128 v[84:87], v240 offset:21504
    s_mov_b32 s68, 9453568
    buffer_load_dwordx4 v[180:183], v29, s[52:55], s68 offen offset:2048 sc1
    s_waitcnt lgkmcnt(4)
    v_mfma_f32_16x16x32_bf16 v[128:131], v[68:71], v[152:155], v[128:131]
    ds_read_b128 v[88:91], v240 offset:22528
    s_waitcnt vmcnt(6)
    v_max3_u32 v1, v156, v157, v158
    s_waitcnt lgkmcnt(4)
    v_mfma_f32_16x16x32_bf16 v[132:135], v[72:75], v[152:155], v[132:135]
    ds_read_b128 v[92:95], v240 offset:23552
    v_max_u32 v1, v1, v159
    s_waitcnt lgkmcnt(4)
    v_mfma_f32_16x16x32_bf16 v[136:139], v[76:79], v[152:155], v[136:139]
    ds_read_b128 v[96:99], v240 offset:24576
    v_cmp_eq_u32 vcc, -1, v1
    s_waitcnt lgkmcnt(4)
    v_mfma_f32_16x16x32_bf16 v[140:143], v[80:83], v[152:155], v[140:143]
    ds_read_b128 v[100:103], v240 offset:25600
    s_cbranch_vccnz Lofretry_109
Lofok_108:
    s_waitcnt lgkmcnt(4)
    v_mfma_f32_16x16x32_bf16 v[124:127], v[84:87], v[156:159], v[124:127]
    ds_read_b128 v[64:67], v240 offset:31744
    s_waitcnt lgkmcnt(4)
    v_mfma_f32_16x16x32_bf16 v[128:131], v[88:91], v[156:159], v[128:131]
    ds_read_b128 v[68:71], v240 offset:32768
    s_waitcnt vmcnt(5)
    v_max3_u32 v1, v160, v161, v162
    s_waitcnt lgkmcnt(4)
    v_mfma_f32_16x16x32_bf16 v[132:135], v[92:95], v[156:159], v[132:135]
    ds_read_b128 v[72:75], v240 offset:33792
    v_max_u32 v1, v1, v163
    s_waitcnt lgkmcnt(4)
    v_mfma_f32_16x16x32_bf16 v[136:139], v[96:99], v[156:159], v[136:139]
    ds_read_b128 v[76:79], v240 offset:34816
    v_cmp_eq_u32 vcc, -1, v1
    s_waitcnt lgkmcnt(4)
    v_mfma_f32_16x16x32_bf16 v[140:143], v[100:103], v[156:159], v[140:143]
    ds_read_b128 v[80:83], v240 offset:35840
    s_cbranch_vccnz Lofretry_111
Lofok_110:
    s_barrier
    s_cmp_ge_u32 s60, 4
    s_cbranch_scc1 Lhi_112
    ds_read_b128 v[20:23], v243 offset:34816
    ds_read_b128 v[16:19], v243 offset:33792
    ds_read_b128 v[12:15], v243 offset:32768
    s_branch Ljoin_113
Lhi_112:
    ds_read_b128 v[16:19], v243 offset:31744
    ds_read_b128 v[12:15], v243 offset:30720
Ljoin_113:
    s_waitcnt lgkmcnt(6)
    v_mfma_f32_16x16x32_bf16 v[124:127], v[64:67], v[160:163], v[124:127]
    ds_read_b128 v[84:87], v241 offset:0
    s_waitcnt lgkmcnt(6)
    v_mfma_f32_16x16x32_bf16 v[128:131], v[68:71], v[160:163], v[128:131]
    ds_read_b128 v[88:91], v241 offset:1024
    s_waitcnt vmcnt(4)
    v_max3_u32 v1, v164, v165, v166
    s_waitcnt lgkmcnt(6)
    v_mfma_f32_16x16x32_bf16 v[132:135], v[72:75], v[160:163], v[132:135]
    ds_read_b128 v[92:95], v241 offset:2048
    v_max_u32 v1, v1, v167
    s_waitcnt lgkmcnt(6)
    v_mfma_f32_16x16x32_bf16 v[136:139], v[76:79], v[160:163], v[136:139]
    ds_read_b128 v[96:99], v241 offset:3072
    v_cmp_eq_u32 vcc, -1, v1
    s_waitcnt lgkmcnt(6)
    v_mfma_f32_16x16x32_bf16 v[140:143], v[80:83], v[160:163], v[140:143]
    ds_read_b128 v[100:103], v241 offset:4096
    s_cbranch_vccnz Lofretry_115
Lofok_114:
    s_waitcnt lgkmcnt(4)
    v_mfma_f32_16x16x32_bf16 v[124:127], v[84:87], v[164:167], v[124:127]
    ds_read_b128 v[64:67], v241 offset:10240
    s_waitcnt lgkmcnt(4)
    v_mfma_f32_16x16x32_bf16 v[128:131], v[88:91], v[164:167], v[128:131]
    ds_read_b128 v[68:71], v241 offset:11264
    s_waitcnt vmcnt(3)
    v_max3_u32 v1, v168, v169, v170
    s_waitcnt lgkmcnt(4)
    v_mfma_f32_16x16x32_bf16 v[132:135], v[92:95], v[164:167], v[132:135]
    ds_read_b128 v[72:75], v241 offset:12288
    v_max_u32 v1, v1, v171
    s_waitcnt lgkmcnt(4)
    v_mfma_f32_16x16x32_bf16 v[136:139], v[96:99], v[164:167], v[136:139]
    ds_read_b128 v[76:79], v241 offset:13312
    v_cmp_eq_u32 vcc, -1, v1
    s_waitcnt lgkmcnt(4)
    v_mfma_f32_16x16x32_bf16 v[140:143], v[100:103], v[164:167], v[140:143]
    ds_read_b128 v[80:83], v241 offset:14336
    s_cbranch_vccnz Lofretry_117
Lofok_116:
    s_cmp_ge_u32 s60, 4
    s_cbranch_scc1 Lhi_118
    v_pk_add_f32 v[12:13], v[12:13], v[104:105]
    v_pk_add_f32 v[14:15], v[14:15], v[106:107]
    v_cvt_pk_bf16_f32 v12, v12, v13
    v_cvt_pk_bf16_f32 v13, v14, v15
    v_pk_add_f32 v[16:17], v[16:17], v[108:109]
    v_pk_add_f32 v[18:19], v[18:19], v[110:111]
    v_cvt_pk_bf16_f32 v14, v16, v17
    v_cvt_pk_bf16_f32 v15, v18, v19
    s_nop 1
    v_permlane16_swap_b32 v12, v14
    v_permlane16_swap_b32 v13, v15
    buffer_store_dwordx4 v[12:15], v26, s[48:51], 0 offen offset:0
    v_pk_add_f32 v[20:21], v[20:21], v[112:113]
    v_pk_add_f32 v[22:23], v[22:23], v[114:115]
    v_cvt_pk_bf16_f32 v20, v20, v21
    v_cvt_pk_bf16_f32 v21, v22, v23
    buffer_store_dwordx2 v[20:21], v244, s[48:51], 0 offen offset:64
    s_branch Ljoin_119
Lhi_118:
    v_pk_add_f32 v[12:13], v[12:13], v[116:117]
    v_pk_add_f32 v[14:15], v[14:15], v[118:119]
    v_cvt_pk_bf16_f32 v12, v12, v13
    v_cvt_pk_bf16_f32 v13, v14, v15
    v_pk_add_f32 v[16:17], v[16:17], v[120:121]
    v_pk_add_f32 v[18:19], v[18:19], v[122:123]
    v_cvt_pk_bf16_f32 v14, v16, v17
    v_cvt_pk_bf16_f32 v15, v18, v19
    s_nop 1
    v_permlane16_swap_b32 v12, v14
    v_permlane16_swap_b32 v13, v15
    buffer_store_dwordx4 v[12:15], v26, s[48:51], 0 offen offset:96
Ljoin_119:
    s_waitcnt lgkmcnt(4)
    v_mfma_f32_16x16x32_bf16 v[124:127], v[64:67], v[168:171], v[124:127]
    ds_read_b128 v[84:87], v241 offset:20480
    s_waitcnt lgkmcnt(4)
    v_mfma_f32_16x16x32_bf16 v[128:131], v[68:71], v[168:171], v[128:131]
    ds_read_b128 v[88:91], v241 offset:21504
    s_waitcnt vmcnt(2)
    v_max3_u32 v1, v172, v173, v174
    s_waitcnt lgkmcnt(4)
    v_mfma_f32_16x16x32_bf16 v[132:135], v[72:75], v[168:171], v[132:135]
    ds_read_b128 v[92:95], v241 offset:22528
    v_max_u32 v1, v1, v175
    s_waitcnt lgkmcnt(4)
    v_mfma_f32_16x16x32_bf16 v[136:139], v[76:79], v[168:171], v[136:139]
    ds_read_b128 v[96:99], v241 offset:23552
    v_cmp_eq_u32 vcc, -1, v1
    s_waitcnt lgkmcnt(4)
    v_mfma_f32_16x16x32_bf16 v[140:143], v[80:83], v[168:171], v[140:143]
    ds_read_b128 v[100:103], v241 offset:24576
    s_cbranch_vccnz Lofretry_121
Lofok_120:
    s_waitcnt lgkmcnt(4)
    v_mfma_f32_16x16x32_bf16 v[124:127], v[84:87], v[172:175], v[124:127]
    s_waitcnt lgkmcnt(3)
    v_mfma_f32_16x16x32_bf16 v[128:131], v[88:91], v[172:175], v[128:131]
    s_waitcnt vmcnt(1)
    v_max3_u32 v1, v176, v177, v178
    s_waitcnt lgkmcnt(2)
    v_mfma_f32_16x16x32_bf16 v[132:135], v[92:95], v[172:175], v[132:135]
    v_max_u32 v1, v1, v179
    s_waitcnt lgkmcnt(1)
    v_mfma_f32_16x16x32_bf16 v[136:139], v[96:99], v[172:175], v[136:139]
    v_cmp_eq_u32 vcc, -1, v1
    s_waitcnt lgkmcnt(0)
    v_mfma_f32_16x16x32_bf16 v[140:143], v[100:103], v[172:175], v[140:143]
    s_cbranch_vccnz Lofretry_123
Lofok_122:
    s_waitcnt vmcnt(0)
    v_max3_u32 v1, v180, v181, v182
    v_max_u32 v1, v1, v183
    v_cmp_eq_u32 vcc, -1, v1
    s_nop 0
    s_cbranch_vccnz Lofretry_125
Lofok_124:
    s_cmp_ge_u32 s60, 4
    s_cbranch_scc1 Lhi_126
    v_mfma_f32_16x16x32_bf16 v[136:139], v[204:207], v[176:179], v[136:139]
    v_mfma_f32_16x16x32_bf16 v[140:143], v[208:211], v[176:179], v[140:143]
    v_mfma_f32_16x16x32_bf16 v[136:139], v[224:227], v[180:183], v[136:139]
    v_mfma_f32_16x16x32_bf16 v[140:143], v[228:231], v[180:183], v[140:143]
    v_mfma_f32_16x16x32_bf16 v[124:127], v[192:195], v[176:179], v[124:127]
    v_mfma_f32_16x16x32_bf16 v[128:131], v[196:199], v[176:179], v[128:131]
    v_mfma_f32_16x16x32_bf16 v[132:135], v[200:203], v[176:179], v[132:135]
    v_mfma_f32_16x16x32_bf16 v[124:127], v[212:215], v[180:183], v[124:127]
    v_mfma_f32_16x16x32_bf16 v[128:131], v[216:219], v[180:183], v[128:131]
    v_mfma_f32_16x16x32_bf16 v[132:135], v[220:223], v[180:183], v[132:135]
    s_nop 0
    ds_write_b128 v243, v[136:139] offset:51200
    ds_write_b128 v243, v[140:143] offset:52224
    s_waitcnt lgkmcnt(0)
    s_barrier
    ds_read_b128 v[64:67], v243 offset:53248
    ds_read_b128 v[68:71], v243 offset:54272
    ds_read_b128 v[72:75], v243 offset:55296
    s_waitcnt lgkmcnt(2)
    v_pk_add_f32 v[64:65], v[64:65], v[124:125]
    v_pk_add_f32 v[66:67], v[66:67], v[126:127]
    v_cvt_pk_bf16_f32 v64, v64, v65
    v_cvt_pk_bf16_f32 v65, v66, v67
    s_waitcnt lgkmcnt(1)
    v_pk_add_f32 v[68:69], v[68:69], v[128:129]
    v_pk_add_f32 v[70:71], v[70:71], v[130:131]
    v_cvt_pk_bf16_f32 v66, v68, v69
    v_cvt_pk_bf16_f32 v67, v70, v71
    s_nop 1
    v_permlane16_swap_b32 v64, v66
    v_permlane16_swap_b32 v65, v67
    buffer_store_dwordx4 v[64:67], v26, s[48:51], s75 offen offset:0
    s_waitcnt lgkmcnt(0)
    v_pk_add_f32 v[72:73], v[72:73], v[132:133]
    v_pk_add_f32 v[74:75], v[74:75], v[134:135]
    v_cvt_pk_bf16_f32 v72, v72, v73
    v_cvt_pk_bf16_f32 v73, v74, v75
    buffer_store_dwordx2 v[72:73], v244, s[48:51], s75 offen offset:64
    s_branch Ljoin_127
Lhi_126:
    v_mfma_f32_16x16x32_bf16 v[124:127], v[192:195], v[176:179], v[124:127]
    v_mfma_f32_16x16x32_bf16 v[128:131], v[196:199], v[176:179], v[128:131]
    v_mfma_f32_16x16x32_bf16 v[132:135], v[200:203], v[176:179], v[132:135]
    v_mfma_f32_16x16x32_bf16 v[124:127], v[212:215], v[180:183], v[124:127]
    v_mfma_f32_16x16x32_bf16 v[128:131], v[216:219], v[180:183], v[128:131]
    v_mfma_f32_16x16x32_bf16 v[132:135], v[220:223], v[180:183], v[132:135]
    v_mfma_f32_16x16x32_bf16 v[136:139], v[204:207], v[176:179], v[136:139]
    v_mfma_f32_16x16x32_bf16 v[140:143], v[208:211], v[176:179], v[140:143]
    v_mfma_f32_16x16x32_bf16 v[136:139], v[224:227], v[180:183], v[136:139]
    v_mfma_f32_16x16x32_bf16 v[140:143], v[228:231], v[180:183], v[140:143]
    s_nop 1
    ds_write_b128 v243, v[124:127] offset:53248
    ds_write_b128 v243, v[128:131] offset:54272
    ds_write_b128 v243, v[132:135] offset:55296
    s_waitcnt lgkmcnt(0)
    s_barrier
    ds_read_b128 v[64:67], v243 offset:51200
    ds_read_b128 v[68:71], v243 offset:52224
    s_waitcnt lgkmcnt(1)
    v_pk_add_f32 v[64:65], v[64:65], v[136:137]
    v_pk_add_f32 v[66:67], v[66:67], v[138:139]
    v_cvt_pk_bf16_f32 v64, v64, v65
    v_cvt_pk_bf16_f32 v65, v66, v67
    s_waitcnt lgkmcnt(0)
    v_pk_add_f32 v[68:69], v[68:69], v[140:141]
    v_pk_add_f32 v[70:71], v[70:71], v[142:143]
    v_cvt_pk_bf16_f32 v66, v68, v69
    v_cvt_pk_bf16_f32 v67, v70, v71
    s_nop 1
    v_permlane16_swap_b32 v64, v66
    v_permlane16_swap_b32 v65, v67
    buffer_store_dwordx4 v[64:67], v26, s[48:51], s75 offen offset:96
Ljoin_127:
L_end:
    s_endpgm
L_cons:
    s_mov_b32 s54, 17825792
    s_mov_b32 s55, 0x20000
    s_mov_b32 s22, 2621440
    s_mov_b32 s23, 0x20000
    s_mov_b32 s26, 2457600
    s_mov_b32 s27, 0x20000
    s_mov_b32 s30, 819200
    s_mov_b32 s31, 0x20000
    s_mov_b32 s46, 819200
    s_mov_b32 s47, 0x20000
    s_mov_b32 s50, 5242880
    s_mov_b32 s51, 0x20000
    s_and_b32 s70, s2, 3
    s_bfe_u32 s71, s2, 0x10002
    s_bfe_u32 s73, s2, 0x20003
    s_lshl_b32 s61, s70, 2
    s_add_u32 s61, s61, s73
    s_lshr_b32 s73, s2, 5
    s_lshl_b32 s62, s71, 3
    s_add_u32 s62, s62, s73
    s_min_u32 s43, s62, 14
    s_and_b32 s77, s64, 1
    s_bfe_u32 s83, s60, 0x10001
    s_lshl_b32 s83, s83, 1
    s_lshr_b32 s70, s60, 2
    s_add_u32 s83, s83, s70
    s_mov_b32 s84, 0
    s_mov_b32 s85, -1
    s_mov_b32 s90, 1051011932
    s_mov_b32 s79, 0
    s_mov_b32 s80, 0x400000
    v_mov_b32 v16, 0xdddddddd
    s_mov_b32 s70, 0
    v_and_b32 v1, 31, v0
    v_bfe_u32 v2, v1, 1, 3
    v_lshrrev_b32 v3, 5, v0
    v_xor_b32 v2, v2, v3
    v_lshlrev_b32 v2, 4, v2
    s_lshl_b32 s70, s70, 12
    v_lshl_add_u32 v1, v1, 7, v2
    v_add_u32 v64, s70, v1
    v_xor_b32 v65, 32, v64
    v_xor_b32 v66, 64, v64
    v_xor_b32 v67, 0x60, v64
    s_and_b32 s70, s60, 2
    v_and_b32 v1, 31, v0
    v_bfe_u32 v2, v1, 1, 3
    v_lshrrev_b32 v3, 5, v0
    v_xor_b32 v2, v2, v3
    v_lshlrev_b32 v2, 4, v2
    s_lshl_b32 s70, s70, 12
    v_lshl_add_u32 v1, v1, 7, v2
    v_add_u32 v78, s70, v1
    v_xor_b32 v79, 32, v78
    v_xor_b32 v80, 64, v78
    v_xor_b32 v81, 0x60, v78
    v_bfe_u32 v1, v0, 2, 2
    v_lshrrev_b32 v2, 5, v0
    v_bfe_u32 v3, v0, 4, 1
    v_and_b32 v30, 3, v0
    v_lshl_add_u32 v3, v3, 2, v30
    v_min_u32 v240, 4, v3
    v_lshlrev_b32 v240, 3, v240
    v_lshl_add_u32 v241, v2, 2, v1
    v_mul_u32_u24 v241, 320, v241
    s_mul_i32 s70, s81, 40
    s_add_u32 s70, s70, 8192
    v_add3_u32 v68, v241, v240, s70
    v_lshl_add_u32 v241, v2, 3, v1
    v_lshlrev_b32 v241, 8, v241
    v_add_u32 v241, 16384, v241
    v_lshlrev_b32 v1, 6, v1
    s_and_b32 s70, s60, 1
    s_lshl_b32 s71, s70, 7
    v_lshlrev_b32 v240, 3, v3
    v_add3_u32 v2, v240, v1, s71
    v_and_b32 v2, 255, v2
    v_add_u32 v75, v241, v2
    v_add_u32 v2, 64, v2
    v_and_b32 v2, 255, v2
    v_add_u32 v76, v241, v2
    v_and_b32 v3, 31, v0
    v_lshrrev_b32 v2, 5, v0
    v_lshlrev_b32 v2, 2, v2
    v_sub_u32 v3, v3, v2
    v_mov_b32 v30, 4048155338
    v_cmp_gt_i32 s[86:87], 0, v3
    v_cmp_gt_i32 s[88:89], 1, v3
    s_nop 0
    v_cndmask_b32 v32, 0, v30, s[86:87]
    v_cndmask_b32 v48, v30, 0, s[86:87]
    v_cndmask_b32 v33, 0, v30, s[88:89]
    v_cndmask_b32 v49, v30, 0, s[88:89]
    v_cmp_gt_i32 s[86:87], 2, v3
    v_cmp_gt_i32 s[88:89], 3, v3
    s_nop 0
    v_cndmask_b32 v34, 0, v30, s[86:87]
    v_cndmask_b32 v50, v30, 0, s[86:87]
    v_cndmask_b32 v35, 0, v30, s[88:89]
    v_cndmask_b32 v51, v30, 0, s[88:89]
    v_cmp_gt_i32 s[86:87], 8, v3
    v_cmp_gt_i32 s[88:89], 9, v3
    s_nop 0
    v_cndmask_b32 v36, 0, v30, s[86:87]
    v_cndmask_b32 v52, v30, 0, s[86:87]
    v_cndmask_b32 v37, 0, v30, s[88:89]
    v_cndmask_b32 v53, v30, 0, s[88:89]
    v_cmp_gt_i32 s[86:87], 10, v3
    v_cmp_gt_i32 s[88:89], 11, v3
    s_nop 0
    v_cndmask_b32 v38, 0, v30, s[86:87]
    v_cndmask_b32 v54, v30, 0, s[86:87]
    v_cndmask_b32 v39, 0, v30, s[88:89]
    v_cndmask_b32 v55, v30, 0, s[88:89]
    v_cmp_gt_i32 s[86:87], 16, v3
    v_cmp_gt_i32 s[88:89], 17, v3
    s_nop 0
    v_cndmask_b32 v40, 0, v30, s[86:87]
    v_cndmask_b32 v56, v30, 0, s[86:87]
    v_cndmask_b32 v41, 0, v30, s[88:89]
    v_cndmask_b32 v57, v30, 0, s[88:89]
    v_cmp_gt_i32 s[86:87], 18, v3
    v_cmp_gt_i32 s[88:89], 19, v3
    s_nop 0
    v_cndmask_b32 v42, 0, v30, s[86:87]
    v_cndmask_b32 v58, v30, 0, s[86:87]
    v_cndmask_b32 v43, 0, v30, s[88:89]
    v_cndmask_b32 v59, v30, 0, s[88:89]
    v_cmp_gt_i32 s[86:87], 24, v3
    v_cmp_gt_i32 s[88:89], 25, v3
    s_nop 0
    v_cndmask_b32 v44, 0, v30, s[86:87]
    v_cndmask_b32 v60, v30, 0, s[86:87]
    v_cndmask_b32 v45, 0, v30, s[88:89]
    v_cndmask_b32 v61, v30, 0, s[88:89]
    v_cmp_gt_i32 s[86:87], 26, v3
    v_cmp_gt_i32 s[88:89], 27, v3
    s_nop 0
    v_cndmask_b32 v46, 0, v30, s[86:87]
    v_cndmask_b32 v62, v30, 0, s[86:87]
    v_cndmask_b32 v47, 0, v30, s[88:89]
    v_cndmask_b32 v63, v30, 0, s[88:89]
    s_mul_i32 s70, s43, 13108
    s_lshr_b32 s70, s70, 16
    s_mul_i32 s71, s70, 5
    s_sub_u32 s71, s43, s71
    s_lshl_b32 s71, s71, 1
    s_and_b32 s72, s60, 1
    s_add_u32 s71, s71, s72
    s_lshl_b32 s71, s71, 4
    s_mul_i32 s75, s70, 2880
    s_add_u32 s75, s75, 521408
    s_movk_i32 s73, 576
    s_movk_i32 s41, 2880
    s_cmp_eq_u32 s70, 0
    s_cselect_b32 s75, 6815744, s75
    s_cselect_b32 s73, 512, s73
    s_cselect_b32 s41, 1280, s41
    s_lshl_b32 s72, s41, 6
    s_lshl_b32 s70, s61, 2
    s_and_b32 s74, s60, 2
    s_add_u32 s70, s70, s74
    s_mul_i32 s70, s70, s41
    s_add_u32 s75, s75, s70
    v_and_b32 v2, 31, v0
    v_lshlrev_b32 v2, 4, v2
    v_add_u32 v2, s75, v2
    v_lshrrev_b32 v3, 5, v0
    v_add_u32 v3, s71, v3
    v_add_u32 v1, 0, v3
    v_mul_u32_u24 v240, 13108, v1
    v_lshrrev_b32 v240, 16, v240
    v_mul_u32_u24 v241, 5, v240
    v_sub_u32 v1, v1, v241
    v_mad_u32_u24 v1, v1, s73, v2
    v_mad_u32_u24 v232, v240, s72, v1
    v_add_u32 v1, 2, v3
    v_mul_u32_u24 v240, 13108, v1
    v_lshrrev_b32 v240, 16, v240
    v_mul_u32_u24 v241, 5, v240
    v_sub_u32 v1, v1, v241
    v_mad_u32_u24 v1, v1, s73, v2
    v_mad_u32_u24 v233, v240, s72, v1
    v_add_u32 v1, 4, v3
    v_mul_u32_u24 v240, 13108, v1
    v_lshrrev_b32 v240, 16, v240
    v_mul_u32_u24 v241, 5, v240
    v_sub_u32 v1, v1, v241
    v_mad_u32_u24 v1, v1, s73, v2
    v_mad_u32_u24 v234, v240, s72, v1
    v_add_u32 v1, 6, v3
    v_mul_u32_u24 v240, 13108, v1
    v_lshrrev_b32 v240, 16, v240
    v_mul_u32_u24 v241, 5, v240
    v_sub_u32 v1, v1, v241
    v_mad_u32_u24 v1, v1, s73, v2
    v_mad_u32_u24 v235, v240, s72, v1
    v_add_u32 v1, 8, v3
    v_mul_u32_u24 v240, 13108, v1
    v_lshrrev_b32 v240, 16, v240
    v_mul_u32_u24 v241, 5, v240
    v_sub_u32 v1, v1, v241
    v_mad_u32_u24 v1, v1, s73, v2
    v_mad_u32_u24 v236, v240, s72, v1
    v_add_u32 v1, 10, v3
    v_mul_u32_u24 v240, 13108, v1
    v_lshrrev_b32 v240, 16, v240
    v_mul_u32_u24 v241, 5, v240
    v_sub_u32 v1, v1, v241
    v_mad_u32_u24 v1, v1, s73, v2
    v_mad_u32_u24 v237, v240, s72, v1
    v_add_u32 v1, 12, v3
    v_mul_u32_u24 v240, 13108, v1
    v_lshrrev_b32 v240, 16, v240
    v_mul_u32_u24 v241, 5, v240
    v_sub_u32 v1, v1, v241
    v_mad_u32_u24 v1, v1, s73, v2
    v_mad_u32_u24 v238, v240, s72, v1
    v_add_u32 v1, 14, v3
    v_mul_u32_u24 v240, 13108, v1
    v_lshrrev_b32 v240, 16, v240
    v_mul_u32_u24 v241, 5, v240
    v_sub_u32 v1, v1, v241
    v_mad_u32_u24 v1, v1, s73, v2
    v_mad_u32_u24 v239, v240, s72, v1
    s_mul_i32 s71, s2, 13108
    s_lshr_b32 s71, s71, 16
    s_mul_i32 s72, s71, 5
    s_sub_u32 s70, s2, s72
    s_lshl_b32 s70, s70, 3
    s_add_u32 s70, s70, s60
    s_mul_i32 s18, s71, 3277
    s_lshr_b32 s18, s18, 16
    s_mul_i32 s74, s18, 20
    s_sub_u32 s71, s71, s74
    s_mul_i32 s73, s70, 13108
    s_lshr_b32 s73, s73, 16
    s_mul_i32 s74, s73, 5
    s_sub_u32 s72, s70, s74
    s_lshl_b32 s74, s18, 3
    s_add_u32 s74, s74, s73
    s_mul_i32 s19, s74, 102400
    s_mul_i32 s73, s73, 160
    s_lshl_b32 s74, s72, 10
    s_add_u32 s19, s19, s74
    s_lshl_b32 s72, s72, 5
    v_mov_b32 v1, s72
    s_cmp_ge_u32 s71, 10
    s_cselect_b32 s72, 1, 0
    s_mul_i32 s74, s72, 19
    s_lshl_b32 s75, s71, 1
    s_sub_u32 s75, s75, s74
    s_mul_i32 s75, s75, 5120
    s_add_u32 s19, s19, s75
    s_add_u32 s19, s19, 14680064
    s_mul_i32 s72, s71, 13108
    s_lshr_b32 s72, s72, 16
    s_mul_i32 s74, s72, 5
    s_sub_u32 s71, s71, s74
    s_mul_i32 s72, s72, 160
    s_mul_i32 s74, s71, 40
    s_cmp_eq_u32 s71, 4
    s_cselect_b64 s[86:87], -1, 0
    s_cselect_b32 s74, 0, s74
    s_add_u32 s72, s72, s74
    s_mul_i32 s72, s72, 1280
    s_add_u32 s72, s72, s73
    v_bfe_u32 v2, v0, 3, 2
    v_lshrrev_b32 v3, 1, v2
    v_mul_u32_u24 v3, 20, v3
    v_and_b32 v30, 1, v2
    v_lshl_add_u32 v3, v30, 2, v3
    v_lshrrev_b32 v30, 5, v0
    v_lshl_add_u32 v3, v30, 3, v3
    v_mul_u32_u24 v2, 40, v2
    v_mul_u32_u24 v30, 20, v30
    v_add3_u32 v2, v2, v30, 16
    v_cndmask_b32 v2, v3, v2, s[86:87]
    v_bfe_u32 v3, v0, 1, 2
    v_add_u32 v2, v2, v3
    v_mul_u32_u24 v2, 1280, v2
    v_and_b32 v3, 1, v0
    v_lshl_add_u32 v2, v3, 4, v2
    v_add3_u32 v28, v2, v1, s72
    v_and_b32 v2, 31, v0
    v_lshlrev_b32 v2, 4, v2
    v_lshrrev_b32 v3, 5, v0
    v_lshl_add_u32 v3, v3, 9, v2
    s_and_b32 s70, s60, 3
    s_lshl_b32 s71, s64, 2
    s_add_u32 s70, s70, s71
    s_lshr_b32 s71, s60, 2
    s_lshl_b32 s72, s63, 1
    s_add_u32 s71, s71, s72
    s_mul_i32 s71, s71, 40960
    s_add_u32 s71, s71, 9437184
    s_lshr_b32 s72, s70, 3
    s_mul_i32 s72, s72, 10240
    s_add_u32 s71, s71, s72
    s_and_b32 s72, s70, 7
    s_lshl_b32 s72, s72, 10
    s_add_u32 s72, s72, s71
    v_add_u32 v18, s72, v3
    s_bfe_u32 s72, s70, 0x20001
    s_lshl_b32 s72, s72, 9
    s_add_u32 s71, s71, s72
    s_and_b32 s72, s70, 1
    s_lshl_b32 s72, s72, 3
    s_add_u32 s71, s71, s72
    s_add_u32 s71, s71, 8192
    v_add_u32 v19, s71, v2
    v_mov_b32 v1, 2130706432
    v_cndmask_b32 v19, v19, v1, s[84:85]
    v_mov_b32 v248, -1
    v_mov_b32 v249, -1
    v_mov_b32 v250, -1
    v_mov_b32 v251, -1
    v_and_b32 v2, 31, v0
    v_lshlrev_b32 v2, 4, v2
    v_lshrrev_b32 v3, 5, v0
    v_lshl_add_u32 v3, v3, 9, v2
    s_and_b32 s70, s60, 1
    s_lshl_b32 s71, s62, 1
    s_add_u32 s70, s70, s71
    s_mov_b32 s71, s83
    s_lshl_b32 s72, s61, 2
    s_add_u32 s71, s71, s72
    s_mul_i32 s71, s71, 40960
    s_add_u32 s71, s71, 12058624
    s_lshr_b32 s72, s70, 3
    s_mul_i32 s72, s72, 10240
    s_add_u32 s71, s71, s72
    s_and_b32 s72, s70, 7
    s_lshl_b32 s72, s72, 10
    s_add_u32 s72, s72, s71
    v_add_u32 v20, s72, v3
    s_bfe_u32 s72, s70, 0x20001
    s_lshl_b32 s72, s72, 9
    s_add_u32 s71, s71, s72
    s_and_b32 s72, s70, 1
    s_lshl_b32 s72, s72, 3
    s_add_u32 s71, s71, s72
    s_add_u32 s71, s71, 8192
    v_add_u32 v21, s71, v2
    v_mov_b32 v1, 2130706432
    v_cndmask_b32 v21, v21, v1, s[84:85]
    s_and_b32 s71, s60, 1
    s_mul_i32 s71, s71, 34816
    s_lshr_b32 s73, s83, 1
    s_mul_i32 s73, s73, 5760
    s_add_u32 s71, s71, s73
    s_and_b32 s73, s83, 1
    s_lshl_b32 s73, s73, 3
    s_add_u32 s71, s71, s73
    s_add_u32 s71, s71, 65536
    s_lshl_b32 s73, s61, 2
    s_add_u32 s72, s83, s73
    s_min_u32 s72, s72, 8
    s_sub_u32 s78, 8, s72
    v_and_b32 v1, 31, v0
    v_lshlrev_b32 v1, 4, v1
    v_add_u32 v1, s71, v1
    v_lshrrev_b32 v3, 5, v0
    v_mul_u32_u24 v245, 576, v3
    v_add_u32 v245, v245, v1
    s_add_u32 s72, s71, 512
    v_add_u32 v1, 2304, v1
    v_mov_b32 v30, s72
    v_cndmask_b32 v246, v1, v30, s[84:85]
    v_bfe_u32 v1, v0, 4, 1
    v_and_b32 v2, 3, v0
    v_lshl_add_u32 v1, v1, 2, v2
    v_cmp_lt_u32 s[86:87], 4, v1
    v_mul_u32_u24 v1, 576, v1
    v_bfe_u32 v2, v0, 2, 2
    v_lshl_add_u32 v2, v3, 3, v2
    v_lshl_add_u32 v1, v2, 4, v1
    s_add_u32 s71, s71, 2880
    v_add_u32 v1, s71, v1
    v_cndmask_b32 v247, v1, v30, s[86:87]
    v_add_u32 v2, 64, v1
    v_cndmask_b32 v252, v2, v30, s[86:87]
    v_add_u32 v2, 256, v1
    v_cndmask_b32 v253, v2, v30, s[86:87]
    v_add_u32 v2, 320, v1
    v_cndmask_b32 v254, v2, v30, s[86:87]
    s_and_b32 s70, s60, 3
    s_lshr_b32 s71, s70, 1
    s_lshl_b32 s72, s63, 1
    s_add_u32 s71, s71, s72
    s_mul_i32 s71, s71, 40960
    s_and_b32 s70, s70, 1
    s_lshl_b32 s70, s70, 8
    s_add_u32 s71, s71, s70
    s_lshr_b32 s70, s60, 2
    s_mul_i32 s70, s70, 20480
    s_add_u32 s71, s71, s70
    v_lshrrev_b32 v1, 4, v0
    v_lshlrev_b32 v1, 9, v1
    v_and_b32 v2, 15, v0
    v_lshl_add_u32 v1, v2, 4, v1
    v_add_u32 v29, s71, v1
    s_lshr_b32 s70, s60, 2
    s_mul_i32 s70, s70, 5120
    v_add_u32 v240, s70, v27
    v_add_u32 v241, 0x10000, v240
    v_add_u32 v242, 0x20000, v240
    s_mul_i32 s70, s81, 5120
    s_add_u32 s70, s70, 65536
    v_add_u32 v243, s70, v27
    s_lshl_b32 s71, s63, 6
    s_lshl_b32 s72, s81, 4
    s_add_u32 s71, s71, s72
    v_and_b32 v2, 15, v0
    v_add_u32 v2, s71, v2
    v_mul_u32_u24 v2, 2560, v2
    v_lshrrev_b32 v3, 4, v0
    v_lshl_add_u32 v2, v3, 3, v2
    s_mul_i32 s71, s64, 160
    v_add_u32 v244, s71, v2
    v_and_b32 v1, 1, v3
    v_mul_u32_u24 v1, 24, v1
    v_add_u32 v26, v1, v244
    s_waitcnt lgkmcnt(0)
    s_barrier
    ds_read_b128 v[184:187], v64 offset:0
    ds_read_b64_tr_b16 v[192:193], v68 offset:0
    ds_read_b64_tr_b16 v[194:195], v68 offset:160
    ds_read_b128 v[188:191], v64 offset:4096
    ds_read_b128 v[196:199], v65 offset:0
    ds_read_b64_tr_b16 v[204:205], v68 offset:2560
    ds_read_b64_tr_b16 v[206:207], v68 offset:2720
    ds_read_b128 v[200:203], v65 offset:4096
    ds_read_b128 v[208:211], v66 offset:0
    ds_read_b64_tr_b16 v[216:217], v68 offset:5120
    ds_read_b64_tr_b16 v[218:219], v68 offset:5280
    ds_read_b128 v[212:215], v66 offset:4096
    s_waitcnt lgkmcnt(8)
    v_mfma_f32_32x32x16_bf16 v[84:99], v[192:195], v[184:187], 0
    ds_read_b128 v[220:223], v67 offset:0
    ds_read_b64_tr_b16 v[228:229], v68 offset:7680
    v_mfma_f32_32x32x16_bf16 v[100:115], v[192:195], v[188:191], 0
    ds_read_b64_tr_b16 v[230:231], v68 offset:7840
    ds_read_b128 v[224:227], v67 offset:4096
    s_barrier
    s_waitcnt lgkmcnt(8)
    v_mfma_f32_32x32x16_bf16 v[84:99], v[204:207], v[196:199], v[84:99]
    ds_read_b128 v[184:187], v64 offset:32768
    ds_read_b64_tr_b16 v[192:193], v68 offset:32768
    v_mfma_f32_32x32x16_bf16 v[100:115], v[204:207], v[200:203], v[100:115]
    ds_read_b64_tr_b16 v[194:195], v68 offset:32928
    ds_read_b128 v[188:191], v64 offset:36864
    s_waitcnt lgkmcnt(8)
    v_mfma_f32_32x32x16_bf16 v[84:99], v[216:219], v[208:211], v[84:99]
    ds_read_b128 v[196:199], v65 offset:32768
    ds_read_b64_tr_b16 v[204:205], v68 offset:35328
    v_mfma_f32_32x32x16_bf16 v[100:115], v[216:219], v[212:215], v[100:115]
    ds_read_b64_tr_b16 v[206:207], v68 offset:35488
    ds_read_b128 v[200:203], v65 offset:36864
    s_waitcnt lgkmcnt(8)
    v_mfma_f32_32x32x16_bf16 v[84:99], v[228:231], v[220:223], v[84:99]
    ds_read_b128 v[208:211], v66 offset:32768
    ds_read_b64_tr_b16 v[216:217], v68 offset:37888
    v_mfma_f32_32x32x16_bf16 v[100:115], v[228:231], v[224:227], v[100:115]
    ds_read_b64_tr_b16 v[218:219], v68 offset:38048
    ds_read_b128 v[212:215], v66 offset:36864
    s_waitcnt lgkmcnt(8)
    v_mfma_f32_32x32x16_bf16 v[84:99], v[192:195], v[184:187], v[84:99]
    ds_read_b128 v[220:223], v67 offset:32768
    ds_read_b64_tr_b16 v[228:229], v68 offset:40448
    v_mfma_f32_32x32x16_bf16 v[100:115], v[192:195], v[188:191], v[100:115]
    ds_read_b64_tr_b16 v[230:231], v68 offset:40608
    ds_read_b128 v[224:227], v67 offset:36864
    s_barrier
    s_waitcnt lgkmcnt(8)
    v_mfma_f32_32x32x16_bf16 v[84:99], v[204:207], v[196:199], v[84:99]
    v_add_u32 v64, 0x10000, v64
    ds_read_b128 v[184:187], v64 offset:0
    v_add_u32 v68, 0x10000, v68
    ds_read_b64_tr_b16 v[192:193], v68 offset:0
    v_mfma_f32_32x32x16_bf16 v[100:115], v[204:207], v[200:203], v[100:115]
    ds_read_b64_tr_b16 v[194:195], v68 offset:160
    ds_read_b128 v[188:191], v64 offset:4096
    s_waitcnt lgkmcnt(8)
    v_mfma_f32_32x32x16_bf16 v[84:99], v[216:219], v[208:211], v[84:99]
    v_add_u32 v65, 0x10000, v65
    ds_read_b128 v[196:199], v65 offset:0
    ds_read_b64_tr_b16 v[204:205], v68 offset:2560
    v_mfma_f32_32x32x16_bf16 v[100:115], v[216:219], v[212:215], v[100:115]
    ds_read_b64_tr_b16 v[206:207], v68 offset:2720
    ds_read_b128 v[200:203], v65 offset:4096
    s_waitcnt lgkmcnt(8)
    v_mfma_f32_32x32x16_bf16 v[84:99], v[228:231], v[220:223], v[84:99]
    v_add_u32 v66, 0x10000, v66
    ds_read_b128 v[208:211], v66 offset:0
    ds_read_b64_tr_b16 v[216:217], v68 offset:5120
    v_mfma_f32_32x32x16_bf16 v[100:115], v[228:231], v[224:227], v[100:115]
    ds_read_b64_tr_b16 v[218:219], v68 offset:5280
    ds_read_b128 v[212:215], v66 offset:4096
    s_waitcnt lgkmcnt(8)
    v_mfma_f32_32x32x16_bf16 v[84:99], v[192:195], v[184:187], v[84:99]
    v_add_u32 v67, 0x10000, v67
    ds_read_b128 v[220:223], v67 offset:0
    ds_read_b64_tr_b16 v[228:229], v68 offset:7680
    v_mfma_f32_32x32x16_bf16 v[100:115], v[192:195], v[188:191], v[100:115]
    ds_read_b64_tr_b16 v[230:231], v68 offset:7840
    ds_read_b128 v[224:227], v67 offset:4096
    s_barrier
    s_waitcnt lgkmcnt(8)
    v_mfma_f32_32x32x16_bf16 v[84:99], v[204:207], v[196:199], v[84:99]
    ds_read_b128 v[184:187], v64 offset:32768
    ds_read_b64_tr_b16 v[192:193], v68 offset:32768
    v_mfma_f32_32x32x16_bf16 v[100:115], v[204:207], v[200:203], v[100:115]
    ds_read_b64_tr_b16 v[194:195], v68 offset:32928
    ds_read_b128 v[188:191], v64 offset:36864
    v_mov_b32 v1, 0
    buffer_load_dword v17, v1, s[52:55], 0 offen sc1
    s_waitcnt lgkmcnt(8)
    v_mfma_f32_32x32x16_bf16 v[84:99], v[216:219], v[208:211], v[84:99]
    ds_read_b128 v[196:199], v65 offset:32768
    ds_read_b64_tr_b16 v[204:205], v68 offset:35328
    v_mfma_f32_32x32x16_bf16 v[100:115], v[216:219], v[212:215], v[100:115]
    ds_read_b64_tr_b16 v[206:207], v68 offset:35488
    ds_read_b128 v[200:203], v65 offset:36864
    s_waitcnt lgkmcnt(8)
    v_mfma_f32_32x32x16_bf16 v[84:99], v[228:231], v[220:223], v[84:99]
    ds_read_b128 v[208:211], v66 offset:32768
    ds_read_b64_tr_b16 v[216:217], v68 offset:37888
    v_mfma_f32_32x32x16_bf16 v[100:115], v[228:231], v[224:227], v[100:115]
    ds_read_b64_tr_b16 v[218:219], v68 offset:38048
    ds_read_b128 v[212:215], v66 offset:36864
    s_waitcnt lgkmcnt(8)
    v_mfma_f32_32x32x16_bf16 v[84:99], v[192:195], v[184:187], v[84:99]
    ds_read_b128 v[220:223], v67 offset:32768
    ds_read_b64_tr_b16 v[228:229], v68 offset:40448
    v_mfma_f32_32x32x16_bf16 v[100:115], v[192:195], v[188:191], v[100:115]
    ds_read_b64_tr_b16 v[230:231], v68 offset:40608
    ds_read_b128 v[224:227], v67 offset:36864
    s_barrier
    s_waitcnt lgkmcnt(8)
    v_mfma_f32_32x32x16_bf16 v[84:99], v[204:207], v[196:199], v[84:99]
    v_add_u32 v64, 0x10000, v64
    ds_read_b128 v[184:187], v64 offset:0
    v_add_u32 v68, 0x10000, v68
    ds_read_b64_tr_b16 v[192:193], v68 offset:0
    v_mfma_f32_32x32x16_bf16 v[100:115], v[204:207], v[200:203], v[100:115]
    ds_read_b64_tr_b16 v[194:195], v68 offset:160
    ds_read_b128 v[188:191], v64 offset:4096
    s_waitcnt lgkmcnt(8)
    v_mfma_f32_32x32x16_bf16 v[84:99], v[216:219], v[208:211], v[84:99]
    v_add_u32 v65, 0x10000, v65
    ds_read_b128 v[196:199], v65 offset:0
    ds_read_b64_tr_b16 v[204:205], v68 offset:2560
    v_mfma_f32_32x32x16_bf16 v[100:115], v[216:219], v[212:215], v[100:115]
    ds_read_b64_tr_b16 v[206:207], v68 offset:2720
    ds_read_b128 v[200:203], v65 offset:4096
    s_waitcnt lgkmcnt(8)
    v_mfma_f32_32x32x16_bf16 v[84:99], v[228:231], v[220:223], v[84:99]
    v_add_u32 v66, 0x10000, v66
    ds_read_b128 v[208:211], v66 offset:0
    ds_read_b64_tr_b16 v[216:217], v68 offset:5120
    v_mfma_f32_32x32x16_bf16 v[100:115], v[228:231], v[224:227], v[100:115]
    ds_read_b64_tr_b16 v[218:219], v68 offset:5280
    ds_read_b128 v[212:215], v66 offset:4096
    s_waitcnt lgkmcnt(8)
    v_mfma_f32_32x32x16_bf16 v[84:99], v[192:195], v[184:187], v[84:99]
    v_add_u32 v67, 0x10000, v67
    ds_read_b128 v[220:223], v67 offset:0
    ds_read_b64_tr_b16 v[228:229], v68 offset:7680
    v_mfma_f32_32x32x16_bf16 v[100:115], v[192:195], v[188:191], v[100:115]
    ds_read_b64_tr_b16 v[230:231], v68 offset:7840
    ds_read_b128 v[224:227], v67 offset:4096
    s_barrier
    s_waitcnt lgkmcnt(8)
    v_mfma_f32_32x32x16_bf16 v[84:99], v[204:207], v[196:199], v[84:99]
    v_add_u32 v64, 0xfffe0000, v64
    ds_read_b128 v[184:187], v64 offset:0
    v_add_u32 v68, 0xfffe0000, v68
    ds_read_b64_tr_b16 v[192:193], v68 offset:0
    v_mfma_f32_32x32x16_bf16 v[100:115], v[204:207], v[200:203], v[100:115]
    ds_read_b64_tr_b16 v[194:195], v68 offset:160
    ds_read_b128 v[188:191], v64 offset:4096
    s_waitcnt lgkmcnt(8)
    v_mfma_f32_32x32x16_bf16 v[84:99], v[216:219], v[208:211], v[84:99]
    v_add_u32 v65, 0xfffe0000, v65
    ds_read_b128 v[196:199], v65 offset:0
    ds_read_b64_tr_b16 v[204:205], v68 offset:2560
    v_mfma_f32_32x32x16_bf16 v[100:115], v[216:219], v[212:215], v[100:115]
    ds_read_b64_tr_b16 v[206:207], v68 offset:2720
    ds_read_b128 v[200:203], v65 offset:4096
    s_waitcnt lgkmcnt(8)
    v_mfma_f32_32x32x16_bf16 v[84:99], v[228:231], v[220:223], v[84:99]
    v_add_u32 v66, 0xfffe0000, v66
    ds_read_b128 v[208:211], v66 offset:0
    ds_read_b64_tr_b16 v[216:217], v68 offset:5120
    v_mfma_f32_32x32x16_bf16 v[100:115], v[228:231], v[224:227], v[100:115]
    ds_read_b64_tr_b16 v[218:219], v68 offset:5280
    ds_read_b128 v[212:215], v66 offset:4096
    s_waitcnt lgkmcnt(8)
    v_mfma_f32_32x32x16_bf16 v[84:99], v[192:195], v[184:187], v[84:99]
    v_add_u32 v67, 0xfffe0000, v67
    ds_read_b128 v[220:223], v67 offset:0
    ds_read_b64_tr_b16 v[228:229], v68 offset:7680
    v_mfma_f32_32x32x16_bf16 v[100:115], v[192:195], v[188:191], v[100:115]
    ds_read_b64_tr_b16 v[230:231], v68 offset:7840
    ds_read_b128 v[224:227], v67 offset:4096
    s_barrier
    s_waitcnt lgkmcnt(8)
    v_mfma_f32_32x32x16_bf16 v[84:99], v[204:207], v[196:199], v[84:99]
    ds_read_b128 v[184:187], v64 offset:32768
    ds_read_b64_tr_b16 v[192:193], v68 offset:32768
    v_mfma_f32_32x32x16_bf16 v[100:115], v[204:207], v[200:203], v[100:115]
    ds_read_b64_tr_b16 v[194:195], v68 offset:32928
    ds_read_b128 v[188:191], v64 offset:36864
    s_waitcnt lgkmcnt(8)
    v_mfma_f32_32x32x16_bf16 v[84:99], v[216:219], v[208:211], v[84:99]
    ds_read_b128 v[196:199], v65 offset:32768
    ds_read_b64_tr_b16 v[204:205], v68 offset:35328
    v_mfma_f32_32x32x16_bf16 v[100:115], v[216:219], v[212:215], v[100:115]
    ds_read_b64_tr_b16 v[206:207], v68 offset:35488
    ds_read_b128 v[200:203], v65 offset:36864
    s_waitcnt lgkmcnt(8)
    v_mfma_f32_32x32x16_bf16 v[84:99], v[228:231], v[220:223], v[84:99]
    ds_read_b128 v[208:211], v66 offset:32768
    ds_read_b64_tr_b16 v[216:217], v68 offset:37888
    v_mfma_f32_32x32x16_bf16 v[100:115], v[228:231], v[224:227], v[100:115]
    ds_read_b64_tr_b16 v[218:219], v68 offset:38048
    ds_read_b128 v[212:215], v66 offset:36864
    s_waitcnt lgkmcnt(8)
    v_mfma_f32_32x32x16_bf16 v[84:99], v[192:195], v[184:187], v[84:99]
    ds_read_b128 v[220:223], v67 offset:32768
    ds_read_b64_tr_b16 v[228:229], v68 offset:40448
    v_mfma_f32_32x32x16_bf16 v[100:115], v[192:195], v[188:191], v[100:115]
    ds_read_b64_tr_b16 v[230:231], v68 offset:40608
    ds_read_b128 v[224:227], v67 offset:36864
    s_barrier
    s_waitcnt lgkmcnt(8)
    v_mfma_f32_32x32x16_bf16 v[84:99], v[204:207], v[196:199], v[84:99]
    v_add_u32 v64, 0x10000, v64
    ds_read_b128 v[184:187], v64 offset:0
    v_add_u32 v68, 0x10000, v68
    ds_read_b64_tr_b16 v[192:193], v68 offset:0
    v_mfma_f32_32x32x16_bf16 v[100:115], v[204:207], v[200:203], v[100:115]
    ds_read_b64_tr_b16 v[194:195], v68 offset:160
    ds_read_b128 v[188:191], v64 offset:4096
    s_waitcnt lgkmcnt(8)
    v_mfma_f32_32x32x16_bf16 v[84:99], v[216:219], v[208:211], v[84:99]
    v_add_u32 v65, 0x10000, v65
    ds_read_b128 v[196:199], v65 offset:0
    ds_read_b64_tr_b16 v[204:205], v68 offset:2560
    v_mfma_f32_32x32x16_bf16 v[100:115], v[216:219], v[212:215], v[100:115]
    ds_read_b64_tr_b16 v[206:207], v68 offset:2720
    ds_read_b128 v[200:203], v65 offset:4096
    s_waitcnt lgkmcnt(8)
    v_mfma_f32_32x32x16_bf16 v[84:99], v[228:231], v[220:223], v[84:99]
    v_add_u32 v66, 0x10000, v66
    ds_read_b128 v[208:211], v66 offset:0
    ds_read_b64_tr_b16 v[216:217], v68 offset:5120
    v_mfma_f32_32x32x16_bf16 v[100:115], v[228:231], v[224:227], v[100:115]
    ds_read_b64_tr_b16 v[218:219], v68 offset:5280
    ds_read_b128 v[212:215], v66 offset:4096
    s_waitcnt lgkmcnt(8)
    v_mfma_f32_32x32x16_bf16 v[84:99], v[192:195], v[184:187], v[84:99]
    v_add_u32 v67, 0x10000, v67
    ds_read_b128 v[220:223], v67 offset:0
    ds_read_b64_tr_b16 v[228:229], v68 offset:7680
    v_mfma_f32_32x32x16_bf16 v[100:115], v[192:195], v[188:191], v[100:115]
    ds_read_b64_tr_b16 v[230:231], v68 offset:7840
    ds_read_b128 v[224:227], v67 offset:4096
    s_waitcnt vmcnt(0)
    v_add_u32 v17, 0x9e3779b9, v17
    s_barrier
    s_waitcnt lgkmcnt(8)
    v_mfma_f32_32x32x16_bf16 v[84:99], v[204:207], v[196:199], v[84:99]
    ds_read_b128 v[184:187], v64 offset:32768
    ds_read_b64_tr_b16 v[192:193], v68 offset:32768
    v_mfma_f32_32x32x16_bf16 v[100:115], v[204:207], v[200:203], v[100:115]
    ds_read_b64_tr_b16 v[194:195], v68 offset:32928
    ds_read_b128 v[188:191], v64 offset:36864
    s_waitcnt lgkmcnt(8)
    v_mfma_f32_32x32x16_bf16 v[84:99], v[216:219], v[208:211], v[84:99]
    ds_read_b128 v[196:199], v65 offset:32768
    ds_read_b64_tr_b16 v[204:205], v68 offset:35328
    v_mfma_f32_32x32x16_bf16 v[100:115], v[216:219], v[212:215], v[100:115]
    ds_read_b64_tr_b16 v[206:207], v68 offset:35488
    ds_read_b128 v[200:203], v65 offset:36864
    s_waitcnt lgkmcnt(8)
    v_mfma_f32_32x32x16_bf16 v[84:99], v[228:231], v[220:223], v[84:99]
    ds_read_b128 v[208:211], v66 offset:32768
    ds_read_b64_tr_b16 v[216:217], v68 offset:37888
    v_mfma_f32_32x32x16_bf16 v[100:115], v[228:231], v[224:227], v[100:115]
    ds_read_b64_tr_b16 v[218:219], v68 offset:38048
    ds_read_b128 v[212:215], v66 offset:36864
    s_waitcnt lgkmcnt(8)
    v_mfma_f32_32x32x16_bf16 v[84:99], v[192:195], v[184:187], v[84:99]
    ds_read_b128 v[220:223], v67 offset:32768
    ds_read_b64_tr_b16 v[228:229], v68 offset:40448
    v_mfma_f32_32x32x16_bf16 v[100:115], v[192:195], v[188:191], v[100:115]
    ds_read_b64_tr_b16 v[230:231], v68 offset:40608
    ds_read_b128 v[224:227], v67 offset:36864
    s_barrier
    s_waitcnt lgkmcnt(8)
    v_mfma_f32_32x32x16_bf16 v[84:99], v[204:207], v[196:199], v[84:99]
    v_add_u32 v64, 0x10000, v64
    ds_read_b128 v[184:187], v64 offset:0
    v_add_u32 v68, 0x10000, v68
    ds_read_b64_tr_b16 v[192:193], v68 offset:0
    v_mfma_f32_32x32x16_bf16 v[100:115], v[204:207], v[200:203], v[100:115]
    ds_read_b64_tr_b16 v[194:195], v68 offset:160
    ds_read_b128 v[188:191], v64 offset:4096
    s_waitcnt lgkmcnt(8)
    v_mfma_f32_32x32x16_bf16 v[84:99], v[216:219], v[208:211], v[84:99]
    v_add_u32 v65, 0x10000, v65
    ds_read_b128 v[196:199], v65 offset:0
    ds_read_b64_tr_b16 v[204:205], v68 offset:2560
    v_mfma_f32_32x32x16_bf16 v[100:115], v[216:219], v[212:215], v[100:115]
    ds_read_b64_tr_b16 v[206:207], v68 offset:2720
    ds_read_b128 v[200:203], v65 offset:4096
    s_waitcnt lgkmcnt(8)
    v_mfma_f32_32x32x16_bf16 v[84:99], v[228:231], v[220:223], v[84:99]
    v_add_u32 v66, 0x10000, v66
    ds_read_b128 v[208:211], v66 offset:0
    ds_read_b64_tr_b16 v[216:217], v68 offset:5120
    v_mfma_f32_32x32x16_bf16 v[100:115], v[228:231], v[224:227], v[100:115]
    ds_read_b64_tr_b16 v[218:219], v68 offset:5280
    ds_read_b128 v[212:215], v66 offset:4096
    s_waitcnt lgkmcnt(8)
    v_mfma_f32_32x32x16_bf16 v[84:99], v[192:195], v[184:187], v[84:99]
    v_add_u32 v67, 0x10000, v67
    ds_read_b128 v[220:223], v67 offset:0
    ds_read_b64_tr_b16 v[228:229], v68 offset:7680
    v_mfma_f32_32x32x16_bf16 v[100:115], v[192:195], v[188:191], v[100:115]
    ds_read_b64_tr_b16 v[230:231], v68 offset:7840
    ds_read_b128 v[224:227], v67 offset:4096
    s_waitcnt lgkmcnt(8)
    v_mfma_f32_32x32x16_bf16 v[84:99], v[204:207], v[196:199], v[84:99]
    v_mfma_f32_32x32x16_bf16 v[100:115], v[204:207], v[200:203], v[100:115]
    s_barrier
    s_waitcnt lgkmcnt(4)
    v_mfma_f32_32x32x16_bf16 v[84:99], v[216:219], v[208:211], v[84:99]
    v_mfma_f32_32x32x16_bf16 v[100:115], v[216:219], v[212:215], v[100:115]
    ds_read_b128 v[200:203], v78 offset:0
    ds_read_b64_tr_b16 v[208:209], v75 offset:0
    ds_read_b64_tr_b16 v[210:211], v75 offset:1024
    ds_read_b128 v[204:207], v78 offset:4096
    ds_read_b64_tr_b16 v[212:213], v76 offset:0
    ds_read_b64_tr_b16 v[214:215], v76 offset:1024
    s_waitcnt lgkmcnt(6)
    v_mfma_f32_32x32x16_bf16 v[84:99], v[228:231], v[220:223], v[84:99]
    v_mfma_f32_32x32x16_bf16 v[100:115], v[228:231], v[224:227], v[100:115]
    ds_read_b128 v[216:219], v79 offset:0
    ds_read_b64_tr_b16 v[224:225], v75 offset:4096
    ds_read_b64_tr_b16 v[226:227], v75 offset:5120
    ds_read_b128 v[220:223], v79 offset:4096
    ds_read_b64_tr_b16 v[228:229], v76 offset:4096
    ds_read_b64_tr_b16 v[230:231], v76 offset:5120
    s_waitcnt lgkmcnt(6)
    v_mfma_f32_32x32x16_bf16 v[120:135], v[208:211], v[200:203], 0
    ds_read_b128 v[184:187], v80 offset:0
    ds_read_b64_tr_b16 v[192:193], v75 offset:8192
    v_mfma_f32_32x32x16_bf16 v[152:167], v[208:211], v[204:207], 0
    ds_read_b64_tr_b16 v[194:195], v75 offset:9216
    ds_read_b128 v[188:191], v80 offset:4096
    v_mfma_f32_32x32x16_bf16 v[136:151], v[212:215], v[200:203], 0
    ds_read_b64_tr_b16 v[196:197], v76 offset:8192
    ds_read_b64_tr_b16 v[198:199], v76 offset:9216
    v_mfma_f32_32x32x16_bf16 v[168:183], v[212:215], v[204:207], 0
    s_waitcnt lgkmcnt(6)
    v_mfma_f32_32x32x16_bf16 v[120:135], v[224:227], v[216:219], v[120:135]
    ds_read_b128 v[200:203], v81 offset:0
    ds_read_b64_tr_b16 v[208:209], v75 offset:12288
    v_mfma_f32_32x32x16_bf16 v[152:167], v[224:227], v[220:223], v[152:167]
    ds_read_b64_tr_b16 v[210:211], v75 offset:13312
    ds_read_b128 v[204:207], v81 offset:4096
    v_mfma_f32_32x32x16_bf16 v[136:151], v[228:231], v[216:219], v[136:151]
    ds_read_b64_tr_b16 v[212:213], v76 offset:12288
    ds_read_b64_tr_b16 v[214:215], v76 offset:13312
    v_mfma_f32_32x32x16_bf16 v[168:183], v[228:231], v[220:223], v[168:183]
    v_pk_mul_f32 v[84:85], v[84:85], s[90:91] op_sel_hi:[1,0]
    v_pk_mul_f32 v[86:87], v[86:87], s[90:91] op_sel_hi:[1,0]
    v_pk_mul_f32 v[88:89], v[88:89], s[90:91] op_sel_hi:[1,0]
    v_pk_mul_f32 v[90:91], v[90:91], s[90:91] op_sel_hi:[1,0]
    v_pk_mul_f32 v[92:93], v[92:93], s[90:91] op_sel_hi:[1,0]
    v_pk_mul_f32 v[94:95], v[94:95], s[90:91] op_sel_hi:[1,0]
    v_cvt_pk_bf16_f32 v4, v84, v85
    v_cvt_pk_bf16_f32 v5, v86, v87
    v_cvt_pk_bf16_f32 v6, v88, v89
    v_cvt_pk_bf16_f32 v7, v90, v91
    v_cvt_pk_bf16_f32 v8, v92, v93
    v_cvt_pk_bf16_f32 v9, v94, v95
    v_pk_mul_f32 v[100:101], v[100:101], s[90:91] op_sel_hi:[1,0]
    v_pk_mul_f32 v[102:103], v[102:103], s[90:91] op_sel_hi:[1,0]
    v_pk_mul_f32 v[104:105], v[104:105], s[90:91] op_sel_hi:[1,0]
    v_pk_mul_f32 v[106:107], v[106:107], s[90:91] op_sel_hi:[1,0]
    v_pk_mul_f32 v[108:109], v[108:109], s[90:91] op_sel_hi:[1,0]
    v_pk_mul_f32 v[110:111], v[110:111], s[90:91] op_sel_hi:[1,0]
    v_cvt_pk_bf16_f32 v116, v100, v101
    v_cvt_pk_bf16_f32 v117, v102, v103
    v_cvt_pk_bf16_f32 v118, v104, v105
    v_cvt_pk_bf16_f32 v119, v106, v107
    v_cvt_pk_bf16_f32 v82, v108, v109
    v_cvt_pk_bf16_f32 v83, v110, v111
    s_add_u32 s70, s82, 155648
    v_add_u32 v1, s70, v27
    v_lshlrev_b32 v2, 3, v0
    s_add_u32 s70, s82, 159744
    v_add_u32 v2, s70, v2
    ds_write_b128 v1, v[116:119]
    ds_write_b64 v2, v[82:83]
    s_waitcnt lgkmcnt(0)
    s_barrier
    v_mfma_f32_32x32x16_bf16 v[120:135], v[192:195], v[184:187], v[120:135]
    ds_read_b128 v[216:219], v78 offset:32768
    ds_read_b64_tr_b16 v[224:225], v75 offset:32768
    v_mfma_f32_32x32x16_bf16 v[152:167], v[192:195], v[188:191], v[152:167]
    ds_read_b64_tr_b16 v[226:227], v75 offset:33792
    ds_read_b128 v[220:223], v78 offset:36864
    v_mfma_f32_32x32x16_bf16 v[136:151], v[196:199], v[184:187], v[136:151]
    ds_read_b64_tr_b16 v[228:229], v76 offset:32768
    ds_read_b64_tr_b16 v[230:231], v76 offset:33792
    v_mfma_f32_32x32x16_bf16 v[168:183], v[196:199], v[188:191], v[168:183]
    v_mfma_f32_32x32x16_bf16 v[120:135], v[208:211], v[200:203], v[120:135]
    ds_read_b128 v[184:187], v79 offset:32768
    ds_read_b64_tr_b16 v[192:193], v75 offset:36864
    v_mfma_f32_32x32x16_bf16 v[152:167], v[208:211], v[204:207], v[152:167]
    ds_read_b64_tr_b16 v[194:195], v75 offset:37888
    ds_read_b128 v[188:191], v79 offset:36864
    v_mfma_f32_32x32x16_bf16 v[136:151], v[212:215], v[200:203], v[136:151]
    ds_read_b64_tr_b16 v[196:197], v76 offset:36864
    ds_read_b64_tr_b16 v[198:199], v76 offset:37888
    v_mfma_f32_32x32x16_bf16 v[168:183], v[212:215], v[204:207], v[168:183]
    s_waitcnt lgkmcnt(6)
    v_mfma_f32_32x32x16_bf16 v[120:135], v[224:227], v[216:219], v[120:135]
    ds_read_b128 v[200:203], v80 offset:32768
    ds_read_b64_tr_b16 v[208:209], v75 offset:40960
    v_mfma_f32_32x32x16_bf16 v[152:167], v[224:227], v[220:223], v[152:167]
    ds_read_b64_tr_b16 v[210:211], v75 offset:41984
    ds_read_b128 v[204:207], v80 offset:36864
    v_mfma_f32_32x32x16_bf16 v[136:151], v[228:231], v[216:219], v[136:151]
    ds_read_b64_tr_b16 v[212:213], v76 offset:40960
    ds_read_b64_tr_b16 v[214:215], v76 offset:41984
    v_mfma_f32_32x32x16_bf16 v[168:183], v[228:231], v[220:223], v[168:183]
    s_waitcnt lgkmcnt(6)
    v_mfma_f32_32x32x16_bf16 v[120:135], v[192:195], v[184:187], v[120:135]
    ds_read_b128 v[216:219], v81 offset:32768
    ds_read_b64_tr_b16 v[224:225], v75 offset:45056
    v_mfma_f32_32x32x16_bf16 v[152:167], v[192:195], v[188:191], v[152:167]
    ds_read_b64_tr_b16 v[226:227], v75 offset:46080
    ds_read_b128 v[220:223], v81 offset:36864
    v_mfma_f32_32x32x16_bf16 v[136:151], v[196:199], v[184:187], v[136:151]
    ds_read_b64_tr_b16 v[228:229], v76 offset:45056
    ds_read_b64_tr_b16 v[230:231], v76 offset:46080
    v_mfma_f32_32x32x16_bf16 v[168:183], v[196:199], v[188:191], v[168:183]
    s_barrier
    s_waitcnt lgkmcnt(6)
    v_mfma_f32_32x32x16_bf16 v[120:135], v[208:211], v[200:203], v[120:135]
    v_add_u32 v78, 0x10000, v78
    ds_read_b128 v[184:187], v78 offset:0
    v_add_u32 v75, 0x10000, v75
    ds_read_b64_tr_b16 v[192:193], v75 offset:0
    v_mfma_f32_32x32x16_bf16 v[152:167], v[208:211], v[204:207], v[152:167]
    ds_read_b64_tr_b16 v[194:195], v75 offset:1024
    ds_read_b128 v[188:191], v78 offset:4096
    v_mfma_f32_32x32x16_bf16 v[136:151], v[212:215], v[200:203], v[136:151]
    v_add_u32 v76, 0x10000, v76
    ds_read_b64_tr_b16 v[196:197], v76 offset:0
    ds_read_b64_tr_b16 v[198:199], v76 offset:1024
    v_mfma_f32_32x32x16_bf16 v[168:183], v[212:215], v[204:207], v[168:183]
    s_waitcnt lgkmcnt(6)
    v_mfma_f32_32x32x16_bf16 v[120:135], v[224:227], v[216:219], v[120:135]
    v_add_u32 v79, 0x10000, v79
    ds_read_b128 v[200:203], v79 offset:0
    ds_read_b64_tr_b16 v[208:209], v75 offset:4096
    v_mfma_f32_32x32x16_bf16 v[152:167], v[224:227], v[220:223], v[152:167]
    ds_read_b64_tr_b16 v[210:211], v75 offset:5120
    ds_read_b128 v[204:207], v79 offset:4096
    v_mfma_f32_32x32x16_bf16 v[136:151], v[228:231], v[216:219], v[136:151]
    ds_read_b64_tr_b16 v[212:213], v76 offset:4096
    ds_read_b64_tr_b16 v[214:215], v76 offset:5120
    v_mfma_f32_32x32x16_bf16 v[168:183], v[228:231], v[220:223], v[168:183]
    s_waitcnt lgkmcnt(6)
    v_mfma_f32_32x32x16_bf16 v[120:135], v[192:195], v[184:187], v[120:135]
    v_add_u32 v80, 0x10000, v80
    ds_read_b128 v[216:219], v80 offset:0
    ds_read_b64_tr_b16 v[224:225], v75 offset:8192
    v_mfma_f32_32x32x16_bf16 v[152:167], v[192:195], v[188:191], v[152:167]
    ds_read_b64_tr_b16 v[226:227], v75 offset:9216
    ds_read_b128 v[220:223], v80 offset:4096
    v_mfma_f32_32x32x16_bf16 v[136:151], v[196:199], v[184:187], v[136:151]
    ds_read_b64_tr_b16 v[228:229], v76 offset:8192
    ds_read_b64_tr_b16 v[230:231], v76 offset:9216
    v_mfma_f32_32x32x16_bf16 v[168:183], v[196:199], v[188:191], v[168:183]
    s_waitcnt lgkmcnt(6)
    v_mfma_f32_32x32x16_bf16 v[120:135], v[208:211], v[200:203], v[120:135]
    v_add_u32 v81, 0x10000, v81
    ds_read_b128 v[184:187], v81 offset:0
    ds_read_b64_tr_b16 v[192:193], v75 offset:12288
    v_mfma_f32_32x32x16_bf16 v[152:167], v[208:211], v[204:207], v[152:167]
    ds_read_b64_tr_b16 v[194:195], v75 offset:13312
    ds_read_b128 v[188:191], v81 offset:4096
    v_mfma_f32_32x32x16_bf16 v[136:151], v[212:215], v[200:203], v[136:151]
    ds_read_b64_tr_b16 v[196:197], v76 offset:12288
    ds_read_b64_tr_b16 v[198:199], v76 offset:13312
    v_mfma_f32_32x32x16_bf16 v[168:183], v[212:215], v[204:207], v[168:183]
    s_barrier
    s_waitcnt lgkmcnt(6)
    v_mfma_f32_32x32x16_bf16 v[120:135], v[224:227], v[216:219], v[120:135]
    ds_read_b128 v[200:203], v78 offset:32768
    ds_read_b64_tr_b16 v[208:209], v75 offset:32768
    v_mfma_f32_32x32x16_bf16 v[152:167], v[224:227], v[220:223], v[152:167]
    ds_read_b64_tr_b16 v[210:211], v75 offset:33792
    ds_read_b128 v[204:207], v78 offset:36864
    v_mfma_f32_32x32x16_bf16 v[136:151], v[228:231], v[216:219], v[136:151]
    ds_read_b64_tr_b16 v[212:213], v76 offset:32768
    ds_read_b64_tr_b16 v[214:215], v76 offset:33792
    v_mfma_f32_32x32x16_bf16 v[168:183], v[228:231], v[220:223], v[168:183]
    s_waitcnt lgkmcnt(6)
    v_mfma_f32_32x32x16_bf16 v[120:135], v[192:195], v[184:187], v[120:135]
    ds_read_b128 v[216:219], v79 offset:32768
    ds_read_b64_tr_b16 v[224:225], v75 offset:36864
    v_mfma_f32_32x32x16_bf16 v[152:167], v[192:195], v[188:191], v[152:167]
    ds_read_b64_tr_b16 v[226:227], v75 offset:37888
    ds_read_b128 v[220:223], v79 offset:36864
    v_mfma_f32_32x32x16_bf16 v[136:151], v[196:199], v[184:187], v[136:151]
    ds_read_b64_tr_b16 v[228:229], v76 offset:36864
    ds_read_b64_tr_b16 v[230:231], v76 offset:37888
    v_mfma_f32_32x32x16_bf16 v[168:183], v[196:199], v[188:191], v[168:183]
    s_waitcnt lgkmcnt(6)
    v_mfma_f32_32x32x16_bf16 v[120:135], v[208:211], v[200:203], v[120:135]
    ds_read_b128 v[184:187], v80 offset:32768
    ds_read_b64_tr_b16 v[192:193], v75 offset:40960
    v_mfma_f32_32x32x16_bf16 v[152:167], v[208:211], v[204:207], v[152:167]
    ds_read_b64_tr_b16 v[194:195], v75 offset:41984
    ds_read_b128 v[188:191], v80 offset:36864
    v_mfma_f32_32x32x16_bf16 v[136:151], v[212:215], v[200:203], v[136:151]
    ds_read_b64_tr_b16 v[196:197], v76 offset:40960
    ds_read_b64_tr_b16 v[198:199], v76 offset:41984
    v_mfma_f32_32x32x16_bf16 v[168:183], v[212:215], v[204:207], v[168:183]
    s_waitcnt lgkmcnt(6)
    v_mfma_f32_32x32x16_bf16 v[120:135], v[224:227], v[216:219], v[120:135]
    ds_read_b128 v[200:203], v81 offset:32768
    ds_read_b64_tr_b16 v[208:209], v75 offset:45056
    v_mfma_f32_32x32x16_bf16 v[152:167], v[224:227], v[220:223], v[152:167]
    ds_read_b64_tr_b16 v[210:211], v75 offset:46080
    ds_read_b128 v[204:207], v81 offset:36864
    v_mfma_f32_32x32x16_bf16 v[136:151], v[228:231], v[216:219], v[136:151]
    ds_read_b64_tr_b16 v[212:213], v76 offset:45056
    ds_read_b64_tr_b16 v[214:215], v76 offset:46080
    v_mfma_f32_32x32x16_bf16 v[168:183], v[228:231], v[220:223], v[168:183]
    s_barrier
    s_waitcnt lgkmcnt(6)
    v_mfma_f32_32x32x16_bf16 v[120:135], v[192:195], v[184:187], v[120:135]
    v_add_u32 v78, 0x10000, v78
    ds_read_b128 v[216:219], v78 offset:0
    v_add_u32 v75, 0x10000, v75
    ds_read_b64_tr_b16 v[224:225], v75 offset:0
    v_mfma_f32_32x32x16_bf16 v[152:167], v[192:195], v[188:191], v[152:167]
    ds_read_b64_tr_b16 v[226:227], v75 offset:1024
    ds_read_b128 v[220:223], v78 offset:4096
    v_mfma_f32_32x32x16_bf16 v[136:151], v[196:199], v[184:187], v[136:151]
    v_add_u32 v76, 0x10000, v76
    ds_read_b64_tr_b16 v[228:229], v76 offset:0
    ds_read_b64_tr_b16 v[230:231], v76 offset:1024
    v_mfma_f32_32x32x16_bf16 v[168:183], v[196:199], v[188:191], v[168:183]
    s_waitcnt lgkmcnt(6)
    v_mfma_f32_32x32x16_bf16 v[120:135], v[208:211], v[200:203], v[120:135]
    v_add_u32 v79, 0x10000, v79
    ds_read_b128 v[184:187], v79 offset:0
    ds_read_b64_tr_b16 v[192:193], v75 offset:4096
    v_mfma_f32_32x32x16_bf16 v[152:167], v[208:211], v[204:207], v[152:167]
    ds_read_b64_tr_b16 v[194:195], v75 offset:5120
    ds_read_b128 v[188:191], v79 offset:4096
    v_mfma_f32_32x32x16_bf16 v[136:151], v[212:215], v[200:203], v[136:151]
    ds_read_b64_tr_b16 v[196:197], v76 offset:4096
    ds_read_b64_tr_b16 v[198:199], v76 offset:5120
    v_mfma_f32_32x32x16_bf16 v[168:183], v[212:215], v[204:207], v[168:183]
    s_waitcnt lgkmcnt(6)
    v_mfma_f32_32x32x16_bf16 v[120:135], v[224:227], v[216:219], v[120:135]
    v_add_u32 v80, 0x10000, v80
    ds_read_b128 v[200:203], v80 offset:0
    ds_read_b64_tr_b16 v[208:209], v75 offset:8192
    v_mfma_f32_32x32x16_bf16 v[152:167], v[224:227], v[220:223], v[152:167]
    ds_read_b64_tr_b16 v[210:211], v75 offset:9216
    ds_read_b128 v[204:207], v80 offset:4096
    v_mfma_f32_32x32x16_bf16 v[136:151], v[228:231], v[216:219], v[136:151]
    ds_read_b64_tr_b16 v[212:213], v76 offset:8192
    ds_read_b64_tr_b16 v[214:215], v76 offset:9216
    v_mfma_f32_32x32x16_bf16 v[168:183], v[228:231], v[220:223], v[168:183]
    s_waitcnt lgkmcnt(6)
    v_mfma_f32_32x32x16_bf16 v[120:135], v[192:195], v[184:187], v[120:135]
    v_add_u32 v81, 0x10000, v81
    ds_read_b128 v[216:219], v81 offset:0
    ds_read_b64_tr_b16 v[224:225], v75 offset:12288
    v_mfma_f32_32x32x16_bf16 v[152:167], v[192:195], v[188:191], v[152:167]
    ds_read_b64_tr_b16 v[226:227], v75 offset:13312
    ds_read_b128 v[220:223], v81 offset:4096
    v_mfma_f32_32x32x16_bf16 v[136:151], v[196:199], v[184:187], v[136:151]
    ds_read_b64_tr_b16 v[228:229], v76 offset:12288
    ds_read_b64_tr_b16 v[230:231], v76 offset:13312
    v_mfma_f32_32x32x16_bf16 v[168:183], v[196:199], v[188:191], v[168:183]
    s_barrier
    s_waitcnt lgkmcnt(6)
    v_mfma_f32_32x32x16_bf16 v[120:135], v[208:211], v[200:203], v[120:135]
    v_add_u32 v78, 0xfffe0000, v78
    ds_read_b128 v[184:187], v78 offset:0
    v_add_u32 v75, 0xfffe0000, v75
    ds_read_b64_tr_b16 v[192:193], v75 offset:0
    v_mfma_f32_32x32x16_bf16 v[152:167], v[208:211], v[204:207], v[152:167]
    ds_read_b64_tr_b16 v[194:195], v75 offset:1024
    ds_read_b128 v[188:191], v78 offset:4096
    v_mfma_f32_32x32x16_bf16 v[136:151], v[212:215], v[200:203], v[136:151]
    v_add_u32 v76, 0xfffe0000, v76
    ds_read_b64_tr_b16 v[196:197], v76 offset:0
    ds_read_b64_tr_b16 v[198:199], v76 offset:1024
    v_mfma_f32_32x32x16_bf16 v[168:183], v[212:215], v[204:207], v[168:183]
    s_waitcnt lgkmcnt(6)
    v_mfma_f32_32x32x16_bf16 v[120:135], v[224:227], v[216:219], v[120:135]
    v_add_u32 v79, 0xfffe0000, v79
    ds_read_b128 v[200:203], v79 offset:0
    ds_read_b64_tr_b16 v[208:209], v75 offset:4096
    v_mfma_f32_32x32x16_bf16 v[152:167], v[224:227], v[220:223], v[152:167]
    ds_read_b64_tr_b16 v[210:211], v75 offset:5120
    ds_read_b128 v[204:207], v79 offset:4096
    v_mfma_f32_32x32x16_bf16 v[136:151], v[228:231], v[216:219], v[136:151]
    ds_read_b64_tr_b16 v[212:213], v76 offset:4096
    ds_read_b64_tr_b16 v[214:215], v76 offset:5120
    v_mfma_f32_32x32x16_bf16 v[168:183], v[228:231], v[220:223], v[168:183]
    s_waitcnt lgkmcnt(6)
    v_mfma_f32_32x32x16_bf16 v[120:135], v[192:195], v[184:187], v[120:135]
    v_add_u32 v80, 0xfffe0000, v80
    ds_read_b128 v[216:219], v80 offset:0
    ds_read_b64_tr_b16 v[224:225], v75 offset:8192
    v_mfma_f32_32x32x16_bf16 v[152:167], v[192:195], v[188:191], v[152:167]
    ds_read_b64_tr_b16 v[226:227], v75 offset:9216
    ds_read_b128 v[220:223], v80 offset:4096
    v_mfma_f32_32x32x16_bf16 v[136:151], v[196:199], v[184:187], v[136:151]
    ds_read_b64_tr_b16 v[228:229], v76 offset:8192
    ds_read_b64_tr_b16 v[230:231], v76 offset:9216
    v_mfma_f32_32x32x16_bf16 v[168:183], v[196:199], v[188:191], v[168:183]
    s_waitcnt lgkmcnt(6)
    v_mfma_f32_32x32x16_bf16 v[120:135], v[208:211], v[200:203], v[120:135]
    v_add_u32 v81, 0xfffe0000, v81
    ds_read_b128 v[184:187], v81 offset:0
    ds_read_b64_tr_b16 v[192:193], v75 offset:12288
    v_mfma_f32_32x32x16_bf16 v[152:167], v[208:211], v[204:207], v[152:167]
    ds_read_b64_tr_b16 v[194:195], v75 offset:13312
    ds_read_b128 v[188:191], v81 offset:4096
    v_mfma_f32_32x32x16_bf16 v[136:151], v[212:215], v[200:203], v[136:151]
    ds_read_b64_tr_b16 v[196:197], v76 offset:12288
    ds_read_b64_tr_b16 v[198:199], v76 offset:13312
    v_mfma_f32_32x32x16_bf16 v[168:183], v[212:215], v[204:207], v[168:183]
    s_barrier
    s_waitcnt lgkmcnt(6)
    v_mfma_f32_32x32x16_bf16 v[120:135], v[224:227], v[216:219], v[120:135]
    ds_read_b128 v[200:203], v78 offset:32768
    ds_read_b64_tr_b16 v[208:209], v75 offset:32768
    v_mfma_f32_32x32x16_bf16 v[152:167], v[224:227], v[220:223], v[152:167]
    ds_read_b64_tr_b16 v[210:211], v75 offset:33792
    ds_read_b128 v[204:207], v78 offset:36864
    v_mfma_f32_32x32x16_bf16 v[136:151], v[228:231], v[216:219], v[136:151]
    ds_read_b64_tr_b16 v[212:213], v76 offset:32768
    ds_read_b64_tr_b16 v[214:215], v76 offset:33792
    v_mfma_f32_32x32x16_bf16 v[168:183], v[228:231], v[220:223], v[168:183]
    s_cmp_eq_u32 s60, 0
    s_cbranch_scc0 Lpi_8001
    s_mov_b32 s68, 4096
    buffer_load_dwordx4 v[22:25], v27, s[52:55], s68 offen sc1
Lpi_8001:
    s_waitcnt lgkmcnt(6)
    v_mfma_f32_32x32x16_bf16 v[120:135], v[192:195], v[184:187], v[120:135]
    ds_read_b128 v[216:219], v79 offset:32768
    ds_read_b64_tr_b16 v[224:225], v75 offset:36864
    v_mfma_f32_32x32x16_bf16 v[152:167], v[192:195], v[188:191], v[152:167]
    ds_read_b64_tr_b16 v[226:227], v75 offset:37888
    ds_read_b128 v[220:223], v79 offset:36864
    v_mfma_f32_32x32x16_bf16 v[136:151], v[196:199], v[184:187], v[136:151]
    ds_read_b64_tr_b16 v[228:229], v76 offset:36864
    ds_read_b64_tr_b16 v[230:231], v76 offset:37888
    v_mfma_f32_32x32x16_bf16 v[168:183], v[196:199], v[188:191], v[168:183]
    s_waitcnt lgkmcnt(6)
    v_mfma_f32_32x32x16_bf16 v[120:135], v[208:211], v[200:203], v[120:135]
    ds_read_b128 v[184:187], v80 offset:32768
    ds_read_b64_tr_b16 v[192:193], v75 offset:40960
    v_mfma_f32_32x32x16_bf16 v[152:167], v[208:211], v[204:207], v[152:167]
    ds_read_b64_tr_b16 v[194:195], v75 offset:41984
    ds_read_b128 v[188:191], v80 offset:36864
    v_mfma_f32_32x32x16_bf16 v[136:151], v[212:215], v[200:203], v[136:151]
    ds_read_b64_tr_b16 v[196:197], v76 offset:40960
    ds_read_b64_tr_b16 v[198:199], v76 offset:41984
    v_mfma_f32_32x32x16_bf16 v[168:183], v[212:215], v[204:207], v[168:183]
    s_waitcnt lgkmcnt(6)
    v_mfma_f32_32x32x16_bf16 v[120:135], v[224:227], v[216:219], v[120:135]
    ds_read_b128 v[200:203], v81 offset:32768
    ds_read_b64_tr_b16 v[208:209], v75 offset:45056
    v_mfma_f32_32x32x16_bf16 v[152:167], v[224:227], v[220:223], v[152:167]
    ds_read_b64_tr_b16 v[210:211], v75 offset:46080
    ds_read_b128 v[204:207], v81 offset:36864
    v_mfma_f32_32x32x16_bf16 v[136:151], v[228:231], v[216:219], v[136:151]
    ds_read_b64_tr_b16 v[212:213], v76 offset:45056
    ds_read_b64_tr_b16 v[214:215], v76 offset:46080
    v_mfma_f32_32x32x16_bf16 v[168:183], v[228:231], v[220:223], v[168:183]
    s_barrier
    s_waitcnt lgkmcnt(6)
    v_mfma_f32_32x32x16_bf16 v[120:135], v[192:195], v[184:187], v[120:135]
    v_add_u32 v78, 0x10000, v78
    ds_read_b128 v[216:219], v78 offset:0
    v_add_u32 v75, 0x10000, v75
    ds_read_b64_tr_b16 v[224:225], v75 offset:0
    v_mfma_f32_32x32x16_bf16 v[152:167], v[192:195], v[188:191], v[152:167]
    ds_read_b64_tr_b16 v[226:227], v75 offset:1024
    ds_read_b128 v[220:223], v78 offset:4096
    v_mfma_f32_32x32x16_bf16 v[136:151], v[196:199], v[184:187], v[136:151]
    v_add_u32 v76, 0x10000, v76
    ds_read_b64_tr_b16 v[228:229], v76 offset:0
    ds_read_b64_tr_b16 v[230:231], v76 offset:1024
    v_mfma_f32_32x32x16_bf16 v[168:183], v[196:199], v[188:191], v[168:183]
    s_waitcnt lgkmcnt(6)
    v_mfma_f32_32x32x16_bf16 v[120:135], v[208:211], v[200:203], v[120:135]
    v_add_u32 v79, 0x10000, v79
    ds_read_b128 v[184:187], v79 offset:0
    ds_read_b64_tr_b16 v[192:193], v75 offset:4096
    v_mfma_f32_32x32x16_bf16 v[152:167], v[208:211], v[204:207], v[152:167]
    ds_read_b64_tr_b16 v[194:195], v75 offset:5120
    ds_read_b128 v[188:191], v79 offset:4096
    v_mfma_f32_32x32x16_bf16 v[136:151], v[212:215], v[200:203], v[136:151]
    ds_read_b64_tr_b16 v[196:197], v76 offset:4096
    ds_read_b64_tr_b16 v[198:199], v76 offset:5120
    v_mfma_f32_32x32x16_bf16 v[168:183], v[212:215], v[204:207], v[168:183]
    s_waitcnt lgkmcnt(6)
    v_mfma_f32_32x32x16_bf16 v[120:135], v[224:227], v[216:219], v[120:135]
    v_add_u32 v80, 0x10000, v80
    ds_read_b128 v[200:203], v80 offset:0
    ds_read_b64_tr_b16 v[208:209], v75 offset:8192
    v_mfma_f32_32x32x16_bf16 v[152:167], v[224:227], v[220:223], v[152:167]
    ds_read_b64_tr_b16 v[210:211], v75 offset:9216
    ds_read_b128 v[204:207], v80 offset:4096
    v_mfma_f32_32x32x16_bf16 v[136:151], v[228:231], v[216:219], v[136:151]
    ds_read_b64_tr_b16 v[212:213], v76 offset:8192
    ds_read_b64_tr_b16 v[214:215], v76 offset:9216
    v_mfma_f32_32x32x16_bf16 v[168:183], v[228:231], v[220:223], v[168:183]
    s_waitcnt lgkmcnt(6)
    v_mfma_f32_32x32x16_bf16 v[120:135], v[192:195], v[184:187], v[120:135]
    v_add_u32 v81, 0x10000, v81
    ds_read_b128 v[216:219], v81 offset:0
    ds_read_b64_tr_b16 v[224:225], v75 offset:12288
    v_mfma_f32_32x32x16_bf16 v[152:167], v[192:195], v[188:191], v[152:167]
    ds_read_b64_tr_b16 v[226:227], v75 offset:13312
    ds_read_b128 v[220:223], v81 offset:4096
    v_mfma_f32_32x32x16_bf16 v[136:151], v[196:199], v[184:187], v[136:151]
    ds_read_b64_tr_b16 v[228:229], v76 offset:12288
    ds_read_b64_tr_b16 v[230:231], v76 offset:13312
    v_mfma_f32_32x32x16_bf16 v[168:183], v[196:199], v[188:191], v[168:183]
    s_cmp_eq_u32 s60, 0
    s_cbranch_scc0 Lok_8002
    s_waitcnt vmcnt(0)
Lpoll_8003:
    v_xor_b32 v1, v17, v22
    v_xor_b32 v2, v17, v23
    v_xor_b32 v3, v17, v24
    v_or3_b32 v1, v1, v2, v3
    v_xor_b32 v2, v17, v25
    v_or_b32 v1, v1, v2
    v_cmp_ne_u32 vcc, 0, v1
    s_nop 0
    s_cbranch_vccz Lok_8002
    s_sub_u32 s80, s80, 1
    s_cbranch_scc1 L_end
    s_mov_b32 s68, 4096
    buffer_load_dwordx4 v[22:25], v27, s[52:55], s68 offen sc1
    s_waitcnt vmcnt(0)
    s_branch Lpoll_8003
Lok_8002:
    s_barrier
    s_waitcnt lgkmcnt(6)
    v_mfma_f32_32x32x16_bf16 v[120:135], v[208:211], v[200:203], v[120:135]
    ds_read_b128 v[184:187], v78 offset:32768
    ds_read_b64_tr_b16 v[192:193], v75 offset:32768
    v_mfma_f32_32x32x16_bf16 v[152:167], v[208:211], v[204:207], v[152:167]
    ds_read_b64_tr_b16 v[194:195], v75 offset:33792
    ds_read_b128 v[188:191], v78 offset:36864
    v_mfma_f32_32x32x16_bf16 v[136:151], v[212:215], v[200:203], v[136:151]
    ds_read_b64_tr_b16 v[196:197], v76 offset:32768
    ds_read_b64_tr_b16 v[198:199], v76 offset:33792
    v_mfma_f32_32x32x16_bf16 v[168:183], v[212:215], v[204:207], v[168:183]
    s_waitcnt lgkmcnt(6)
    v_mfma_f32_32x32x16_bf16 v[120:135], v[224:227], v[216:219], v[120:135]
    ds_read_b128 v[200:203], v79 offset:32768
    ds_read_b64_tr_b16 v[208:209], v75 offset:36864
    v_mfma_f32_32x32x16_bf16 v[152:167], v[224:227], v[220:223], v[152:167]
    ds_read_b64_tr_b16 v[210:211], v75 offset:37888
    ds_read_b128 v[204:207], v79 offset:36864
    v_mfma_f32_32x32x16_bf16 v[136:151], v[228:231], v[216:219], v[136:151]
    ds_read_b64_tr_b16 v[212:213], v76 offset:36864
    ds_read_b64_tr_b16 v[214:215], v76 offset:37888
    v_mfma_f32_32x32x16_bf16 v[168:183], v[228:231], v[220:223], v[168:183]
    s_waitcnt lgkmcnt(6)
    v_mfma_f32_32x32x16_bf16 v[120:135], v[192:195], v[184:187], v[120:135]
    ds_read_b128 v[216:219], v80 offset:32768
    ds_read_b64_tr_b16 v[224:225], v75 offset:40960
    v_mfma_f32_32x32x16_bf16 v[152:167], v[192:195], v[188:191], v[152:167]
    ds_read_b64_tr_b16 v[226:227], v75 offset:41984
    ds_read_b128 v[220:223], v80 offset:36864
    v_mfma_f32_32x32x16_bf16 v[136:151], v[196:199], v[184:187], v[136:151]
    ds_read_b64_tr_b16 v[228:229], v76 offset:40960
    ds_read_b64_tr_b16 v[230:231], v76 offset:41984
    v_mfma_f32_32x32x16_bf16 v[168:183], v[196:199], v[188:191], v[168:183]
    s_waitcnt lgkmcnt(6)
    v_mfma_f32_32x32x16_bf16 v[120:135], v[208:211], v[200:203], v[120:135]
    ds_read_b128 v[184:187], v81 offset:32768
    ds_read_b64_tr_b16 v[192:193], v75 offset:45056
    v_mfma_f32_32x32x16_bf16 v[152:167], v[208:211], v[204:207], v[152:167]
    ds_read_b64_tr_b16 v[194:195], v75 offset:46080
    ds_read_b128 v[188:191], v81 offset:36864
    v_mfma_f32_32x32x16_bf16 v[136:151], v[212:215], v[200:203], v[136:151]
    ds_read_b64_tr_b16 v[196:197], v76 offset:45056
    ds_read_b64_tr_b16 v[198:199], v76 offset:46080
    v_mfma_f32_32x32x16_bf16 v[168:183], v[212:215], v[204:207], v[168:183]
    s_barrier
    s_waitcnt lgkmcnt(6)
    v_mfma_f32_32x32x16_bf16 v[120:135], v[224:227], v[216:219], v[120:135]
    v_add_u32 v78, 0x10000, v78
    ds_read_b128 v[200:203], v78 offset:0
    v_add_u32 v75, 0x10000, v75
    ds_read_b64_tr_b16 v[208:209], v75 offset:0
    v_mfma_f32_32x32x16_bf16 v[152:167], v[224:227], v[220:223], v[152:167]
    ds_read_b64_tr_b16 v[210:211], v75 offset:1024
    ds_read_b128 v[204:207], v78 offset:4096
    v_mfma_f32_32x32x16_bf16 v[136:151], v[228:231], v[216:219], v[136:151]
    v_add_u32 v76, 0x10000, v76
    ds_read_b64_tr_b16 v[212:213], v76 offset:0
    ds_read_b64_tr_b16 v[214:215], v76 offset:1024
    v_mfma_f32_32x32x16_bf16 v[168:183], v[228:231], v[220:223], v[168:183]
    s_waitcnt lgkmcnt(6)
    v_mfma_f32_32x32x16_bf16 v[120:135], v[192:195], v[184:187], v[120:135]
    v_add_u32 v79, 0x10000, v79
    ds_read_b128 v[216:219], v79 offset:0
    ds_read_b64_tr_b16 v[224:225], v75 offset:4096
    v_mfma_f32_32x32x16_bf16 v[152:167], v[192:195], v[188:191], v[152:167]
    ds_read_b64_tr_b16 v[226:227], v75 offset:5120
    ds_read_b128 v[220:223], v79 offset:4096
    v_mfma_f32_32x32x16_bf16 v[136:151], v[196:199], v[184:187], v[136:151]
    ds_read_b64_tr_b16 v[228:229], v76 offset:4096
    ds_read_b64_tr_b16 v[230:231], v76 offset:5120
    v_mfma_f32_32x32x16_bf16 v[168:183], v[196:199], v[188:191], v[168:183]
    s_waitcnt lgkmcnt(6)
    v_mfma_f32_32x32x16_bf16 v[120:135], v[208:211], v[200:203], v[120:135]
    v_add_u32 v80, 0x10000, v80
    ds_read_b128 v[184:187], v80 offset:0
    ds_read_b64_tr_b16 v[192:193], v75 offset:8192
    v_mfma_f32_32x32x16_bf16 v[152:167], v[208:211], v[204:207], v[152:167]
    ds_read_b64_tr_b16 v[194:195], v75 offset:9216
    ds_read_b128 v[188:191], v80 offset:4096
    v_mfma_f32_32x32x16_bf16 v[136:151], v[212:215], v[200:203], v[136:151]
    ds_read_b64_tr_b16 v[196:197], v76 offset:8192
    ds_read_b64_tr_b16 v[198:199], v76 offset:9216
    v_mfma_f32_32x32x16_bf16 v[168:183], v[212:215], v[204:207], v[168:183]
    s_waitcnt lgkmcnt(6)
    v_mfma_f32_32x32x16_bf16 v[120:135], v[224:227], v[216:219], v[120:135]
    v_add_u32 v81, 0x10000, v81
    ds_read_b128 v[200:203], v81 offset:0
    ds_read_b64_tr_b16 v[208:209], v75 offset:12288
    v_mfma_f32_32x32x16_bf16 v[152:167], v[224:227], v[220:223], v[152:167]
    ds_read_b64_tr_b16 v[210:211], v75 offset:13312
    ds_read_b128 v[204:207], v81 offset:4096
    v_mfma_f32_32x32x16_bf16 v[136:151], v[228:231], v[216:219], v[136:151]
    ds_read_b64_tr_b16 v[212:213], v76 offset:12288
    ds_read_b64_tr_b16 v[214:215], v76 offset:13312
    v_mfma_f32_32x32x16_bf16 v[168:183], v[228:231], v[220:223], v[168:183]
    s_waitcnt lgkmcnt(6)
    v_mfma_f32_32x32x16_bf16 v[120:135], v[192:195], v[184:187], v[120:135]
    v_mfma_f32_32x32x16_bf16 v[152:167], v[192:195], v[188:191], v[152:167]
    v_mfma_f32_32x32x16_bf16 v[136:151], v[196:199], v[184:187], v[136:151]
    v_mfma_f32_32x32x16_bf16 v[168:183], v[196:199], v[188:191], v[168:183]
    s_waitcnt lgkmcnt(0)
    v_mfma_f32_32x32x16_bf16 v[120:135], v[208:211], v[200:203], v[120:135]
    v_mfma_f32_32x32x16_bf16 v[152:167], v[208:211], v[204:207], v[152:167]
    v_mfma_f32_32x32x16_bf16 v[136:151], v[212:215], v[200:203], v[136:151]
    v_mfma_f32_32x32x16_bf16 v[168:183], v[212:215], v[204:207], v[168:183]
    s_barrier
L_cons_end:
    s_cmp_lt_u32 s43, 5
    s_cbranch_scc0 Lnoscale_8004
    s_nop 8
    v_pk_mul_f32 v[120:121], v[120:121], s[90:91] op_sel_hi:[1,0]
    v_pk_mul_f32 v[122:123], v[122:123], s[90:91] op_sel_hi:[1,0]
    v_pk_mul_f32 v[124:125], v[124:125], s[90:91] op_sel_hi:[1,0]
    v_pk_mul_f32 v[126:127], v[126:127], s[90:91] op_sel_hi:[1,0]
    v_pk_mul_f32 v[128:129], v[128:129], s[90:91] op_sel_hi:[1,0]
    v_pk_mul_f32 v[130:131], v[130:131], s[90:91] op_sel_hi:[1,0]
    v_pk_mul_f32 v[132:133], v[132:133], s[90:91] op_sel_hi:[1,0]
    v_pk_mul_f32 v[134:135], v[134:135], s[90:91] op_sel_hi:[1,0]
    v_pk_mul_f32 v[136:137], v[136:137], s[90:91] op_sel_hi:[1,0]
    v_pk_mul_f32 v[138:139], v[138:139], s[90:91] op_sel_hi:[1,0]
    v_pk_mul_f32 v[140:141], v[140:141], s[90:91] op_sel_hi:[1,0]
    v_pk_mul_f32 v[142:143], v[142:143], s[90:91] op_sel_hi:[1,0]
    v_pk_mul_f32 v[144:145], v[144:145], s[90:91] op_sel_hi:[1,0]
    v_pk_mul_f32 v[146:147], v[146:147], s[90:91] op_sel_hi:[1,0]
    v_pk_mul_f32 v[148:149], v[148:149], s[90:91] op_sel_hi:[1,0]
    v_pk_mul_f32 v[150:151], v[150:151], s[90:91] op_sel_hi:[1,0]
    v_pk_mul_f32 v[152:153], v[152:153], s[90:91] op_sel_hi:[1,0]
    v_pk_mul_f32 v[154:155], v[154:155], s[90:91] op_sel_hi:[1,0]
    v_pk_mul_f32 v[156:157], v[156:157], s[90:91] op_sel_hi:[1,0]
    v_pk_mul_f32 v[158:159], v[158:159], s[90:91] op_sel_hi:[1,0]
    v_pk_mul_f32 v[160:161], v[160:161], s[90:91] op_sel_hi:[1,0]
    v_pk_mul_f32 v[162:163], v[162:163], s[90:91] op_sel_hi:[1,0]
    v_pk_mul_f32 v[164:165], v[164:165], s[90:91] op_sel_hi:[1,0]
    v_pk_mul_f32 v[166:167], v[166:167], s[90:91] op_sel_hi:[1,0]
    v_pk_mul_f32 v[168:169], v[168:169], s[90:91] op_sel_hi:[1,0]
    v_pk_mul_f32 v[170:171], v[170:171], s[90:91] op_sel_hi:[1,0]
    v_pk_mul_f32 v[172:173], v[172:173], s[90:91] op_sel_hi:[1,0]
    v_pk_mul_f32 v[174:175], v[174:175], s[90:91] op_sel_hi:[1,0]
    v_pk_mul_f32 v[176:177], v[176:177], s[90:91] op_sel_hi:[1,0]
    v_pk_mul_f32 v[178:179], v[178:179], s[90:91] op_sel_hi:[1,0]
    v_pk_mul_f32 v[180:181], v[180:181], s[90:91] op_sel_hi:[1,0]
    v_pk_mul_f32 v[182:183], v[182:183], s[90:91] op_sel_hi:[1,0]
Lnoscale_8004:
    s_nop 9
    v_cvt_pk_bf16_f32 v192, v120, v121
    v_cvt_pk_bf16_f32 v193, v122, v123
    v_cvt_pk_bf16_f32 v196, v124, v125
    v_cvt_pk_bf16_f32 v197, v126, v127
    v_cvt_pk_bf16_f32 v200, v128, v129
    v_cvt_pk_bf16_f32 v201, v130, v131
    v_cvt_pk_bf16_f32 v204, v132, v133
    v_cvt_pk_bf16_f32 v205, v134, v135
    v_cvt_pk_bf16_f32 v208, v136, v137
    v_cvt_pk_bf16_f32 v209, v138, v139
    v_cvt_pk_bf16_f32 v212, v140, v141
    v_cvt_pk_bf16_f32 v213, v142, v143
    v_cvt_pk_bf16_f32 v216, v144, v145
    v_cvt_pk_bf16_f32 v217, v146, v147
    v_cvt_pk_bf16_f32 v220, v148, v149
    v_cvt_pk_bf16_f32 v221, v150, v151
    v_cvt_pk_bf16_f32 v194, v152, v153
    v_cvt_pk_bf16_f32 v195, v154, v155
    v_cvt_pk_bf16_f32 v198, v156, v157
    v_cvt_pk_bf16_f32 v199, v158, v159
    v_cvt_pk_bf16_f32 v202, v160, v161
    v_cvt_pk_bf16_f32 v203, v162, v163
    v_cvt_pk_bf16_f32 v206, v164, v165
    v_cvt_pk_bf16_f32 v207, v166, v167
    v_cvt_pk_bf16_f32 v210, v168, v169
    v_cvt_pk_bf16_f32 v211, v170, v171
    v_cvt_pk_bf16_f32 v214, v172, v173
    v_cvt_pk_bf16_f32 v215, v174, v175
    v_cvt_pk_bf16_f32 v218, v176, v177
    v_cvt_pk_bf16_f32 v219, v178, v179
    v_cvt_pk_bf16_f32 v222, v180, v181
    v_cvt_pk_bf16_f32 v223, v182, v183
Lqs_8005:
    s_branch L_attnB
L_fallback:
    s_mov_b32 s11, 8
    s_mov_b32 s79, 1
    v_mov_b32 v1, 4048155338
    s_waitcnt vmcnt(0) lgkmcnt(0)
    s_barrier
    v_and_b32 v3, 31, v0
    v_lshrrev_b32 v2, 5, v0
    v_lshlrev_b32 v2, 2, v2
    v_sub_u32 v3, v3, v2
    v_mov_b32 v30, 4048155338
    v_cmp_gt_i32 s[86:87], 0, v3
    v_cmp_gt_i32 s[88:89], 1, v3
    s_nop 0
    v_cndmask_b32 v32, 0, v30, s[86:87]
    v_cndmask_b32 v48, v30, 0, s[86:87]
    v_cndmask_b32 v33, 0, v30, s[88:89]
    v_cndmask_b32 v49, v30, 0, s[88:89]
    v_cmp_gt_i32 s[86:87], 2, v3
    v_cmp_gt_i32 s[88:89], 3, v3
    s_nop 0
    v_cndmask_b32 v34, 0, v30, s[86:87]
    v_cndmask_b32 v50, v30, 0, s[86:87]
    v_cndmask_b32 v35, 0, v30, s[88:89]
    v_cndmask_b32 v51, v30, 0, s[88:89]
    v_cmp_gt_i32 s[86:87], 8, v3
    v_cmp_gt_i32 s[88:89], 9, v3
    s_nop 0
    v_cndmask_b32 v36, 0, v30, s[86:87]
    v_cndmask_b32 v52, v30, 0, s[86:87]
    v_cndmask_b32 v37, 0, v30, s[88:89]
    v_cndmask_b32 v53, v30, 0, s[88:89]
    v_cmp_gt_i32 s[86:87], 10, v3
    v_cmp_gt_i32 s[88:89], 11, v3
    s_nop 0
    v_cndmask_b32 v38, 0, v30, s[86:87]
    v_cndmask_b32 v54, v30, 0, s[86:87]
    v_cndmask_b32 v39, 0, v30, s[88:89]
    v_cndmask_b32 v55, v30, 0, s[88:89]
    v_cmp_gt_i32 s[86:87], 16, v3
    v_cmp_gt_i32 s[88:89], 17, v3
    s_nop 0
    v_cndmask_b32 v40, 0, v30, s[86:87]
    v_cndmask_b32 v56, v30, 0, s[86:87]
    v_cndmask_b32 v41, 0, v30, s[88:89]
    v_cndmask_b32 v57, v30, 0, s[88:89]
    v_cmp_gt_i32 s[86:87], 18, v3
    v_cmp_gt_i32 s[88:89], 19, v3
    s_nop 0
    v_cndmask_b32 v42, 0, v30, s[86:87]
    v_cndmask_b32 v58, v30, 0, s[86:87]
    v_cndmask_b32 v43, 0, v30, s[88:89]
    v_cndmask_b32 v59, v30, 0, s[88:89]
    v_cmp_gt_i32 s[86:87], 24, v3
    v_cmp_gt_i32 s[88:89], 25, v3
    s_nop 0
    v_cndmask_b32 v44, 0, v30, s[86:87]
    v_cndmask_b32 v60, v30, 0, s[86:87]
    v_cndmask_b32 v45, 0, v30, s[88:89]
    v_cndmask_b32 v61, v30, 0, s[88:89]
    v_cmp_gt_i32 s[86:87], 26, v3
    v_cmp_gt_i32 s[88:89], 27, v3
    s_nop 0
    v_cndmask_b32 v46, 0, v30, s[86:87]
    v_cndmask_b32 v62, v30, 0, s[86:87]
    v_cndmask_b32 v47, 0, v30, s[88:89]
    v_cndmask_b32 v63, v30, 0, s[88:89]
    s_add_u32 m0, s66, 0
    s_add_u32 s68, s66, 131072
    buffer_load_dwordx4 v27, s[52:55], s68 offen sc1 lds
    s_add_u32 m0, s66, 8192
    s_add_u32 s68, s66, 139264
    buffer_load_dwordx4 v27, s[52:55], s68 offen sc1 lds
    s_cmp_ge_u32 s60, 5
    s_cbranch_scc1 Lkv_5001
    s_add_u32 m0, s66, 16384
    s_add_u32 s68, s66, 147456
    buffer_load_dwordx4 v27, s[52:55], s68 offen sc1 lds
Lkv_5001:
    s_waitcnt vmcnt(0)
    s_barrier
    ds_read_b128 v[160:163], v189 offset:0
    ds_read_b128 v[164:167], v189 offset:1024
    ds_read_b64 v[168:169], v190 offset:2048
    s_waitcnt lgkmcnt(0)
    v_mfma_f32_32x32x16_bf16 v[64:79], v[160:163], v[4:7], 0
    v_mfma_f32_32x32x16_bf16 v[80:95], v[164:167], v[4:7], 0
    s_nop 9
    v_mfma_f32_32x32x4_2b_bf16 v[64:95], v[168:169], v[8:9], v[64:95]
    s_nop 15
    s_nop 3
    v_max3_f32 v1, v1, v64, v65
    v_max3_f32 v1, v1, v66, v67
    v_max3_f32 v1, v1, v68, v69
    v_max3_f32 v1, v1, v70, v71
    v_max3_f32 v1, v1, v72, v73
    v_max3_f32 v1, v1, v74, v75
    v_max3_f32 v1, v1, v76, v77
    v_max3_f32 v1, v1, v78, v79
    v_max3_f32 v1, v1, v80, v81
    v_max3_f32 v1, v1, v82, v83
    v_max3_f32 v1, v1, v84, v85
    v_max3_f32 v1, v1, v86, v87
    v_max3_f32 v1, v1, v88, v89
    v_max3_f32 v1, v1, v90, v91
    v_max3_f32 v1, v1, v92, v93
    v_max3_f32 v1, v1, v94, v95
    ds_read_b128 v[160:163], v189 offset:5376
    ds_read_b128 v[164:167], v189 offset:6400
    ds_read_b64 v[168:169], v190 offset:7424
    s_waitcnt lgkmcnt(0)
    v_mfma_f32_32x32x16_bf16 v[64:79], v[160:163], v[4:7], 0
    v_mfma_f32_32x32x16_bf16 v[80:95], v[164:167], v[4:7], 0
    s_nop 9
    v_mfma_f32_32x32x4_2b_bf16 v[64:95], v[168:169], v[8:9], v[64:95]
    s_nop 15
    s_nop 3
    v_max3_f32 v1, v1, v64, v65
    v_max3_f32 v1, v1, v66, v67
    v_max3_f32 v1, v1, v68, v69
    v_max3_f32 v1, v1, v70, v71
    v_max3_f32 v1, v1, v72, v73
    v_max3_f32 v1, v1, v74, v75
    v_max3_f32 v1, v1, v76, v77
    v_max3_f32 v1, v1, v78, v79
    v_max3_f32 v1, v1, v80, v81
    v_max3_f32 v1, v1, v82, v83
    v_max3_f32 v1, v1, v84, v85
    v_max3_f32 v1, v1, v86, v87
    v_max3_f32 v1, v1, v88, v89
    v_max3_f32 v1, v1, v90, v91
    v_max3_f32 v1, v1, v92, v93
    v_max3_f32 v1, v1, v94, v95
    ds_read_b128 v[160:163], v189 offset:10752
    ds_read_b128 v[164:167], v189 offset:11776
    ds_read_b64 v[168:169], v190 offset:12800
    s_waitcnt lgkmcnt(0)
    v_mfma_f32_32x32x16_bf16 v[64:79], v[160:163], v[4:7], 0
    v_mfma_f32_32x32x16_bf16 v[80:95], v[164:167], v[4:7], 0
    s_nop 9
    v_mfma_f32_32x32x4_2b_bf16 v[64:95], v[168:169], v[8:9], v[64:95]
    s_nop 15
    s_nop 3
    v_max3_f32 v1, v1, v64, v65
    v_max3_f32 v1, v1, v66, v67
    v_max3_f32 v1, v1, v68, v69
    v_max3_f32 v1, v1, v70, v71
    v_max3_f32 v1, v1, v72, v73
    v_max3_f32 v1, v1, v74, v75
    v_max3_f32 v1, v1, v76, v77
    v_max3_f32 v1, v1, v78, v79
    v_max3_f32 v1, v1, v80, v81
    v_max3_f32 v1, v1, v82, v83
    v_max3_f32 v1, v1, v84, v85
    v_max3_f32 v1, v1, v86, v87
    v_max3_f32 v1, v1, v88, v89
    v_max3_f32 v1, v1, v90, v91
    v_max3_f32 v1, v1, v92, v93
    v_max3_f32 v1, v1, v94, v95
    ds_read_b128 v[160:163], v189 offset:16128
    ds_read_b128 v[164:167], v189 offset:17152
    ds_read_b64 v[168:169], v190 offset:18176
    s_waitcnt lgkmcnt(0)
    v_mfma_f32_32x32x16_bf16 v[64:79], v[160:163], v[4:7], 0
    v_mfma_f32_32x32x16_bf16 v[80:95], v[164:167], v[4:7], 0
    s_nop 9
    v_mfma_f32_32x32x4_2b_bf16 v[64:95], v[168:169], v[8:9], v[64:95]
    s_nop 15
    s_nop 3
    v_max3_f32 v1, v1, v64, v65
    v_max3_f32 v1, v1, v66, v67
    v_max3_f32 v1, v1, v68, v69
    v_max3_f32 v1, v1, v70, v71
    v_max3_f32 v1, v1, v72, v73
    v_max3_f32 v1, v1, v74, v75
    v_max3_f32 v1, v1, v76, v77
    v_max3_f32 v1, v1, v78, v79
    v_max3_f32 v1, v1, v80, v81
    v_max3_f32 v1, v1, v82, v83
    v_max3_f32 v1, v1, v84, v85
    v_max3_f32 v1, v1, v86, v87
    v_max3_f32 v1, v1, v88, v89
    v_max3_f32 v1, v1, v90, v91
    v_max3_f32 v1, v1, v92, v93
    v_max3_f32 v1, v1, v94, v95
    s_barrier
    s_add_u32 m0, s66, 21504
    s_add_u32 s68, s66, 152576
    buffer_load_dwordx4 v27, s[52:55], s68 offen sc1 lds
    s_add_u32 m0, s66, 29696
    s_add_u32 s68, s66, 160768
    buffer_load_dwordx4 v27, s[52:55], s68 offen sc1 lds
    s_cmp_ge_u32 s60, 5
    s_cbranch_scc1 Lkv_5002
    s_add_u32 m0, s66, 37888
    s_add_u32 s68, s66, 168960
    buffer_load_dwordx4 v27, s[52:55], s68 offen sc1 lds
Lkv_5002:
    s_waitcnt vmcnt(0)
    s_barrier
    ds_read_b128 v[160:163], v189 offset:21504
    ds_read_b128 v[164:167], v189 offset:22528
    ds_read_b64 v[168:169], v190 offset:23552
    s_waitcnt lgkmcnt(0)
    v_mfma_f32_32x32x16_bf16 v[64:79], v[160:163], v[4:7], 0
    v_mfma_f32_32x32x16_bf16 v[80:95], v[164:167], v[4:7], 0
    s_nop 9
    v_mfma_f32_32x32x4_2b_bf16 v[64:95], v[168:169], v[8:9], v[64:95]
    s_nop 15
    s_nop 3
    v_max3_f32 v1, v1, v64, v65
    v_max3_f32 v1, v1, v66, v67
    v_max3_f32 v1, v1, v68, v69
    v_max3_f32 v1, v1, v70, v71
    v_max3_f32 v1, v1, v72, v73
    v_max3_f32 v1, v1, v74, v75
    v_max3_f32 v1, v1, v76, v77
    v_max3_f32 v1, v1, v78, v79
    v_max3_f32 v1, v1, v80, v81
    v_max3_f32 v1, v1, v82, v83
    v_max3_f32 v1, v1, v84, v85
    v_max3_f32 v1, v1, v86, v87
    v_max3_f32 v1, v1, v88, v89
    v_max3_f32 v1, v1, v90, v91
    v_max3_f32 v1, v1, v92, v93
    v_max3_f32 v1, v1, v94, v95
    ds_read_b128 v[160:163], v189 offset:26880
    ds_read_b128 v[164:167], v189 offset:27904
    ds_read_b64 v[168:169], v190 offset:28928
    s_waitcnt lgkmcnt(0)
    v_mfma_f32_32x32x16_bf16 v[64:79], v[160:163], v[4:7], 0
    v_mfma_f32_32x32x16_bf16 v[80:95], v[164:167], v[4:7], 0
    s_nop 9
    v_mfma_f32_32x32x4_2b_bf16 v[64:95], v[168:169], v[8:9], v[64:95]
    s_nop 15
    s_nop 3
    v_max3_f32 v1, v1, v64, v65
    v_max3_f32 v1, v1, v66, v67
    v_max3_f32 v1, v1, v68, v69
    v_max3_f32 v1, v1, v70, v71
    v_max3_f32 v1, v1, v72, v73
    v_max3_f32 v1, v1, v74, v75
    v_max3_f32 v1, v1, v76, v77
    v_max3_f32 v1, v1, v78, v79
    v_max3_f32 v1, v1, v80, v81
    v_max3_f32 v1, v1, v82, v83
    v_max3_f32 v1, v1, v84, v85
    v_max3_f32 v1, v1, v86, v87
    v_max3_f32 v1, v1, v88, v89
    v_max3_f32 v1, v1, v90, v91
    v_max3_f32 v1, v1, v92, v93
    v_max3_f32 v1, v1, v94, v95
    ds_read_b128 v[160:163], v189 offset:32256
    ds_read_b128 v[164:167], v189 offset:33280
    ds_read_b64 v[168:169], v190 offset:34304
    s_waitcnt lgkmcnt(0)
    v_mfma_f32_32x32x16_bf16 v[64:79], v[160:163], v[4:7], 0
    v_mfma_f32_32x32x16_bf16 v[80:95], v[164:167], v[4:7], 0
    s_nop 9
    v_mfma_f32_32x32x4_2b_bf16 v[64:95], v[168:169], v[8:9], v[64:95]
    s_nop 15
    s_nop 3
    v_max3_f32 v1, v1, v64, v65
    v_max3_f32 v1, v1, v66, v67
    v_max3_f32 v1, v1, v68, v69
    v_max3_f32 v1, v1, v70, v71
    v_max3_f32 v1, v1, v72, v73
    v_max3_f32 v1, v1, v74, v75
    v_max3_f32 v1, v1, v76, v77
    v_max3_f32 v1, v1, v78, v79
    v_max3_f32 v1, v1, v80, v81
    v_max3_f32 v1, v1, v82, v83
    v_max3_f32 v1, v1, v84, v85
    v_max3_f32 v1, v1, v86, v87
    v_max3_f32 v1, v1, v88, v89
    v_max3_f32 v1, v1, v90, v91
    v_max3_f32 v1, v1, v92, v93
    v_max3_f32 v1, v1, v94, v95
    ds_read_b128 v[160:163], v189 offset:37632
    ds_read_b128 v[164:167], v189 offset:38656
    ds_read_b64 v[168:169], v190 offset:39680
    s_waitcnt lgkmcnt(0)
    v_mfma_f32_32x32x16_bf16 v[64:79], v[160:163], v[4:7], 0
    v_mfma_f32_32x32x16_bf16 v[80:95], v[164:167], v[4:7], 0
    s_nop 9
    v_mfma_f32_32x32x4_2b_bf16 v[64:95], v[168:169], v[8:9], v[64:95]
    s_nop 15
    s_nop 3
    v_max3_f32 v1, v1, v64, v65
    v_max3_f32 v1, v1, v66, v67
    v_max3_f32 v1, v1, v68, v69
    v_max3_f32 v1, v1, v70, v71
    v_max3_f32 v1, v1, v72, v73
    v_max3_f32 v1, v1, v74, v75
    v_max3_f32 v1, v1, v76, v77
    v_max3_f32 v1, v1, v78, v79
    v_max3_f32 v1, v1, v80, v81
    v_max3_f32 v1, v1, v82, v83
    v_max3_f32 v1, v1, v84, v85
    v_max3_f32 v1, v1, v86, v87
    v_max3_f32 v1, v1, v88, v89
    v_max3_f32 v1, v1, v90, v91
    v_max3_f32 v1, v1, v92, v93
    v_max3_f32 v1, v1, v94, v95
    s_barrier
    s_add_u32 m0, s66, 43008
    s_add_u32 s68, s66, 174080
    buffer_load_dwordx4 v27, s[52:55], s68 offen sc1 lds
    s_add_u32 m0, s66, 51200
    s_add_u32 s68, s66, 182272
    buffer_load_dwordx4 v27, s[52:55], s68 offen sc1 lds
    s_cmp_ge_u32 s60, 5
    s_cbranch_scc1 Lkv_5003
    s_add_u32 m0, s66, 59392
    s_add_u32 s68, s66, 190464
    buffer_load_dwordx4 v27, s[52:55], s68 offen sc1 lds
Lkv_5003:
    s_waitcnt vmcnt(0)
    s_barrier
    ds_read_b128 v[160:163], v189 offset:43008
    ds_read_b128 v[164:167], v189 offset:44032
    ds_read_b64 v[168:169], v190 offset:45056
    s_waitcnt lgkmcnt(0)
    v_mfma_f32_32x32x16_bf16 v[64:79], v[160:163], v[4:7], 0
    v_mfma_f32_32x32x16_bf16 v[80:95], v[164:167], v[4:7], 0
    s_nop 9
    v_mfma_f32_32x32x4_2b_bf16 v[64:95], v[168:169], v[8:9], v[64:95]
    s_nop 15
    s_nop 3
    v_max3_f32 v1, v1, v64, v65
    v_max3_f32 v1, v1, v66, v67
    v_max3_f32 v1, v1, v68, v69
    v_max3_f32 v1, v1, v70, v71
    v_max3_f32 v1, v1, v72, v73
    v_max3_f32 v1, v1, v74, v75
    v_max3_f32 v1, v1, v76, v77
    v_max3_f32 v1, v1, v78, v79
    v_max3_f32 v1, v1, v80, v81
    v_max3_f32 v1, v1, v82, v83
    v_max3_f32 v1, v1, v84, v85
    v_max3_f32 v1, v1, v86, v87
    v_max3_f32 v1, v1, v88, v89
    v_max3_f32 v1, v1, v90, v91
    v_max3_f32 v1, v1, v92, v93
    v_max3_f32 v1, v1, v94, v95
    ds_read_b128 v[160:163], v189 offset:48384
    ds_read_b128 v[164:167], v189 offset:49408
    ds_read_b64 v[168:169], v190 offset:50432
    s_waitcnt lgkmcnt(0)
    v_mfma_f32_32x32x16_bf16 v[64:79], v[160:163], v[4:7], 0
    v_mfma_f32_32x32x16_bf16 v[80:95], v[164:167], v[4:7], 0
    s_nop 9
    v_mfma_f32_32x32x4_2b_bf16 v[64:95], v[168:169], v[8:9], v[64:95]
    s_nop 15
    s_nop 3
    v_max3_f32 v1, v1, v64, v65
    v_max3_f32 v1, v1, v66, v67
    v_max3_f32 v1, v1, v68, v69
    v_max3_f32 v1, v1, v70, v71
    v_max3_f32 v1, v1, v72, v73
    v_max3_f32 v1, v1, v74, v75
    v_max3_f32 v1, v1, v76, v77
    v_max3_f32 v1, v1, v78, v79
    v_max3_f32 v1, v1, v80, v81
    v_max3_f32 v1, v1, v82, v83
    v_max3_f32 v1, v1, v84, v85
    v_max3_f32 v1, v1, v86, v87
    v_max3_f32 v1, v1, v88, v89
    v_max3_f32 v1, v1, v90, v91
    v_max3_f32 v1, v1, v92, v93
    v_max3_f32 v1, v1, v94, v95
    ds_read_b128 v[160:163], v189 offset:53760
    ds_read_b128 v[164:167], v189 offset:54784
    ds_read_b64 v[168:169], v190 offset:55808
    s_waitcnt lgkmcnt(0)
    v_mfma_f32_32x32x16_bf16 v[64:79], v[160:163], v[4:7], 0
    v_mfma_f32_32x32x16_bf16 v[80:95], v[164:167], v[4:7], 0
    s_nop 9
    v_mfma_f32_32x32x4_2b_bf16 v[64:95], v[168:169], v[8:9], v[64:95]
    s_nop 15
    s_nop 3
    v_max3_f32 v1, v1, v64, v65
    v_max3_f32 v1, v1, v66, v67
    v_max3_f32 v1, v1, v68, v69
    v_max3_f32 v1, v1, v70, v71
    v_max3_f32 v1, v1, v72, v73
    v_max3_f32 v1, v1, v74, v75
    v_max3_f32 v1, v1, v76, v77
    v_max3_f32 v1, v1, v78, v79
    v_max3_f32 v1, v1, v80, v81
    v_max3_f32 v1, v1, v82, v83
    v_max3_f32 v1, v1, v84, v85
    v_max3_f32 v1, v1, v86, v87
    v_max3_f32 v1, v1, v88, v89
    v_max3_f32 v1, v1, v90, v91
    v_max3_f32 v1, v1, v92, v93
    v_max3_f32 v1, v1, v94, v95
    ds_read_b128 v[160:163], v189 offset:59136
    ds_read_b128 v[164:167], v189 offset:60160
    ds_read_b64 v[168:169], v190 offset:61184
    s_waitcnt lgkmcnt(0)
    v_mfma_f32_32x32x16_bf16 v[64:79], v[160:163], v[4:7], 0
    v_mfma_f32_32x32x16_bf16 v[80:95], v[164:167], v[4:7], 0
    s_nop 9
    v_mfma_f32_32x32x4_2b_bf16 v[64:95], v[168:169], v[8:9], v[64:95]
    s_nop 15
    s_nop 3
    v_max3_f32 v1, v1, v64, v65
    v_max3_f32 v1, v1, v66, v67
    v_max3_f32 v1, v1, v68, v69
    v_max3_f32 v1, v1, v70, v71
    v_max3_f32 v1, v1, v72, v73
    v_max3_f32 v1, v1, v74, v75
    v_max3_f32 v1, v1, v76, v77
    v_max3_f32 v1, v1, v78, v79
    v_max3_f32 v1, v1, v80, v81
    v_max3_f32 v1, v1, v82, v83
    v_max3_f32 v1, v1, v84, v85
    v_max3_f32 v1, v1, v86, v87
    v_max3_f32 v1, v1, v88, v89
    v_max3_f32 v1, v1, v90, v91
    v_max3_f32 v1, v1, v92, v93
    v_max3_f32 v1, v1, v94, v95
    s_barrier
    s_add_u32 m0, s66, 0
    s_add_u32 s68, s66, 195584
    buffer_load_dwordx4 v27, s[52:55], s68 offen sc1 lds
    s_add_u32 m0, s66, 8192
    s_add_u32 s68, s66, 203776
    buffer_load_dwordx4 v27, s[52:55], s68 offen sc1 lds
    s_cmp_ge_u32 s60, 5
    s_cbranch_scc1 Lkv_5004
    s_add_u32 m0, s66, 16384
    s_add_u32 s68, s66, 211968
    buffer_load_dwordx4 v27, s[52:55], s68 offen sc1 lds
Lkv_5004:
    s_waitcnt vmcnt(0)
    s_barrier
    ds_read_b128 v[160:163], v189 offset:0
    ds_read_b128 v[164:167], v189 offset:1024
    ds_read_b64 v[168:169], v190 offset:2048
    s_waitcnt lgkmcnt(0)
    v_mfma_f32_32x32x16_bf16 v[64:79], v[160:163], v[4:7], 0
    v_mfma_f32_32x32x16_bf16 v[80:95], v[164:167], v[4:7], 0
    s_nop 9
    v_mfma_f32_32x32x4_2b_bf16 v[64:95], v[168:169], v[8:9], v[64:95]
    s_nop 15
    s_nop 3
    v_max3_f32 v1, v1, v64, v65
    v_max3_f32 v1, v1, v66, v67
    v_max3_f32 v1, v1, v68, v69
    v_max3_f32 v1, v1, v70, v71
    v_max3_f32 v1, v1, v72, v73
    v_max3_f32 v1, v1, v74, v75
    v_max3_f32 v1, v1, v76, v77
    v_max3_f32 v1, v1, v78, v79
    v_max3_f32 v1, v1, v80, v81
    v_max3_f32 v1, v1, v82, v83
    v_max3_f32 v1, v1, v84, v85
    v_max3_f32 v1, v1, v86, v87
    v_max3_f32 v1, v1, v88, v89
    v_max3_f32 v1, v1, v90, v91
    v_max3_f32 v1, v1, v92, v93
    v_max3_f32 v1, v1, v94, v95
    ds_read_b128 v[160:163], v189 offset:5376
    ds_read_b128 v[164:167], v189 offset:6400
    ds_read_b64 v[168:169], v190 offset:7424
    s_waitcnt lgkmcnt(0)
    v_mfma_f32_32x32x16_bf16 v[64:79], v[160:163], v[4:7], 0
    v_mfma_f32_32x32x16_bf16 v[80:95], v[164:167], v[4:7], 0
    s_nop 9
    v_mfma_f32_32x32x4_2b_bf16 v[64:95], v[168:169], v[8:9], v[64:95]
    s_nop 15
    s_nop 3
    v_max3_f32 v1, v1, v64, v65
    v_max3_f32 v1, v1, v66, v67
    v_max3_f32 v1, v1, v68, v69
    v_max3_f32 v1, v1, v70, v71
    v_max3_f32 v1, v1, v72, v73
    v_max3_f32 v1, v1, v74, v75
    v_max3_f32 v1, v1, v76, v77
    v_max3_f32 v1, v1, v78, v79
    v_max3_f32 v1, v1, v80, v81
    v_max3_f32 v1, v1, v82, v83
    v_max3_f32 v1, v1, v84, v85
    v_max3_f32 v1, v1, v86, v87
    v_max3_f32 v1, v1, v88, v89
    v_max3_f32 v1, v1, v90, v91
    v_max3_f32 v1, v1, v92, v93
    v_max3_f32 v1, v1, v94, v95
    ds_read_b128 v[160:163], v189 offset:10752
    ds_read_b128 v[164:167], v189 offset:11776
    ds_read_b64 v[168:169], v190 offset:12800
    s_waitcnt lgkmcnt(0)
    v_mfma_f32_32x32x16_bf16 v[64:79], v[160:163], v[4:7], 0
    v_mfma_f32_32x32x16_bf16 v[80:95], v[164:167], v[4:7], 0
    s_nop 9
    v_mfma_f32_32x32x4_2b_bf16 v[64:95], v[168:169], v[8:9], v[64:95]
    s_nop 15
    s_nop 3
    v_max3_f32 v1, v1, v64, v65
    v_max3_f32 v1, v1, v66, v67
    v_max3_f32 v1, v1, v68, v69
    v_max3_f32 v1, v1, v70, v71
    v_max3_f32 v1, v1, v72, v73
    v_max3_f32 v1, v1, v74, v75
    v_max3_f32 v1, v1, v76, v77
    v_max3_f32 v1, v1, v78, v79
    v_max3_f32 v1, v1, v80, v81
    v_max3_f32 v1, v1, v82, v83
    v_max3_f32 v1, v1, v84, v85
    v_max3_f32 v1, v1, v86, v87
    v_max3_f32 v1, v1, v88, v89
    v_max3_f32 v1, v1, v90, v91
    v_max3_f32 v1, v1, v92, v93
    v_max3_f32 v1, v1, v94, v95
    ds_read_b128 v[160:163], v189 offset:16128
    ds_read_b128 v[164:167], v189 offset:17152
    ds_read_b64 v[168:169], v190 offset:18176
    s_waitcnt lgkmcnt(0)
    v_mfma_f32_32x32x16_bf16 v[64:79], v[160:163], v[4:7], 0
    v_mfma_f32_32x32x16_bf16 v[80:95], v[164:167], v[4:7], 0
    s_nop 9
    v_mfma_f32_32x32x4_2b_bf16 v[64:95], v[168:169], v[8:9], v[64:95]
    s_nop 15
    s_nop 3
    v_max3_f32 v1, v1, v64, v65
    v_max3_f32 v1, v1, v66, v67
    v_max3_f32 v1, v1, v68, v69
    v_max3_f32 v1, v1, v70, v71
    v_max3_f32 v1, v1, v72, v73
    v_max3_f32 v1, v1, v74, v75
    v_max3_f32 v1, v1, v76, v77
    v_max3_f32 v1, v1, v78, v79
    v_max3_f32 v1, v1, v80, v81
    v_max3_f32 v1, v1, v82, v83
    v_max3_f32 v1, v1, v84, v85
    v_max3_f32 v1, v1, v86, v87
    v_max3_f32 v1, v1, v88, v89
    v_max3_f32 v1, v1, v90, v91
    v_max3_f32 v1, v1, v92, v93
    v_max3_f32 v1, v1, v94, v95
    s_barrier
    s_add_u32 m0, s66, 21504
    s_add_u32 s68, s66, 217088
    buffer_load_dwordx4 v27, s[52:55], s68 offen sc1 lds
    s_add_u32 m0, s66, 29696
    s_add_u32 s68, s66, 225280
    buffer_load_dwordx4 v27, s[52:55], s68 offen sc1 lds
    s_cmp_ge_u32 s60, 5
    s_cbranch_scc1 Lkv_5005
    s_add_u32 m0, s66, 37888
    s_add_u32 s68, s66, 233472
    buffer_load_dwordx4 v27, s[52:55], s68 offen sc1 lds
Lkv_5005:
    s_waitcnt vmcnt(0)
    s_barrier
    ds_read_b128 v[160:163], v189 offset:21504
    ds_read_b128 v[164:167], v189 offset:22528
    ds_read_b64 v[168:169], v190 offset:23552
    s_waitcnt lgkmcnt(0)
    v_mfma_f32_32x32x16_bf16 v[64:79], v[160:163], v[4:7], 0
    v_mfma_f32_32x32x16_bf16 v[80:95], v[164:167], v[4:7], 0
    s_nop 9
    v_mfma_f32_32x32x4_2b_bf16 v[64:95], v[168:169], v[8:9], v[64:95]
    s_nop 15
    s_nop 3
    v_max3_f32 v1, v1, v64, v65
    v_max3_f32 v1, v1, v66, v67
    v_max3_f32 v1, v1, v68, v69
    v_max3_f32 v1, v1, v70, v71
    v_max3_f32 v1, v1, v72, v73
    v_max3_f32 v1, v1, v74, v75
    v_max3_f32 v1, v1, v76, v77
    v_max3_f32 v1, v1, v78, v79
    v_max3_f32 v1, v1, v80, v81
    v_max3_f32 v1, v1, v82, v83
    v_max3_f32 v1, v1, v84, v85
    v_max3_f32 v1, v1, v86, v87
    v_max3_f32 v1, v1, v88, v89
    v_max3_f32 v1, v1, v90, v91
    v_max3_f32 v1, v1, v92, v93
    v_max3_f32 v1, v1, v94, v95
    ds_read_b128 v[160:163], v189 offset:26880
    ds_read_b128 v[164:167], v189 offset:27904
    ds_read_b64 v[168:169], v190 offset:28928
    s_waitcnt lgkmcnt(0)
    v_mfma_f32_32x32x16_bf16 v[64:79], v[160:163], v[4:7], 0
    v_mfma_f32_32x32x16_bf16 v[80:95], v[164:167], v[4:7], 0
    s_nop 9
    v_mfma_f32_32x32x4_2b_bf16 v[64:95], v[168:169], v[8:9], v[64:95]
    s_nop 15
    s_nop 3
    v_max3_f32 v1, v1, v64, v65
    v_max3_f32 v1, v1, v66, v67
    v_max3_f32 v1, v1, v68, v69
    v_max3_f32 v1, v1, v70, v71
    v_max3_f32 v1, v1, v72, v73
    v_max3_f32 v1, v1, v74, v75
    v_max3_f32 v1, v1, v76, v77
    v_max3_f32 v1, v1, v78, v79
    v_max3_f32 v1, v1, v80, v81
    v_max3_f32 v1, v1, v82, v83
    v_max3_f32 v1, v1, v84, v85
    v_max3_f32 v1, v1, v86, v87
    v_max3_f32 v1, v1, v88, v89
    v_max3_f32 v1, v1, v90, v91
    v_max3_f32 v1, v1, v92, v93
    v_max3_f32 v1, v1, v94, v95
    ds_read_b128 v[160:163], v189 offset:32256
    ds_read_b128 v[164:167], v189 offset:33280
    ds_read_b64 v[168:169], v190 offset:34304
    s_waitcnt lgkmcnt(0)
    v_mfma_f32_32x32x16_bf16 v[64:79], v[160:163], v[4:7], 0
    v_mfma_f32_32x32x16_bf16 v[80:95], v[164:167], v[4:7], 0
    s_nop 9
    v_mfma_f32_32x32x4_2b_bf16 v[64:95], v[168:169], v[8:9], v[64:95]
    s_nop 15
    s_nop 3
    v_max3_f32 v1, v1, v64, v65
    v_max3_f32 v1, v1, v66, v67
    v_max3_f32 v1, v1, v68, v69
    v_max3_f32 v1, v1, v70, v71
    v_max3_f32 v1, v1, v72, v73
    v_max3_f32 v1, v1, v74, v75
    v_max3_f32 v1, v1, v76, v77
    v_max3_f32 v1, v1, v78, v79
    v_max3_f32 v1, v1, v80, v81
    v_max3_f32 v1, v1, v82, v83
    v_max3_f32 v1, v1, v84, v85
    v_max3_f32 v1, v1, v86, v87
    v_max3_f32 v1, v1, v88, v89
    v_max3_f32 v1, v1, v90, v91
    v_max3_f32 v1, v1, v92, v93
    v_max3_f32 v1, v1, v94, v95
    ds_read_b128 v[160:163], v189 offset:37632
    ds_read_b128 v[164:167], v189 offset:38656
    ds_read_b64 v[168:169], v190 offset:39680
    s_waitcnt lgkmcnt(0)
    v_mfma_f32_32x32x16_bf16 v[64:79], v[160:163], v[4:7], 0
    v_mfma_f32_32x32x16_bf16 v[80:95], v[164:167], v[4:7], 0
    s_nop 9
    v_mfma_f32_32x32x4_2b_bf16 v[64:95], v[168:169], v[8:9], v[64:95]
    s_nop 15
    s_nop 3
    v_max3_f32 v1, v1, v64, v65
    v_max3_f32 v1, v1, v66, v67
    v_max3_f32 v1, v1, v68, v69
    v_max3_f32 v1, v1, v70, v71
    v_max3_f32 v1, v1, v72, v73
    v_max3_f32 v1, v1, v74, v75
    v_max3_f32 v1, v1, v76, v77
    v_max3_f32 v1, v1, v78, v79
    v_max3_f32 v1, v1, v80, v81
    v_max3_f32 v1, v1, v82, v83
    v_max3_f32 v1, v1, v84, v85
    v_max3_f32 v1, v1, v86, v87
    v_max3_f32 v1, v1, v88, v89
    v_max3_f32 v1, v1, v90, v91
    v_max3_f32 v1, v1, v92, v93
    v_max3_f32 v1, v1, v94, v95
    s_barrier
    s_add_u32 m0, s66, 43008
    s_add_u32 s68, s66, 238592
    buffer_load_dwordx4 v27, s[52:55], s68 offen sc1 lds
    s_add_u32 m0, s66, 51200
    s_add_u32 s68, s66, 246784
    buffer_load_dwordx4 v27, s[52:55], s68 offen sc1 lds
    s_cmp_ge_u32 s60, 5
    s_cbranch_scc1 Lkv_5006
    s_add_u32 m0, s66, 59392
    s_add_u32 s68, s66, 254976
    buffer_load_dwordx4 v27, s[52:55], s68 offen sc1 lds
Lkv_5006:
    s_waitcnt vmcnt(0)
    s_barrier
    ds_read_b128 v[160:163], v189 offset:43008
    ds_read_b128 v[164:167], v189 offset:44032
    ds_read_b64 v[168:169], v190 offset:45056
    s_waitcnt lgkmcnt(0)
    v_mfma_f32_32x32x16_bf16 v[64:79], v[160:163], v[4:7], 0
    v_mfma_f32_32x32x16_bf16 v[80:95], v[164:167], v[4:7], 0
    s_nop 9
    v_mfma_f32_32x32x4_2b_bf16 v[64:95], v[168:169], v[8:9], v[64:95]
    s_nop 15
    s_nop 3
    v_max3_f32 v1, v1, v64, v65
    v_max3_f32 v1, v1, v66, v67
    v_max3_f32 v1, v1, v68, v69
    v_max3_f32 v1, v1, v70, v71
    v_max3_f32 v1, v1, v72, v73
    v_max3_f32 v1, v1, v74, v75
    v_max3_f32 v1, v1, v76, v77
    v_max3_f32 v1, v1, v78, v79
    v_max3_f32 v1, v1, v80, v81
    v_max3_f32 v1, v1, v82, v83
    v_max3_f32 v1, v1, v84, v85
    v_max3_f32 v1, v1, v86, v87
    v_max3_f32 v1, v1, v88, v89
    v_max3_f32 v1, v1, v90, v91
    v_max3_f32 v1, v1, v92, v93
    v_max3_f32 v1, v1, v94, v95
    ds_read_b128 v[160:163], v189 offset:48384
    ds_read_b128 v[164:167], v189 offset:49408
    ds_read_b64 v[168:169], v190 offset:50432
    s_waitcnt lgkmcnt(0)
    v_mfma_f32_32x32x16_bf16 v[64:79], v[160:163], v[4:7], 0
    v_mfma_f32_32x32x16_bf16 v[80:95], v[164:167], v[4:7], 0
    s_nop 9
    v_mfma_f32_32x32x4_2b_bf16 v[64:95], v[168:169], v[8:9], v[64:95]
    s_nop 15
    s_nop 3
    v_max3_f32 v1, v1, v64, v65
    v_max3_f32 v1, v1, v66, v67
    v_max3_f32 v1, v1, v68, v69
    v_max3_f32 v1, v1, v70, v71
    v_max3_f32 v1, v1, v72, v73
    v_max3_f32 v1, v1, v74, v75
    v_max3_f32 v1, v1, v76, v77
    v_max3_f32 v1, v1, v78, v79
    v_max3_f32 v1, v1, v80, v81
    v_max3_f32 v1, v1, v82, v83
    v_max3_f32 v1, v1, v84, v85
    v_max3_f32 v1, v1, v86, v87
    v_max3_f32 v1, v1, v88, v89
    v_max3_f32 v1, v1, v90, v91
    v_max3_f32 v1, v1, v92, v93
    v_max3_f32 v1, v1, v94, v95
    ds_read_b128 v[160:163], v189 offset:53760
    ds_read_b128 v[164:167], v189 offset:54784
    ds_read_b64 v[168:169], v190 offset:55808
    s_waitcnt lgkmcnt(0)
    v_mfma_f32_32x32x16_bf16 v[64:79], v[160:163], v[4:7], 0
    v_mfma_f32_32x32x16_bf16 v[80:95], v[164:167], v[4:7], 0
    s_nop 9
    v_mfma_f32_32x32x4_2b_bf16 v[64:95], v[168:169], v[8:9], v[64:95]
    s_nop 15
    s_nop 3
    v_max3_f32 v1, v1, v64, v65
    v_max3_f32 v1, v1, v66, v67
    v_max3_f32 v1, v1, v68, v69
    v_max3_f32 v1, v1, v70, v71
    v_max3_f32 v1, v1, v72, v73
    v_max3_f32 v1, v1, v74, v75
    v_max3_f32 v1, v1, v76, v77
    v_max3_f32 v1, v1, v78, v79
    v_max3_f32 v1, v1, v80, v81
    v_max3_f32 v1, v1, v82, v83
    v_max3_f32 v1, v1, v84, v85
    v_max3_f32 v1, v1, v86, v87
    v_max3_f32 v1, v1, v88, v89
    v_max3_f32 v1, v1, v90, v91
    v_max3_f32 v1, v1, v92, v93
    v_max3_f32 v1, v1, v94, v95
    ds_read_b128 v[160:163], v189 offset:59136
    ds_read_b128 v[164:167], v189 offset:60160
    ds_read_b64 v[168:169], v190 offset:61184
    s_waitcnt lgkmcnt(0)
    v_mfma_f32_32x32x16_bf16 v[64:79], v[160:163], v[4:7], 0
    v_mfma_f32_32x32x16_bf16 v[80:95], v[164:167], v[4:7], 0
    s_nop 9
    v_mfma_f32_32x32x4_2b_bf16 v[64:95], v[168:169], v[8:9], v[64:95]
    s_nop 15
    s_nop 3
    v_max3_f32 v1, v1, v64, v65
    v_max3_f32 v1, v1, v66, v67
    v_max3_f32 v1, v1, v68, v69
    v_max3_f32 v1, v1, v70, v71
    v_max3_f32 v1, v1, v72, v73
    v_max3_f32 v1, v1, v74, v75
    v_max3_f32 v1, v1, v76, v77
    v_max3_f32 v1, v1, v78, v79
    v_max3_f32 v1, v1, v80, v81
    v_max3_f32 v1, v1, v82, v83
    v_max3_f32 v1, v1, v84, v85
    v_max3_f32 v1, v1, v86, v87
    v_max3_f32 v1, v1, v88, v89
    v_max3_f32 v1, v1, v90, v91
    v_max3_f32 v1, v1, v92, v93
    v_max3_f32 v1, v1, v94, v95
    s_barrier
    s_add_u32 m0, s66, 0
    s_add_u32 s68, s66, 260096
    buffer_load_dwordx4 v27, s[52:55], s68 offen sc1 lds
    s_add_u32 m0, s66, 8192
    s_add_u32 s68, s66, 268288
    buffer_load_dwordx4 v27, s[52:55], s68 offen sc1 lds
    s_cmp_ge_u32 s60, 5
    s_cbranch_scc1 Lkv_5007
    s_add_u32 m0, s66, 16384
    s_add_u32 s68, s66, 276480
    buffer_load_dwordx4 v27, s[52:55], s68 offen sc1 lds
Lkv_5007:
    s_waitcnt vmcnt(0)
    s_barrier
    ds_read_b128 v[160:163], v189 offset:0
    ds_read_b128 v[164:167], v189 offset:1024
    ds_read_b64 v[168:169], v190 offset:2048
    s_waitcnt lgkmcnt(0)
    v_mfma_f32_32x32x16_bf16 v[64:79], v[160:163], v[4:7], 0
    v_mfma_f32_32x32x16_bf16 v[80:95], v[164:167], v[4:7], 0
    s_nop 9
    v_mfma_f32_32x32x4_2b_bf16 v[64:95], v[168:169], v[8:9], v[64:95]
    s_nop 15
    s_nop 3
    v_max3_f32 v1, v1, v64, v65
    v_max3_f32 v1, v1, v66, v67
    v_max3_f32 v1, v1, v68, v69
    v_max3_f32 v1, v1, v70, v71
    v_max3_f32 v1, v1, v72, v73
    v_max3_f32 v1, v1, v74, v75
    v_max3_f32 v1, v1, v76, v77
    v_max3_f32 v1, v1, v78, v79
    v_max3_f32 v1, v1, v80, v81
    v_max3_f32 v1, v1, v82, v83
    v_max3_f32 v1, v1, v84, v85
    v_max3_f32 v1, v1, v86, v87
    v_max3_f32 v1, v1, v88, v89
    v_max3_f32 v1, v1, v90, v91
    v_max3_f32 v1, v1, v92, v93
    v_max3_f32 v1, v1, v94, v95
    ds_read_b128 v[160:163], v189 offset:5376
    ds_read_b128 v[164:167], v189 offset:6400
    ds_read_b64 v[168:169], v190 offset:7424
    s_waitcnt lgkmcnt(0)
    v_mfma_f32_32x32x16_bf16 v[64:79], v[160:163], v[4:7], 0
    v_mfma_f32_32x32x16_bf16 v[80:95], v[164:167], v[4:7], 0
    s_nop 9
    v_mfma_f32_32x32x4_2b_bf16 v[64:95], v[168:169], v[8:9], v[64:95]
    s_nop 15
    s_nop 3
    v_max3_f32 v1, v1, v64, v65
    v_max3_f32 v1, v1, v66, v67
    v_max3_f32 v1, v1, v68, v69
    v_max3_f32 v1, v1, v70, v71
    v_max3_f32 v1, v1, v72, v73
    v_max3_f32 v1, v1, v74, v75
    v_max3_f32 v1, v1, v76, v77
    v_max3_f32 v1, v1, v78, v79
    v_max3_f32 v1, v1, v80, v81
    v_max3_f32 v1, v1, v82, v83
    v_max3_f32 v1, v1, v84, v85
    v_max3_f32 v1, v1, v86, v87
    v_max3_f32 v1, v1, v88, v89
    v_max3_f32 v1, v1, v90, v91
    v_max3_f32 v1, v1, v92, v93
    v_max3_f32 v1, v1, v94, v95
    ds_read_b128 v[160:163], v189 offset:10752
    ds_read_b128 v[164:167], v189 offset:11776
    ds_read_b64 v[168:169], v190 offset:12800
    s_waitcnt lgkmcnt(0)
    v_mfma_f32_32x32x16_bf16 v[64:79], v[160:163], v[4:7], 0
    v_mfma_f32_32x32x16_bf16 v[80:95], v[164:167], v[4:7], 0
    s_nop 9
    v_mfma_f32_32x32x4_2b_bf16 v[64:95], v[168:169], v[8:9], v[64:95]
    s_nop 15
    s_nop 3
    v_max3_f32 v1, v1, v64, v65
    v_max3_f32 v1, v1, v66, v67
    v_max3_f32 v1, v1, v68, v69
    v_max3_f32 v1, v1, v70, v71
    v_max3_f32 v1, v1, v72, v73
    v_max3_f32 v1, v1, v74, v75
    v_max3_f32 v1, v1, v76, v77
    v_max3_f32 v1, v1, v78, v79
    v_max3_f32 v1, v1, v80, v81
    v_max3_f32 v1, v1, v82, v83
    v_max3_f32 v1, v1, v84, v85
    v_max3_f32 v1, v1, v86, v87
    v_max3_f32 v1, v1, v88, v89
    v_max3_f32 v1, v1, v90, v91
    v_max3_f32 v1, v1, v92, v93
    v_max3_f32 v1, v1, v94, v95
    ds_read_b128 v[160:163], v189 offset:16128
    ds_read_b128 v[164:167], v189 offset:17152
    ds_read_b64 v[168:169], v190 offset:18176
    s_waitcnt lgkmcnt(0)
    v_mfma_f32_32x32x16_bf16 v[64:79], v[160:163], v[4:7], 0
    v_mfma_f32_32x32x16_bf16 v[80:95], v[164:167], v[4:7], 0
    s_nop 9
    v_mfma_f32_32x32x4_2b_bf16 v[64:95], v[168:169], v[8:9], v[64:95]
    s_nop 15
    s_nop 3
    v_max3_f32 v1, v1, v64, v65
    v_max3_f32 v1, v1, v66, v67
    v_max3_f32 v1, v1, v68, v69
    v_max3_f32 v1, v1, v70, v71
    v_max3_f32 v1, v1, v72, v73
    v_max3_f32 v1, v1, v74, v75
    v_max3_f32 v1, v1, v76, v77
    v_max3_f32 v1, v1, v78, v79
    v_max3_f32 v1, v1, v80, v81
    v_max3_f32 v1, v1, v82, v83
    v_max3_f32 v1, v1, v84, v85
    v_max3_f32 v1, v1, v86, v87
    v_max3_f32 v1, v1, v88, v89
    v_max3_f32 v1, v1, v90, v91
    v_max3_f32 v1, v1, v92, v93
    v_max3_f32 v1, v1, v94, v95
    s_barrier
    s_add_u32 m0, s66, 21504
    s_add_u32 s68, s66, 281600
    buffer_load_dwordx4 v27, s[52:55], s68 offen sc1 lds
    s_add_u32 m0, s66, 29696
    s_add_u32 s68, s66, 289792
    buffer_load_dwordx4 v27, s[52:55], s68 offen sc1 lds
    s_cmp_ge_u32 s60, 5
    s_cbranch_scc1 Lkv_5008
    s_add_u32 m0, s66, 37888
    s_add_u32 s68, s66, 297984
    buffer_load_dwordx4 v27, s[52:55], s68 offen sc1 lds
Lkv_5008:
    s_waitcnt vmcnt(0)
    s_barrier
    ds_read_b128 v[160:163], v189 offset:21504
    ds_read_b128 v[164:167], v189 offset:22528
    ds_read_b64 v[168:169], v190 offset:23552
    s_waitcnt lgkmcnt(0)
    v_mfma_f32_32x32x16_bf16 v[64:79], v[160:163], v[4:7], 0
    v_mfma_f32_32x32x16_bf16 v[80:95], v[164:167], v[4:7], 0
    s_nop 9
    v_mfma_f32_32x32x4_2b_bf16 v[64:95], v[168:169], v[8:9], v[64:95]
    s_nop 15
    s_nop 3
    v_max3_f32 v1, v1, v64, v65
    v_max3_f32 v1, v1, v66, v67
    v_max3_f32 v1, v1, v68, v69
    v_max3_f32 v1, v1, v70, v71
    v_max3_f32 v1, v1, v72, v73
    v_max3_f32 v1, v1, v74, v75
    v_max3_f32 v1, v1, v76, v77
    v_max3_f32 v1, v1, v78, v79
    v_max3_f32 v1, v1, v80, v81
    v_max3_f32 v1, v1, v82, v83
    v_max3_f32 v1, v1, v84, v85
    v_max3_f32 v1, v1, v86, v87
    v_max3_f32 v1, v1, v88, v89
    v_max3_f32 v1, v1, v90, v91
    v_max3_f32 v1, v1, v92, v93
    v_max3_f32 v1, v1, v94, v95
    ds_read_b128 v[160:163], v189 offset:26880
    ds_read_b128 v[164:167], v189 offset:27904
    ds_read_b64 v[168:169], v190 offset:28928
    s_waitcnt lgkmcnt(0)
    v_mfma_f32_32x32x16_bf16 v[64:79], v[160:163], v[4:7], 0
    v_mfma_f32_32x32x16_bf16 v[80:95], v[164:167], v[4:7], 0
    s_nop 9
    v_mfma_f32_32x32x4_2b_bf16 v[64:95], v[168:169], v[8:9], v[64:95]
    s_nop 15
    s_nop 3
    v_max3_f32 v1, v1, v64, v65
    v_max3_f32 v1, v1, v66, v67
    v_max3_f32 v1, v1, v68, v69
    v_max3_f32 v1, v1, v70, v71
    v_max3_f32 v1, v1, v72, v73
    v_max3_f32 v1, v1, v74, v75
    v_max3_f32 v1, v1, v76, v77
    v_max3_f32 v1, v1, v78, v79
    v_max3_f32 v1, v1, v80, v81
    v_max3_f32 v1, v1, v82, v83
    v_max3_f32 v1, v1, v84, v85
    v_max3_f32 v1, v1, v86, v87
    v_max3_f32 v1, v1, v88, v89
    v_max3_f32 v1, v1, v90, v91
    v_max3_f32 v1, v1, v92, v93
    v_max3_f32 v1, v1, v94, v95
    ds_read_b128 v[160:163], v189 offset:32256
    ds_read_b128 v[164:167], v189 offset:33280
    ds_read_b64 v[168:169], v190 offset:34304
    s_waitcnt lgkmcnt(0)
    v_mfma_f32_32x32x16_bf16 v[64:79], v[160:163], v[4:7], 0
    v_mfma_f32_32x32x16_bf16 v[80:95], v[164:167], v[4:7], 0
    s_nop 9
    v_mfma_f32_32x32x4_2b_bf16 v[64:95], v[168:169], v[8:9], v[64:95]
    s_nop 15
    s_nop 3
    v_max3_f32 v1, v1, v64, v65
    v_max3_f32 v1, v1, v66, v67
    v_max3_f32 v1, v1, v68, v69
    v_max3_f32 v1, v1, v70, v71
    v_max3_f32 v1, v1, v72, v73
    v_max3_f32 v1, v1, v74, v75
    v_max3_f32 v1, v1, v76, v77
    v_max3_f32 v1, v1, v78, v79
    v_max3_f32 v1, v1, v80, v81
    v_max3_f32 v1, v1, v82, v83
    v_max3_f32 v1, v1, v84, v85
    v_max3_f32 v1, v1, v86, v87
    v_max3_f32 v1, v1, v88, v89
    v_max3_f32 v1, v1, v90, v91
    v_max3_f32 v1, v1, v92, v93
    v_max3_f32 v1, v1, v94, v95
    ds_read_b128 v[160:163], v189 offset:37632
    ds_read_b128 v[164:167], v189 offset:38656
    ds_read_b64 v[168:169], v190 offset:39680
    s_waitcnt lgkmcnt(0)
    v_mfma_f32_32x32x16_bf16 v[64:79], v[160:163], v[4:7], 0
    v_mfma_f32_32x32x16_bf16 v[80:95], v[164:167], v[4:7], 0
    s_nop 9
    v_mfma_f32_32x32x4_2b_bf16 v[64:95], v[168:169], v[8:9], v[64:95]
    s_nop 15
    s_nop 3
    v_max3_f32 v1, v1, v64, v65
    v_max3_f32 v1, v1, v66, v67
    v_max3_f32 v1, v1, v68, v69
    v_max3_f32 v1, v1, v70, v71
    v_max3_f32 v1, v1, v72, v73
    v_max3_f32 v1, v1, v74, v75
    v_max3_f32 v1, v1, v76, v77
    v_max3_f32 v1, v1, v78, v79
    v_max3_f32 v1, v1, v80, v81
    v_max3_f32 v1, v1, v82, v83
    v_max3_f32 v1, v1, v84, v85
    v_max3_f32 v1, v1, v86, v87
    v_max3_f32 v1, v1, v88, v89
    v_max3_f32 v1, v1, v90, v91
    v_max3_f32 v1, v1, v92, v93
    v_max3_f32 v1, v1, v94, v95
    s_barrier
    s_add_u32 m0, s66, 0
    s_add_u32 s68, s66, 131072
    buffer_load_dwordx4 v27, s[52:55], s68 offen sc1 lds
    s_add_u32 m0, s66, 8192
    s_add_u32 s68, s66, 139264
    buffer_load_dwordx4 v27, s[52:55], s68 offen sc1 lds
    s_cmp_ge_u32 s60, 5
    s_cbranch_scc1 Lkv_5009
    s_add_u32 m0, s66, 16384
    s_add_u32 s68, s66, 147456
    buffer_load_dwordx4 v27, s[52:55], s68 offen sc1 lds
Lkv_5009:
    s_add_u32 m0, s66, 21504
    s_add_u32 s68, s66, 152576
    buffer_load_dwordx4 v27, s[52:55], s68 offen sc1 lds
    s_add_u32 m0, s66, 29696
    s_add_u32 s68, s66, 160768
    buffer_load_dwordx4 v27, s[52:55], s68 offen sc1 lds
    s_cmp_ge_u32 s60, 5
    s_cbranch_scc1 Lkv_5010
    s_add_u32 m0, s66, 37888
    s_add_u32 s68, s66, 168960
    buffer_load_dwordx4 v27, s[52:55], s68 offen sc1 lds
Lkv_5010:
    s_add_u32 m0, s66, 43008
    s_add_u32 s68, s66, 174080
    buffer_load_dwordx4 v27, s[52:55], s68 offen sc1 lds
    s_add_u32 m0, s66, 51200
    s_add_u32 s68, s66, 182272
    buffer_load_dwordx4 v27, s[52:55], s68 offen sc1 lds
    s_cmp_ge_u32 s60, 5
    s_cbranch_scc1 Lkv_5011
    s_add_u32 m0, s66, 59392
    s_add_u32 s68, s66, 190464
    buffer_load_dwordx4 v27, s[52:55], s68 offen sc1 lds
Lkv_5011:
    s_waitcnt vmcnt(0)
    s_barrier
    ds_read_b128 v[160:163], v189 offset:0
    ds_read_b128 v[164:167], v189 offset:1024
    ds_read_b64 v[168:169], v190 offset:2048
    v_mov_b32 v224, 0x3f803f80
    v_mov_b32 v225, 0
    v_mov_b32 v227, 0
    v_mov_b32 v229, 0
    v_mov_b32 v230, 0
    v_mov_b32 v231, 0
    s_waitcnt lgkmcnt(0)
    v_mfma_f32_32x32x16_bf16 v[64:79], v[160:163], v[4:7], 0
    v_mfma_f32_32x32x16_bf16 v[80:95], v[164:167], v[4:7], 0
    s_nop 9
    v_mfma_f32_32x32x4_2b_bf16 v[64:95], v[168:169], v[8:9], v[64:95]
    v_mfma_f32_32x32x8_bf16 v[128:143], v[224:225], v[230:231], 0
    ds_read_b128 v[160:163], v189 offset:5376
    ds_read_b128 v[164:167], v189 offset:6400
    ds_read_b128 v[172:175], v188 offset:2560
    ds_read_b128 v[176:179], v188 offset:3264
    ds_read_b128 v[180:183], v188 offset:3968
    ds_read_b64 v[168:169], v190 offset:7424
    s_waitcnt lgkmcnt(0)
    s_nop 15
    s_branch L_attnB_main
Lofretry_79:
    s_sub_u32 s80, s80, 1
    s_cbranch_scc1 L_end
    s_waitcnt vmcnt(0)
    s_mov_b32 s68, 12058624
    buffer_load_dwordx4 v[32:35], v29, s[52:55], s68 offen offset:0 sc1
    buffer_load_dwordx4 v[36:39], v29, s[52:55], s68 offen offset:2048 sc1
    s_mov_b32 s68, 12062720
    buffer_load_dwordx4 v[40:43], v29, s[52:55], s68 offen offset:0 sc1
    buffer_load_dwordx4 v[44:47], v29, s[52:55], s68 offen offset:2048 sc1
    s_mov_b32 s68, 12066816
    buffer_load_dwordx4 v[48:51], v29, s[52:55], s68 offen offset:0 sc1
    buffer_load_dwordx4 v[52:55], v29, s[52:55], s68 offen offset:2048 sc1
    s_mov_b32 s68, 12070912
    buffer_load_dwordx4 v[56:59], v29, s[52:55], s68 offen offset:0 sc1
    buffer_load_dwordx4 v[60:63], v29, s[52:55], s68 offen offset:2048 sc1
    s_mov_b32 s68, 12075008
    buffer_load_dwordx4 v[232:235], v29, s[52:55], s68 offen offset:0 sc1
    buffer_load_dwordx4 v[236:239], v29, s[52:55], s68 offen offset:2048 sc1
    s_waitcnt vmcnt(0)
    v_max3_u32 v1, v32, v33, v34
    v_max_u32 v1, v1, v35
    v_cmp_eq_u32 vcc, -1, v1
    s_nop 0
    s_cbranch_vccnz Lofretry_79
    s_branch Lofok_78
Lofretry_81:
    s_sub_u32 s80, s80, 1
    s_cbranch_scc1 L_end
    s_waitcnt vmcnt(0)
    s_mov_b32 s68, 12058624
    buffer_load_dwordx4 v[36:39], v29, s[52:55], s68 offen offset:2048 sc1
    s_mov_b32 s68, 12062720
    buffer_load_dwordx4 v[40:43], v29, s[52:55], s68 offen offset:0 sc1
    buffer_load_dwordx4 v[44:47], v29, s[52:55], s68 offen offset:2048 sc1
    s_mov_b32 s68, 12066816
    buffer_load_dwordx4 v[48:51], v29, s[52:55], s68 offen offset:0 sc1
    buffer_load_dwordx4 v[52:55], v29, s[52:55], s68 offen offset:2048 sc1
    s_mov_b32 s68, 12070912
    buffer_load_dwordx4 v[56:59], v29, s[52:55], s68 offen offset:0 sc1
    buffer_load_dwordx4 v[60:63], v29, s[52:55], s68 offen offset:2048 sc1
    s_mov_b32 s68, 12075008
    buffer_load_dwordx4 v[232:235], v29, s[52:55], s68 offen offset:0 sc1
    buffer_load_dwordx4 v[236:239], v29, s[52:55], s68 offen offset:2048 sc1
    s_waitcnt vmcnt(0)
    v_max3_u32 v1, v36, v37, v38
    v_max_u32 v1, v1, v39
    v_cmp_eq_u32 vcc, -1, v1
    s_nop 0
    s_cbranch_vccnz Lofretry_81
    s_branch Lofok_80
Lofretry_83:
    s_sub_u32 s80, s80, 1
    s_cbranch_scc1 L_end
    s_waitcnt vmcnt(0)
    s_mov_b32 s68, 12062720
    buffer_load_dwordx4 v[40:43], v29, s[52:55], s68 offen offset:0 sc1
    buffer_load_dwordx4 v[44:47], v29, s[52:55], s68 offen offset:2048 sc1
    s_mov_b32 s68, 12066816
    buffer_load_dwordx4 v[48:51], v29, s[52:55], s68 offen offset:0 sc1
    buffer_load_dwordx4 v[52:55], v29, s[52:55], s68 offen offset:2048 sc1
    s_mov_b32 s68, 12070912
    buffer_load_dwordx4 v[56:59], v29, s[52:55], s68 offen offset:0 sc1
    buffer_load_dwordx4 v[60:63], v29, s[52:55], s68 offen offset:2048 sc1
    s_mov_b32 s68, 12075008
    buffer_load_dwordx4 v[232:235], v29, s[52:55], s68 offen offset:0 sc1
    buffer_load_dwordx4 v[236:239], v29, s[52:55], s68 offen offset:2048 sc1
    s_waitcnt vmcnt(0)
    v_max3_u32 v1, v40, v41, v42
    v_max_u32 v1, v1, v43
    v_cmp_eq_u32 vcc, -1, v1
    s_nop 0
    s_cbranch_vccnz Lofretry_83
    s_branch Lofok_82
Lofretry_85:
    s_sub_u32 s80, s80, 1
    s_cbranch_scc1 L_end
    s_waitcnt vmcnt(0)
    s_mov_b32 s68, 12062720
    buffer_load_dwordx4 v[44:47], v29, s[52:55], s68 offen offset:2048 sc1
    s_mov_b32 s68, 12066816
    buffer_load_dwordx4 v[48:51], v29, s[52:55], s68 offen offset:0 sc1
    buffer_load_dwordx4 v[52:55], v29, s[52:55], s68 offen offset:2048 sc1
    s_mov_b32 s68, 12070912
    buffer_load_dwordx4 v[56:59], v29, s[52:55], s68 offen offset:0 sc1
    buffer_load_dwordx4 v[60:63], v29, s[52:55], s68 offen offset:2048 sc1
    s_mov_b32 s68, 12075008
    buffer_load_dwordx4 v[232:235], v29, s[52:55], s68 offen offset:0 sc1
    buffer_load_dwordx4 v[236:239], v29, s[52:55], s68 offen offset:2048 sc1
    s_waitcnt vmcnt(0)
    v_max3_u32 v1, v44, v45, v46
    v_max_u32 v1, v1, v47
    v_cmp_eq_u32 vcc, -1, v1
    s_nop 0
    s_cbranch_vccnz Lofretry_85
    s_branch Lofok_84
Lofretry_87:
    s_sub_u32 s80, s80, 1
    s_cbranch_scc1 L_end
    s_waitcnt vmcnt(0)
    s_mov_b32 s68, 12066816
    buffer_load_dwordx4 v[48:51], v29, s[52:55], s68 offen offset:0 sc1
    buffer_load_dwordx4 v[52:55], v29, s[52:55], s68 offen offset:2048 sc1
    s_mov_b32 s68, 12070912
    buffer_load_dwordx4 v[56:59], v29, s[52:55], s68 offen offset:0 sc1
    buffer_load_dwordx4 v[60:63], v29, s[52:55], s68 offen offset:2048 sc1
    s_mov_b32 s68, 12075008
    buffer_load_dwordx4 v[232:235], v29, s[52:55], s68 offen offset:0 sc1
    buffer_load_dwordx4 v[236:239], v29, s[52:55], s68 offen offset:2048 sc1
    s_waitcnt vmcnt(0)
    v_max3_u32 v1, v48, v49, v50
    v_max_u32 v1, v1, v51
    v_cmp_eq_u32 vcc, -1, v1
    s_nop 0
    s_cbranch_vccnz Lofretry_87
    s_branch Lofok_86
Lofretry_89:
    s_sub_u32 s80, s80, 1
    s_cbranch_scc1 L_end
    s_waitcnt vmcnt(0)
    s_mov_b32 s68, 12066816
    buffer_load_dwordx4 v[52:55], v29, s[52:55], s68 offen offset:2048 sc1
    s_mov_b32 s68, 12070912
    buffer_load_dwordx4 v[56:59], v29, s[52:55], s68 offen offset:0 sc1
    buffer_load_dwordx4 v[60:63], v29, s[52:55], s68 offen offset:2048 sc1
    s_mov_b32 s68, 12075008
    buffer_load_dwordx4 v[232:235], v29, s[52:55], s68 offen offset:0 sc1
    buffer_load_dwordx4 v[236:239], v29, s[52:55], s68 offen offset:2048 sc1
    s_waitcnt vmcnt(0)
    v_max3_u32 v1, v52, v53, v54
    v_max_u32 v1, v1, v55
    v_cmp_eq_u32 vcc, -1, v1
    s_nop 0
    s_cbranch_vccnz Lofretry_89
    s_branch Lofok_88
Lofretry_92:
    s_sub_u32 s80, s80, 1
    s_cbranch_scc1 L_end
    s_waitcnt vmcnt(0)
    s_mov_b32 s68, 12070912
    buffer_load_dwordx4 v[56:59], v29, s[52:55], s68 offen offset:0 sc1
    buffer_load_dwordx4 v[60:63], v29, s[52:55], s68 offen offset:2048 sc1
    s_mov_b32 s68, 12075008
    buffer_load_dwordx4 v[232:235], v29, s[52:55], s68 offen offset:0 sc1
    buffer_load_dwordx4 v[236:239], v29, s[52:55], s68 offen offset:2048 sc1
    s_waitcnt vmcnt(0)
    v_max3_u32 v1, v56, v57, v58
    v_max_u32 v1, v1, v59
    v_cmp_eq_u32 vcc, -1, v1
    s_nop 0
    s_cbranch_vccnz Lofretry_92
    s_branch Lofok_91
Lofretry_94:
    s_sub_u32 s80, s80, 1
    s_cbranch_scc1 L_end
    s_waitcnt vmcnt(0)
    s_mov_b32 s68, 12070912
    buffer_load_dwordx4 v[60:63], v29, s[52:55], s68 offen offset:2048 sc1
    s_mov_b32 s68, 12075008
    buffer_load_dwordx4 v[232:235], v29, s[52:55], s68 offen offset:0 sc1
    buffer_load_dwordx4 v[236:239], v29, s[52:55], s68 offen offset:2048 sc1
    s_waitcnt vmcnt(0)
    v_max3_u32 v1, v60, v61, v62
    v_max_u32 v1, v1, v63
    v_cmp_eq_u32 vcc, -1, v1
    s_nop 0
    s_cbranch_vccnz Lofretry_94
    s_branch Lofok_93
Lofretry_97:
    s_sub_u32 s80, s80, 1
    s_cbranch_scc1 L_end
    s_waitcnt vmcnt(0)
    s_mov_b32 s68, 12075008
    buffer_load_dwordx4 v[232:235], v29, s[52:55], s68 offen offset:0 sc1
    buffer_load_dwordx4 v[236:239], v29, s[52:55], s68 offen offset:2048 sc1
    s_waitcnt vmcnt(0)
    v_max3_u32 v1, v232, v233, v234
    v_max_u32 v1, v1, v235
    v_cmp_eq_u32 vcc, -1, v1
    s_nop 0
    s_cbranch_vccnz Lofretry_97
    s_branch Lofok_96
Lofretry_99:
    s_sub_u32 s80, s80, 1
    s_cbranch_scc1 L_end
    s_waitcnt vmcnt(0)
    s_mov_b32 s68, 12075008
    buffer_load_dwordx4 v[236:239], v29, s[52:55], s68 offen offset:2048 sc1
    s_waitcnt vmcnt(0)
    v_max3_u32 v1, v236, v237, v238
    v_max_u32 v1, v1, v239
    v_cmp_eq_u32 vcc, -1, v1
    s_nop 0
    s_cbranch_vccnz Lofretry_99
    s_branch Lofok_98
Lofretry_101:
    s_sub_u32 s80, s80, 1
    s_cbranch_scc1 L_end
    s_waitcnt vmcnt(0)
    s_mov_b32 s68, 9437184
    buffer_load_dwordx4 v[144:147], v29, s[52:55], s68 offen offset:0 sc1
    buffer_load_dwordx4 v[148:151], v29, s[52:55], s68 offen offset:2048 sc1
    s_mov_b32 s68, 9441280
    buffer_load_dwordx4 v[152:155], v29, s[52:55], s68 offen offset:0 sc1
    buffer_load_dwordx4 v[156:159], v29, s[52:55], s68 offen offset:2048 sc1
    s_mov_b32 s68, 9445376
    buffer_load_dwordx4 v[160:163], v29, s[52:55], s68 offen offset:0 sc1
    buffer_load_dwordx4 v[164:167], v29, s[52:55], s68 offen offset:2048 sc1
    s_mov_b32 s68, 9449472
    buffer_load_dwordx4 v[168:171], v29, s[52:55], s68 offen offset:0 sc1
    buffer_load_dwordx4 v[172:175], v29, s[52:55], s68 offen offset:2048 sc1
    s_mov_b32 s68, 9453568
    buffer_load_dwordx4 v[176:179], v29, s[52:55], s68 offen offset:0 sc1
    buffer_load_dwordx4 v[180:183], v29, s[52:55], s68 offen offset:2048 sc1
    s_waitcnt vmcnt(0)
    v_max3_u32 v1, v144, v145, v146
    v_max_u32 v1, v1, v147
    v_cmp_eq_u32 vcc, -1, v1
    s_nop 0
    s_cbranch_vccnz Lofretry_101
    s_branch Lofok_100
Lofretry_103:
    s_sub_u32 s80, s80, 1
    s_cbranch_scc1 L_end
    s_waitcnt vmcnt(0)
    s_mov_b32 s68, 9437184
    buffer_load_dwordx4 v[148:151], v29, s[52:55], s68 offen offset:2048 sc1
    s_mov_b32 s68, 9441280
    buffer_load_dwordx4 v[152:155], v29, s[52:55], s68 offen offset:0 sc1
    buffer_load_dwordx4 v[156:159], v29, s[52:55], s68 offen offset:2048 sc1
    s_mov_b32 s68, 9445376
    buffer_load_dwordx4 v[160:163], v29, s[52:55], s68 offen offset:0 sc1
    buffer_load_dwordx4 v[164:167], v29, s[52:55], s68 offen offset:2048 sc1
    s_mov_b32 s68, 9449472
    buffer_load_dwordx4 v[168:171], v29, s[52:55], s68 offen offset:0 sc1
    buffer_load_dwordx4 v[172:175], v29, s[52:55], s68 offen offset:2048 sc1
    s_mov_b32 s68, 9453568
    buffer_load_dwordx4 v[176:179], v29, s[52:55], s68 offen offset:0 sc1
    buffer_load_dwordx4 v[180:183], v29, s[52:55], s68 offen offset:2048 sc1
    s_waitcnt vmcnt(0)
    v_max3_u32 v1, v148, v149, v150
    v_max_u32 v1, v1, v151
    v_cmp_eq_u32 vcc, -1, v1
    s_nop 0
    s_cbranch_vccnz Lofretry_103
    s_branch Lofok_102
Lofretry_107:
    s_sub_u32 s80, s80, 1
    s_cbranch_scc1 L_end
    s_waitcnt vmcnt(0)
    s_mov_b32 s68, 9441280
    buffer_load_dwordx4 v[152:155], v29, s[52:55], s68 offen offset:0 sc1
    buffer_load_dwordx4 v[156:159], v29, s[52:55], s68 offen offset:2048 sc1
    s_mov_b32 s68, 9445376
    buffer_load_dwordx4 v[160:163], v29, s[52:55], s68 offen offset:0 sc1
    buffer_load_dwordx4 v[164:167], v29, s[52:55], s68 offen offset:2048 sc1
    s_mov_b32 s68, 9449472
    buffer_load_dwordx4 v[168:171], v29, s[52:55], s68 offen offset:0 sc1
    buffer_load_dwordx4 v[172:175], v29, s[52:55], s68 offen offset:2048 sc1
    s_mov_b32 s68, 9453568
    buffer_load_dwordx4 v[176:179], v29, s[52:55], s68 offen offset:0 sc1
    buffer_load_dwordx4 v[180:183], v29, s[52:55], s68 offen offset:2048 sc1
    s_waitcnt vmcnt(0)
    v_max3_u32 v1, v152, v153, v154
    v_max_u32 v1, v1, v155
    v_cmp_eq_u32 vcc, -1, v1
    s_nop 0
    s_cbranch_vccnz Lofretry_107
    s_branch Lofok_106
Lofretry_109:
    s_sub_u32 s80, s80, 1
    s_cbranch_scc1 L_end
    s_waitcnt vmcnt(0)
    s_mov_b32 s68, 9441280
    buffer_load_dwordx4 v[156:159], v29, s[52:55], s68 offen offset:2048 sc1
    s_mov_b32 s68, 9445376
    buffer_load_dwordx4 v[160:163], v29, s[52:55], s68 offen offset:0 sc1
    buffer_load_dwordx4 v[164:167], v29, s[52:55], s68 offen offset:2048 sc1
    s_mov_b32 s68, 9449472
    buffer_load_dwordx4 v[168:171], v29, s[52:55], s68 offen offset:0 sc1
    buffer_load_dwordx4 v[172:175], v29, s[52:55], s68 offen offset:2048 sc1
    s_mov_b32 s68, 9453568
    buffer_load_dwordx4 v[176:179], v29, s[52:55], s68 offen offset:0 sc1
    buffer_load_dwordx4 v[180:183], v29, s[52:55], s68 offen offset:2048 sc1
    s_waitcnt vmcnt(0)
    v_max3_u32 v1, v156, v157, v158
    v_max_u32 v1, v1, v159
    v_cmp_eq_u32 vcc, -1, v1
    s_nop 0
    s_cbranch_vccnz Lofretry_109
    s_branch Lofok_108
Lofretry_111:
    s_sub_u32 s80, s80, 1
    s_cbranch_scc1 L_end
    s_waitcnt vmcnt(0)
    s_mov_b32 s68, 9445376
    buffer_load_dwordx4 v[160:163], v29, s[52:55], s68 offen offset:0 sc1
    buffer_load_dwordx4 v[164:167], v29, s[52:55], s68 offen offset:2048 sc1
    s_mov_b32 s68, 9449472
    buffer_load_dwordx4 v[168:171], v29, s[52:55], s68 offen offset:0 sc1
    buffer_load_dwordx4 v[172:175], v29, s[52:55], s68 offen offset:2048 sc1
    s_mov_b32 s68, 9453568
    buffer_load_dwordx4 v[176:179], v29, s[52:55], s68 offen offset:0 sc1
    buffer_load_dwordx4 v[180:183], v29, s[52:55], s68 offen offset:2048 sc1
    s_waitcnt vmcnt(0)
    v_max3_u32 v1, v160, v161, v162
    v_max_u32 v1, v1, v163
    v_cmp_eq_u32 vcc, -1, v1
    s_nop 0
    s_cbranch_vccnz Lofretry_111
    s_branch Lofok_110
Lofretry_115:
    s_sub_u32 s80, s80, 1
    s_cbranch_scc1 L_end
    s_waitcnt vmcnt(0)
    s_mov_b32 s68, 9445376
    buffer_load_dwordx4 v[164:167], v29, s[52:55], s68 offen offset:2048 sc1
    s_mov_b32 s68, 9449472
    buffer_load_dwordx4 v[168:171], v29, s[52:55], s68 offen offset:0 sc1
    buffer_load_dwordx4 v[172:175], v29, s[52:55], s68 offen offset:2048 sc1
    s_mov_b32 s68, 9453568
    buffer_load_dwordx4 v[176:179], v29, s[52:55], s68 offen offset:0 sc1
    buffer_load_dwordx4 v[180:183], v29, s[52:55], s68 offen offset:2048 sc1
    s_waitcnt vmcnt(0)
    v_max3_u32 v1, v164, v165, v166
    v_max_u32 v1, v1, v167
    v_cmp_eq_u32 vcc, -1, v1
    s_nop 0
    s_cbranch_vccnz Lofretry_115
    s_branch Lofok_114
Lofretry_117:
    s_sub_u32 s80, s80, 1
    s_cbranch_scc1 L_end
    s_waitcnt vmcnt(0)
    s_mov_b32 s68, 9449472
    buffer_load_dwordx4 v[168:171], v29, s[52:55], s68 offen offset:0 sc1
    buffer_load_dwordx4 v[172:175], v29, s[52:55], s68 offen offset:2048 sc1
    s_mov_b32 s68, 9453568
    buffer_load_dwordx4 v[176:179], v29, s[52:55], s68 offen offset:0 sc1
    buffer_load_dwordx4 v[180:183], v29, s[52:55], s68 offen offset:2048 sc1
    s_waitcnt vmcnt(0)
    v_max3_u32 v1, v168, v169, v170
    v_max_u32 v1, v1, v171
    v_cmp_eq_u32 vcc, -1, v1
    s_nop 0
    s_cbranch_vccnz Lofretry_117
    s_branch Lofok_116
Lofretry_121:
    s_sub_u32 s80, s80, 1
    s_cbranch_scc1 L_end
    s_waitcnt vmcnt(0)
    s_mov_b32 s68, 9449472
    buffer_load_dwordx4 v[172:175], v29, s[52:55], s68 offen offset:2048 sc1
    s_mov_b32 s68, 9453568
    buffer_load_dwordx4 v[176:179], v29, s[52:55], s68 offen offset:0 sc1
    buffer_load_dwordx4 v[180:183], v29, s[52:55], s68 offen offset:2048 sc1
    s_waitcnt vmcnt(0)
    v_max3_u32 v1, v172, v173, v174
    v_max_u32 v1, v1, v175
    v_cmp_eq_u32 vcc, -1, v1
    s_nop 0
    s_cbranch_vccnz Lofretry_121
    s_branch Lofok_120
Lofretry_123:
    s_sub_u32 s80, s80, 1
    s_cbranch_scc1 L_end
    s_waitcnt vmcnt(0)
    s_mov_b32 s68, 9453568
    buffer_load_dwordx4 v[176:179], v29, s[52:55], s68 offen offset:0 sc1
    buffer_load_dwordx4 v[180:183], v29, s[52:55], s68 offen offset:2048 sc1
    s_waitcnt vmcnt(0)
    v_max3_u32 v1, v176, v177, v178
    v_max_u32 v1, v1, v179
    v_cmp_eq_u32 vcc, -1, v1
    s_nop 0
    s_cbranch_vccnz Lofretry_123
    s_branch Lofok_122
Lofretry_125:
    s_sub_u32 s80, s80, 1
    s_cbranch_scc1 L_end
    s_waitcnt vmcnt(0)
    s_mov_b32 s68, 9453568
    buffer_load_dwordx4 v[180:183], v29, s[52:55], s68 offen offset:2048 sc1
    s_waitcnt vmcnt(0)
    v_max3_u32 v1, v180, v181, v182
    v_max_u32 v1, v1, v183
    v_cmp_eq_u32 vcc, -1, v1
    s_nop 0
    s_cbranch_vccnz Lofretry_125
    s_branch Lofok_124
L_A_fallback:
    s_waitcnt lgkmcnt(0)
    s_mov_b32 s10, 0
    v_cndmask_b32 v10, v10, 0, s[84:85]
    ds_read_b64 v[160:161], v245 offset:23040
    ds_read_b64 v[162:163], v245 offset:24192
    ds_read_b64 v[168:169], v246 offset:23040
    s_waitcnt lgkmcnt(0)
    v_mfma_f32_32x32x16_bf16 v[96:111], v[160:163], v[12:15], v[32:47]
    v_mfma_f32_32x32x8_bf16 v[96:111], v[168:169], v[10:11], v[96:111]
    s_nop 11
    v_max3_f32 v208, v96, v97, v98
    v_max3_f32 v208, v208, v99, v100
    v_max3_f32 v208, v208, v101, v102
    v_max3_f32 v208, v208, v103, v104
    v_max3_f32 v208, v208, v105, v106
    v_max3_f32 v208, v208, v107, v108
    v_max3_f32 v208, v208, v109, v110
    v_max_f32 v208, v208, v111
    s_cmp_gt_u32 s78, 7
    s_cbranch_scc1 Lmaxdone_61
    ds_read_b64 v[164:165], v212 offset:17280
    ds_read_b64 v[166:167], v212 offset:18432
    ds_read_b64 v[170:171], v213 offset:17280
    s_waitcnt lgkmcnt(0)
    v_mfma_f32_32x32x16_bf16 v[112:127], v[164:167], v[12:15], 0
    v_mfma_f32_32x32x8_bf16 v[112:127], v[170:171], v[10:11], v[112:127]
    s_nop 11
    v_max3_f32 v208, v208, v112, v113
    v_max3_f32 v208, v208, v114, v115
    v_max3_f32 v208, v208, v116, v117
    v_max3_f32 v208, v208, v118, v119
    v_max3_f32 v208, v208, v120, v121
    v_max3_f32 v208, v208, v122, v123
    v_max3_f32 v208, v208, v124, v125
    v_max3_f32 v208, v208, v126, v127
    s_cmp_gt_u32 s78, 6
    s_cbranch_scc1 Lmaxdone_61
    ds_read_b64 v[160:161], v245 offset:17280
    ds_read_b64 v[162:163], v245 offset:18432
    ds_read_b64 v[168:169], v246 offset:17280
    s_waitcnt lgkmcnt(0)
    v_mfma_f32_32x32x16_bf16 v[96:111], v[160:163], v[12:15], 0
    v_mfma_f32_32x32x8_bf16 v[96:111], v[168:169], v[10:11], v[96:111]
    s_nop 11
    v_max3_f32 v208, v208, v96, v97
    v_max3_f32 v208, v208, v98, v99
    v_max3_f32 v208, v208, v100, v101
    v_max3_f32 v208, v208, v102, v103
    v_max3_f32 v208, v208, v104, v105
    v_max3_f32 v208, v208, v106, v107
    v_max3_f32 v208, v208, v108, v109
    v_max3_f32 v208, v208, v110, v111
    s_cmp_gt_u32 s78, 5
    s_cbranch_scc1 Lmaxdone_61
    ds_read_b64 v[164:165], v212 offset:11520
    ds_read_b64 v[166:167], v212 offset:12672
    ds_read_b64 v[170:171], v213 offset:11520
    s_waitcnt lgkmcnt(0)
    v_mfma_f32_32x32x16_bf16 v[112:127], v[164:167], v[12:15], 0
    v_mfma_f32_32x32x8_bf16 v[112:127], v[170:171], v[10:11], v[112:127]
    s_nop 11
    v_max3_f32 v208, v208, v112, v113
    v_max3_f32 v208, v208, v114, v115
    v_max3_f32 v208, v208, v116, v117
    v_max3_f32 v208, v208, v118, v119
    v_max3_f32 v208, v208, v120, v121
    v_max3_f32 v208, v208, v122, v123
    v_max3_f32 v208, v208, v124, v125
    v_max3_f32 v208, v208, v126, v127
    s_cmp_gt_u32 s78, 4
    s_cbranch_scc1 Lmaxdone_61
    ds_read_b64 v[160:161], v245 offset:11520
    ds_read_b64 v[162:163], v245 offset:12672
    ds_read_b64 v[168:169], v246 offset:11520
    s_waitcnt lgkmcnt(0)
    v_mfma_f32_32x32x16_bf16 v[96:111], v[160:163], v[12:15], 0
    v_mfma_f32_32x32x8_bf16 v[96:111], v[168:169], v[10:11], v[96:111]
    s_nop 11
    v_max3_f32 v208, v208, v96, v97
    v_max3_f32 v208, v208, v98, v99
    v_max3_f32 v208, v208, v100, v101
    v_max3_f32 v208, v208, v102, v103
    v_max3_f32 v208, v208, v104, v105
    v_max3_f32 v208, v208, v106, v107
    v_max3_f32 v208, v208, v108, v109
    v_max3_f32 v208, v208, v110, v111
    s_cmp_gt_u32 s78, 3
    s_cbranch_scc1 Lmaxdone_61
    ds_read_b64 v[164:165], v212 offset:5760
    ds_read_b64 v[166:167], v212 offset:6912
    ds_read_b64 v[170:171], v213 offset:5760
    s_waitcnt lgkmcnt(0)
    v_mfma_f32_32x32x16_bf16 v[112:127], v[164:167], v[12:15], 0
    v_mfma_f32_32x32x8_bf16 v[112:127], v[170:171], v[10:11], v[112:127]
    s_nop 11
    v_max3_f32 v208, v208, v112, v113
    v_max3_f32 v208, v208, v114, v115
    v_max3_f32 v208, v208, v116, v117
    v_max3_f32 v208, v208, v118, v119
    v_max3_f32 v208, v208, v120, v121
    v_max3_f32 v208, v208, v122, v123
    v_max3_f32 v208, v208, v124, v125
    v_max3_f32 v208, v208, v126, v127
    s_cmp_gt_u32 s78, 2
    s_cbranch_scc1 Lmaxdone_61
    ds_read_b64 v[160:161], v245 offset:5760
    ds_read_b64 v[162:163], v245 offset:6912
    ds_read_b64 v[168:169], v246 offset:5760
    s_waitcnt lgkmcnt(0)
    v_mfma_f32_32x32x16_bf16 v[96:111], v[160:163], v[12:15], 0
    v_mfma_f32_32x32x8_bf16 v[96:111], v[168:169], v[10:11], v[96:111]
    s_nop 11
    v_max3_f32 v208, v208, v96, v97
    v_max3_f32 v208, v208, v98, v99
    v_max3_f32 v208, v208, v100, v101
    v_max3_f32 v208, v208, v102, v103
    v_max3_f32 v208, v208, v104, v105
    v_max3_f32 v208, v208, v106, v107
    v_max3_f32 v208, v208, v108, v109
    v_max3_f32 v208, v208, v110, v111
    s_cmp_gt_u32 s78, 1
    s_cbranch_scc1 Lmaxdone_61
    ds_read_b64 v[164:165], v212 offset:0
    ds_read_b64 v[166:167], v212 offset:1152
    ds_read_b64 v[170:171], v213 offset:0
    s_waitcnt lgkmcnt(0)
    v_mfma_f32_32x32x16_bf16 v[112:127], v[164:167], v[12:15], 0
    v_mfma_f32_32x32x8_bf16 v[112:127], v[170:171], v[10:11], v[112:127]
    s_nop 11
    v_max3_f32 v208, v208, v112, v113
    v_max3_f32 v208, v208, v114, v115
    v_max3_f32 v208, v208, v116, v117
    v_max3_f32 v208, v208, v118, v119
    v_max3_f32 v208, v208, v120, v121
    v_max3_f32 v208, v208, v122, v123
    v_max3_f32 v208, v208, v124, v125
    v_max3_f32 v208, v208, v126, v127
    s_cmp_gt_u32 s78, 0
    s_cbranch_scc1 Lmaxdone_61
    ds_read_b64 v[160:161], v245 offset:0
    ds_read_b64 v[162:163], v245 offset:1152
    ds_read_b64 v[168:169], v246 offset:0
    s_waitcnt lgkmcnt(0)
    v_mfma_f32_32x32x16_bf16 v[96:111], v[160:163], v[12:15], v[48:63]
    v_mfma_f32_32x32x8_bf16 v[96:111], v[168:169], v[10:11], v[96:111]
    s_nop 11
    v_max3_f32 v208, v208, v96, v97
    v_max3_f32 v208, v208, v98, v99
    v_max3_f32 v208, v208, v100, v101
    v_max3_f32 v208, v208, v102, v103
    v_max3_f32 v208, v208, v104, v105
    v_max3_f32 v208, v208, v106, v107
    v_max3_f32 v208, v208, v108, v109
    v_max3_f32 v208, v208, v110, v111
Lmaxdone_61:
    ds_read_b64 v[160:161], v245 offset:23040
    ds_read_b64 v[162:163], v245 offset:24192
    ds_read_b64 v[168:169], v246 offset:23040
    s_waitcnt lgkmcnt(0)
    v_mfma_f32_32x32x16_bf16 v[96:111], v[160:163], v[12:15], v[32:47]
    v_mfma_f32_32x32x8_bf16 v[96:111], v[168:169], v[10:11], v[96:111]
    s_nop 11
    ds_read_b64 v[164:165], v212 offset:17280
    ds_read_b64 v[166:167], v212 offset:18432
    ds_read_b64 v[170:171], v213 offset:17280
    s_waitcnt lgkmcnt(0)
    v_mfma_f32_32x32x16_bf16 v[112:127], v[164:167], v[12:15], 0
    v_mfma_f32_32x32x8_bf16 v[112:127], v[170:171], v[10:11], v[112:127]
    s_nop 11
    ds_read_b64_tr_b16 v[172:173], v247 offset:23040
    ds_read_b64_tr_b16 v[174:175], v252 offset:23040
    ds_read_b64_tr_b16 v[176:177], v253 offset:23040
    ds_read_b64_tr_b16 v[178:179], v254 offset:23040
    v_mov_b32 v192, 0
    v_mov_b32 v193, 0
    v_mov_b32 v194, 0
    v_mov_b32 v195, 0
    v_mov_b32 v196, 0
    v_mov_b32 v197, 0
    v_mov_b32 v198, 0
    v_mov_b32 v199, 0
    v_mov_b32 v200, 0
    v_mov_b32 v201, 0
    v_mov_b32 v202, 0
    v_mov_b32 v203, 0
    v_mov_b32 v204, 0
    v_mov_b32 v205, 0
    v_mov_b32 v206, 0
    v_mov_b32 v207, 0
    s_waitcnt lgkmcnt(0)
    s_branch L_A_m
Lfull_65:
    v_exp_f32 v96, v96
    v_exp_f32 v97, v97
    v_exp_f32 v98, v98
    ds_read_b64_tr_b16 v[180:181], v214 offset:17280
    ds_read_b64_tr_b16 v[182:183], v215 offset:17280
    v_exp_f32 v99, v99
    v_exp_f32 v100, v100
    v_exp_f32 v101, v101
    ds_read_b64_tr_b16 v[184:185], v216 offset:17280
    ds_read_b64_tr_b16 v[186:187], v217 offset:17280
    v_exp_f32 v102, v102
    v_exp_f32 v103, v103
    v_exp_f32 v104, v104
    ds_read_b64 v[164:165], v212 offset:11520
    ds_read_b64 v[166:167], v212 offset:12672
    v_exp_f32 v105, v105
    v_exp_f32 v106, v106
    v_exp_f32 v107, v107
    v_exp_f32 v108, v108
    s_waitcnt lgkmcnt(6)
    v_smfmac_f32_32x32x32_bf16 v[192:207], v[172:175], v[96:103], v16
    ds_read_b64 v[170:171], v213 offset:11520
    v_exp_f32 v109, v109
    v_exp_f32 v110, v110
    v_exp_f32 v111, v111
    s_cmp_gt_u32 s78, 7
    s_cbranch_scc1 Lstub_62
    v_exp_f32 v112, v112
    v_exp_f32 v113, v113
    v_exp_f32 v114, v114
    v_smfmac_f32_32x32x32_bf16 v[192:207], v[176:179], v[104:111], v16
    ds_read_b64_tr_b16 v[172:173], v247 offset:17280
    ds_read_b64_tr_b16 v[174:175], v252 offset:17280
    v_exp_f32 v115, v115
    v_exp_f32 v116, v116
    v_exp_f32 v117, v117
    v_mfma_f32_32x32x16_bf16 v[96:111], v[160:163], v[12:15], 0
    ds_read_b64_tr_b16 v[176:177], v253 offset:17280
    ds_read_b64_tr_b16 v[178:179], v254 offset:17280
    v_exp_f32 v118, v118
    v_exp_f32 v119, v119
    v_exp_f32 v120, v120
    v_mfma_f32_32x32x8_bf16 v[96:111], v[168:169], v[10:11], v[96:111]
    ds_read_b64 v[160:161], v245 offset:11520
    ds_read_b64 v[162:163], v245 offset:12672
    v_exp_f32 v121, v121
    v_exp_f32 v122, v122
    v_exp_f32 v123, v123
    v_exp_f32 v124, v124
    s_waitcnt lgkmcnt(6)
    v_smfmac_f32_32x32x32_bf16 v[192:207], v[180:183], v[112:119], v16
    ds_read_b64 v[168:169], v246 offset:11520
    v_exp_f32 v125, v125
    v_exp_f32 v126, v126
    v_exp_f32 v127, v127
    s_cmp_gt_u32 s78, 6
    s_cbranch_scc1 Lstub_63
    v_exp_f32 v96, v96
    v_exp_f32 v97, v97
    v_exp_f32 v98, v98
    v_smfmac_f32_32x32x32_bf16 v[192:207], v[184:187], v[120:127], v16
    ds_read_b64_tr_b16 v[180:181], v214 offset:11520
    ds_read_b64_tr_b16 v[182:183], v215 offset:11520
    v_exp_f32 v99, v99
    v_exp_f32 v100, v100
    v_exp_f32 v101, v101
    v_mfma_f32_32x32x16_bf16 v[112:127], v[164:167], v[12:15], 0
    ds_read_b64_tr_b16 v[184:185], v216 offset:11520
    ds_read_b64_tr_b16 v[186:187], v217 offset:11520
    v_exp_f32 v102, v102
    v_exp_f32 v103, v103
    v_exp_f32 v104, v104
    v_mfma_f32_32x32x8_bf16 v[112:127], v[170:171], v[10:11], v[112:127]
    ds_read_b64 v[164:165], v212 offset:5760
    ds_read_b64 v[166:167], v212 offset:6912
    v_exp_f32 v105, v105
    v_exp_f32 v106, v106
    v_exp_f32 v107, v107
    v_exp_f32 v108, v108
    s_waitcnt lgkmcnt(6)
    v_smfmac_f32_32x32x32_bf16 v[192:207], v[172:175], v[96:103], v16
    ds_read_b64 v[170:171], v213 offset:5760
    v_exp_f32 v109, v109
    v_exp_f32 v110, v110
    v_exp_f32 v111, v111
    s_cmp_gt_u32 s78, 5
    s_cbranch_scc1 Lstub_62
    v_exp_f32 v112, v112
    v_exp_f32 v113, v113
    v_exp_f32 v114, v114
    v_smfmac_f32_32x32x32_bf16 v[192:207], v[176:179], v[104:111], v16
    ds_read_b64_tr_b16 v[172:173], v247 offset:11520
    ds_read_b64_tr_b16 v[174:175], v252 offset:11520
    v_exp_f32 v115, v115
    v_exp_f32 v116, v116
    v_exp_f32 v117, v117
    v_mfma_f32_32x32x16_bf16 v[96:111], v[160:163], v[12:15], 0
    ds_read_b64_tr_b16 v[176:177], v253 offset:11520
    ds_read_b64_tr_b16 v[178:179], v254 offset:11520
    v_exp_f32 v118, v118
    v_exp_f32 v119, v119
    v_exp_f32 v120, v120
    v_mfma_f32_32x32x8_bf16 v[96:111], v[168:169], v[10:11], v[96:111]
    ds_read_b64 v[160:161], v245 offset:5760
    ds_read_b64 v[162:163], v245 offset:6912
    v_exp_f32 v121, v121
    v_exp_f32 v122, v122
    v_exp_f32 v123, v123
    v_exp_f32 v124, v124
    s_waitcnt lgkmcnt(6)
    v_smfmac_f32_32x32x32_bf16 v[192:207], v[180:183], v[112:119], v16
    ds_read_b64 v[168:169], v246 offset:5760
    v_exp_f32 v125, v125
    v_exp_f32 v126, v126
    v_exp_f32 v127, v127
    s_cmp_gt_u32 s78, 4
    s_cbranch_scc1 Lstub_63
    v_exp_f32 v96, v96
    v_exp_f32 v97, v97
    v_exp_f32 v98, v98
    v_smfmac_f32_32x32x32_bf16 v[192:207], v[184:187], v[120:127], v16
    ds_read_b64_tr_b16 v[180:181], v214 offset:5760
    ds_read_b64_tr_b16 v[182:183], v215 offset:5760
    v_exp_f32 v99, v99
    v_exp_f32 v100, v100
    v_exp_f32 v101, v101
    v_mfma_f32_32x32x16_bf16 v[112:127], v[164:167], v[12:15], 0
    ds_read_b64_tr_b16 v[184:185], v216 offset:5760
    ds_read_b64_tr_b16 v[186:187], v217 offset:5760
    v_exp_f32 v102, v102
    v_exp_f32 v103, v103
    v_exp_f32 v104, v104
    v_mfma_f32_32x32x8_bf16 v[112:127], v[170:171], v[10:11], v[112:127]
    ds_read_b64 v[164:165], v212 offset:0
    ds_read_b64 v[166:167], v212 offset:1152
    v_exp_f32 v105, v105
    v_exp_f32 v106, v106
    v_exp_f32 v107, v107
    v_exp_f32 v108, v108
    s_waitcnt lgkmcnt(6)
    v_smfmac_f32_32x32x32_bf16 v[192:207], v[172:175], v[96:103], v16
    ds_read_b64 v[170:171], v213 offset:0
    v_exp_f32 v109, v109
    v_exp_f32 v110, v110
    v_exp_f32 v111, v111
    s_cmp_gt_u32 s78, 3
    s_cbranch_scc1 Lstub_62
    v_exp_f32 v112, v112
    v_exp_f32 v113, v113
    v_exp_f32 v114, v114
    v_smfmac_f32_32x32x32_bf16 v[192:207], v[176:179], v[104:111], v16
    ds_read_b64_tr_b16 v[172:173], v247 offset:5760
    ds_read_b64_tr_b16 v[174:175], v252 offset:5760
    v_exp_f32 v115, v115
    v_exp_f32 v116, v116
    v_exp_f32 v117, v117
    v_mfma_f32_32x32x16_bf16 v[96:111], v[160:163], v[12:15], 0
    ds_read_b64_tr_b16 v[176:177], v253 offset:5760
    ds_read_b64_tr_b16 v[178:179], v254 offset:5760
    v_exp_f32 v118, v118
    v_exp_f32 v119, v119
    v_exp_f32 v120, v120
    v_mfma_f32_32x32x8_bf16 v[96:111], v[168:169], v[10:11], v[96:111]
    ds_read_b64 v[160:161], v245 offset:0
    ds_read_b64 v[162:163], v245 offset:1152
    v_exp_f32 v121, v121
    v_exp_f32 v122, v122
    v_exp_f32 v123, v123
    v_exp_f32 v124, v124
    s_waitcnt lgkmcnt(6)
    v_smfmac_f32_32x32x32_bf16 v[192:207], v[180:183], v[112:119], v16
    ds_read_b64 v[168:169], v246 offset:0
    v_exp_f32 v125, v125
    v_exp_f32 v126, v126
    v_exp_f32 v127, v127
    s_cmp_gt_u32 s78, 2
    s_cbranch_scc1 Lstub_63
    v_exp_f32 v96, v96
    v_exp_f32 v97, v97
    v_exp_f32 v98, v98
    v_smfmac_f32_32x32x32_bf16 v[192:207], v[184:187], v[120:127], v16
    ds_read_b64_tr_b16 v[180:181], v214 offset:0
    ds_read_b64_tr_b16 v[182:183], v215 offset:0
    v_exp_f32 v99, v99
    v_exp_f32 v100, v100
    v_exp_f32 v101, v101
    v_mfma_f32_32x32x16_bf16 v[112:127], v[164:167], v[12:15], 0
    ds_read_b64_tr_b16 v[184:185], v216 offset:0
    ds_read_b64_tr_b16 v[186:187], v217 offset:0
    v_exp_f32 v102, v102
    v_exp_f32 v103, v103
    v_exp_f32 v104, v104
    v_mfma_f32_32x32x8_bf16 v[112:127], v[170:171], v[10:11], v[112:127]
    v_exp_f32 v105, v105
    v_exp_f32 v106, v106
    v_exp_f32 v107, v107
    v_exp_f32 v108, v108
    s_waitcnt lgkmcnt(4)
    v_smfmac_f32_32x32x32_bf16 v[192:207], v[172:175], v[96:103], v16
    v_exp_f32 v109, v109
    v_exp_f32 v110, v110
    v_exp_f32 v111, v111
    s_nop 0
    s_cmp_gt_u32 s78, 1
    s_cbranch_scc1 Lstub_62
    v_exp_f32 v112, v112
    v_exp_f32 v113, v113
    v_exp_f32 v114, v114
    v_smfmac_f32_32x32x32_bf16 v[192:207], v[176:179], v[104:111], v16
    ds_read_b64_tr_b16 v[172:173], v247 offset:0
    ds_read_b64_tr_b16 v[174:175], v252 offset:0
    v_exp_f32 v115, v115
    v_exp_f32 v116, v116
    v_exp_f32 v117, v117
    v_mfma_f32_32x32x16_bf16 v[96:111], v[160:163], v[12:15], v[48:63]
    ds_read_b64_tr_b16 v[176:177], v253 offset:0
    ds_read_b64_tr_b16 v[178:179], v254 offset:0
    v_exp_f32 v118, v118
    v_exp_f32 v119, v119
    v_exp_f32 v120, v120
    v_mfma_f32_32x32x8_bf16 v[96:111], v[168:169], v[10:11], v[96:111]
    v_exp_f32 v121, v121
    v_exp_f32 v122, v122
    v_exp_f32 v123, v123
    v_exp_f32 v124, v124
    s_waitcnt lgkmcnt(4)
    v_smfmac_f32_32x32x32_bf16 v[192:207], v[180:183], v[112:119], v16
    v_exp_f32 v125, v125
    v_exp_f32 v126, v126
    v_exp_f32 v127, v127
    s_nop 0
    s_cmp_gt_u32 s78, 0
    s_cbranch_scc1 Lstub_63
    v_exp_f32 v96, v96
    v_exp_f32 v97, v97
    v_exp_f32 v98, v98
    v_smfmac_f32_32x32x32_bf16 v[192:207], v[184:187], v[120:127], v16
    v_exp_f32 v99, v99
    v_exp_f32 v100, v100
    v_exp_f32 v101, v101
    v_exp_f32 v102, v102
    v_exp_f32 v103, v103
    v_exp_f32 v104, v104
    v_exp_f32 v105, v105
    v_exp_f32 v106, v106
    v_exp_f32 v107, v107
    v_exp_f32 v108, v108
    s_waitcnt lgkmcnt(0)
    v_smfmac_f32_32x32x32_bf16 v[192:207], v[172:175], v[96:103], v16
    v_exp_f32 v109, v109
    v_exp_f32 v110, v110
    v_exp_f32 v111, v111
    s_nop 1
    s_branch Lstub_62
Lstub_63:
    v_smfmac_f32_32x32x32_bf16 v[192:207], v[184:187], v[120:127], v16
    s_branch Lfin_64
.section .rodata,"a"
.p2align 6
.amdhsa_kernel concat_heads__sliding_block__grouped_kv_mqa__prompt_kernel
  .amdhsa_next_free_vgpr 256
  .amdhsa_next_free_sgpr 102
  .amdhsa_accum_offset 256
  .amdhsa_group_segment_fixed_size 0
  .amdhsa_kernarg_size 88
  .amdhsa_user_sgpr_count 2
  .amdhsa_user_sgpr_kernarg_segment_ptr 1
  .amdhsa_system_sgpr_workgroup_id_x 1
.end_amdhsa_kernel
```
